```python
import torch

def _softmax(x, axis=-1):
    return torch.softmax(x, dim=axis)

def _gelu(x):
    return torch.nn.functional.gelu(x, approximate='tanh')

def _silu(x):
    return torch.nn.functional.silu(x)

def _sigmoid(x):
    return torch.sigmoid(x)

def _layernorm(x, axis=-1, eps=1e-05):
    m = x.mean(dim=axis, keepdim=True)
    v = x.var(dim=axis, keepdim=True, unbiased=False)
    return (x - m) / torch.sqrt(v + eps)

def _scatter_add(tgt, idx, src, axis=0):
    return tgt.clone().index_add_(axis, idx, src)

def _segment_sum(src, seg, n):
    out = torch.zeros((n,) + src.shape[1:], dtype=src.dtype)
    return out.index_add_(0, seg, src)

def _pad(x, pw):
    flat = tuple((v for pair in reversed(pw) for v in pair))
    return torch.nn.functional.pad(x, flat)
kernel_name = 'adaLN_cond__sliding_local_dilated__glu_gated_geglu__prompt'

def setup_inputs():

    _w = lambda a: (lambda t: t.to(torch.bfloat16) if t.is_floating_point() else t)(torch.as_tensor(a))

    def _A_setup():
        B, S, D = (1, 2048, 448)
        return {'x': _w((lambda *s: torch.randn(*s, dtype=torch.bfloat16) * 0.05)(B, S, D)), 'wqkv': _w((lambda *s: torch.randn(*s, dtype=torch.bfloat16) * 0.05)(D, 3 * D)), 'wo': _w((lambda *s: torch.randn(*s, dtype=torch.bfloat16) * 0.05)(D, D))}
    _A_in = _A_setup()

    def _B_setup():
        B, S, Dm, Df = (1, 2048, 448, 1792)
        return {'x': _w((lambda *s: torch.randn(*s, dtype=torch.bfloat16) * 0.05)(B, S, Dm)), 'w_gate': _w((lambda *s: torch.randn(*s, dtype=torch.bfloat16) * 0.8)(Dm, Df) * Dm ** (-0.5)), 'w_up': _w((lambda *s: torch.randn(*s, dtype=torch.bfloat16) * 0.8)(Dm, Df) * Dm ** (-0.5)), 'w_down': _w((lambda *s: torch.randn(*s, dtype=torch.bfloat16) * 0.8)(Df, Dm) * Df ** (-0.5))}
    _B_in = _B_setup()
    return {'A_x': _A_in['x'], 'A_wqkv': _A_in['wqkv'], 'A_wo': _A_in['wo'], 'B_x': _B_in['x'], 'B_w_gate': _B_in['w_gate'], 'B_w_up': _B_in['w_up'], 'B_w_down': _B_in['w_down'], 'c': _w((lambda *s: torch.randn(*s, dtype=torch.bfloat16) * 0.1)(1, 448) * 8.0), 'w_mod': _w((lambda *s: torch.randn(*s, dtype=torch.bfloat16) * 0.1)(448, 6 * 448) * 448 ** (-0.5) * 8.0)}

def reference(A_x, A_wqkv, A_wo, B_x, B_w_gate, B_w_up, B_w_down, c, w_mod):

    def _A_ref(x, wqkv, wo):
        B, S, D = x.shape
        H = 16
        Dh = D // H
        W, dil = (8, 2)
        qkv = (lambda x, *d: x.permute(*d))((x @ wqkv).reshape(B, S, 3, H, Dh), 2, 0, 3, 1, 4)
        q, k, v = (qkv[0], qkv[1], qkv[2])
        scale = Dh ** (-0.5)
        pos = torch.arange(S)
        off = torch.arange(W) * dil
        idx = pos[:, None] - off[None, :]
        mask = idx >= 0
        idx_c = torch.where(mask, idx, 0).reshape(-1)
        kg = k[:, :, idx_c, :].reshape(B, H, S, W, Dh)
        vg = v[:, :, idx_c, :].reshape(B, H, S, W, Dh)
        logits = torch.einsum('bhsd,bhswd->bhsw', q, kg) * scale
        logits = torch.where(mask[None, None, :, :], logits, -1000000000.0)
        attn = _softmax(logits, axis=-1)
        o = torch.einsum('bhsw,bhswd->bhsd', attn, vg)
        return (lambda x, *d: x.permute(*d))(o, 0, 2, 1, 3).reshape(B, S, D) @ wo

    def _B_ref(x, w_gate, w_up, w_down):
        g = torch.einsum('bsd,df->bsf', x, w_gate)
        u = torch.einsum('bsd,df->bsf', x, w_up)
        h = _gelu(g) * u
        return torch.einsum('bsf,fd->bsd', h, w_down)
    x = A_x
    mod = (_silu(c) @ w_mod).reshape(c.shape[0], 6, 1, -1)
    sa, ca, ga, sb, cb, gb = (mod[:, 0].clone(), mod[:, 1].clone(), mod[:, 2].clone(), mod[:, 3].clone(), mod[:, 4].clone(), mod[:, 5].clone())
    h = _layernorm(x, axis=-1) * (1 + ca) + sa
    x = x + ga * _A_ref(h, A_wqkv, A_wo)
    h = _layernorm(x, axis=-1) * (1 + cb) + sb
    x = x + gb * _B_ref(h, B_w_gate, B_w_up, B_w_down)
    return x
```

```asm
; @launch grid=(256,1,1) block=(256,1,1) lds=163840
.amdgcn_target "amdgcn-amd-amdhsa--gfx950"
.text
.globl adaLN_cond__sliding_local_dilated__glu_gated_geglu__prompt_kernel
.p2align 8
.type adaLN_cond__sliding_local_dilated__glu_gated_geglu__prompt_kernel,@function
adaLN_cond__sliding_local_dilated__glu_gated_geglu__prompt_kernel:
L_start:
    s_cmp_ge_u32 s2, 256
    s_cbranch_scc1 L_end
    s_getpc_b64 s[60:61]
L_pc:
    s_lshl_b32 s57, s2, 8
    s_and_b32 s57, s57, 0xf800
    v_and_b32 v4, 15, v0
    v_lshrrev_b32 v8, 4, v0
    v_lshl_add_u32 v8, v8, 7, s57
    v_min_u32 v8, L_end-L_pc, v8
    global_load_dword v255, v8, s[60:61]
    s_load_dwordx2 s[8:9], s[0:1], 0
    s_load_dwordx2 s[36:37], s[0:1], 64
    s_load_dwordx2 s[32:33], s[0:1], 56
    s_load_dwordx2 s[12:13], s[0:1], 8
    s_load_dwordx2 s[44:45], s[0:1], 80
    s_load_dwordx2 s[48:49], s[0:1], 88
    s_load_dwordx2 s[16:17], s[0:1], 16
    s_load_dwordx2 s[20:21], s[0:1], 32
    s_load_dwordx2 s[24:25], s[0:1], 40
    s_load_dwordx2 s[28:29], s[0:1], 48
    s_load_dwordx2 s[40:41], s[0:1], 72
    s_memrealtime s[52:53]
    v_lshrrev_b32 v1, 6, v0
    v_and_b32 v0, 63, v0
    v_readfirstlane_b32 s3, v1
    s_and_b32 s6, s2, 7
    s_lshr_b32 s7, s2, 3
    s_lshr_b32 s56, s6, 1
    s_lshl_b32 s56, s56, 2
    s_lshr_b32 s57, s7, 3
    s_add_u32 s4, s56, s57
    s_and_b32 s56, s6, 1
    s_lshl_b32 s56, s56, 3
    s_and_b32 s57, s7, 7
    s_add_u32 s5, s56, s57
    s_lshl_b32 s77, s4, 20
    s_mov_b32 s6, 0
    s_mov_b32 s11, 0x20000
    s_mov_b32 s10, 1835008
    s_mov_b32 s14, 1204224
    s_mov_b32 s15, s11
    s_mov_b32 s18, 401408
    s_mov_b32 s19, s11
    s_mov_b32 s22, 1605632
    s_mov_b32 s23, s11
    s_mov_b32 s26, 1605632
    s_mov_b32 s27, s11
    s_mov_b32 s30, 1605632
    s_mov_b32 s31, s11
    s_mov_b32 s34, 896
    s_mov_b32 s35, s11
    s_mov_b32 s38, 2408448
    s_mov_b32 s39, s11
    s_mov_b32 s42, 1835008
    s_mov_b32 s43, s11
    s_mov_b32 s46, 256
    s_mov_b32 s47, s11
    s_mov_b32 s50, 23068672
    s_mov_b32 s51, s11
    s_mov_b32 s55, 0xffff0000
    v_and_b32 v2, 7, v0
    v_lshrrev_b32 v3, 3, v0
    v_lshrrev_b32 v5, 4, v0
    v_lshlrev_b32 v7, 4, v0
    v_mov_b32 v116, 0
    v_mov_b32 v117, 0
    s_mov_b32 s54, s3
    s_cmp_eq_u32 s3, 2
    s_cbranch_scc1 L_i2
    s_cmp_eq_u32 s3, 3
    s_cbranch_scc1 L_i1
    s_add_u32 s58, s5, 2
    s_cmp_eq_u32 s3, 0
    s_cbranch_scc1 L_i0
    s_mov_b32 s58, s5
    s_cmp_ge_u32 s5, 2
    s_cbranch_scc1 L_i1
    s_mov_b32 s54, 0
L_i0:
    s_lshl_b32 s56, s4, 4
    v_mul_u32_u24 v8, 896, v2
    s_add_u32 s56, s56, s58
    s_sub_u32 s56, s56, 2
    v_lshl_add_u32 v8, v3, 4, v8
    s_mul_i32 s56, s56, 7168
    v_add_u32 v8, s56, v8
    s_waitcnt lgkmcnt(0)
    s_or_b32 s56, s2, s3
    s_cmp_lg_u32 s56, 0
    s_cbranch_scc1 L_notag
    v_or_b32 v12, 1, v0
    v_or_b32 v12, s52, v12
    v_mov_b32 v13, s53
    v_mov_b32 v14, 0
    v_mov_b32 v15, 0
    s_mov_b64 exec, 1
    buffer_atomic_cmpswap_x2 v[12:15], off, s[44:47], 0 sc1
    s_mov_b64 exec, -1
L_notag:
    buffer_load_dwordx4 v[16:19], v8, s[8:11], 0 offen offset:0 nt
    buffer_load_dwordx4 v[20:23], v8, s[8:11], 0 offen offset:128 nt
    buffer_load_dwordx4 v[24:27], v8, s[8:11], 0 offen offset:256 nt
    buffer_load_dwordx4 v[28:31], v8, s[8:11], 0 offen offset:384 nt
    buffer_load_dwordx4 v[32:35], v8, s[8:11], 0 offen offset:512 nt
    buffer_load_dwordx4 v[36:39], v8, s[8:11], 0 offen offset:640 nt
    buffer_load_dwordx4 v[40:43], v8, s[8:11], 0 offen offset:768 nt
    s_lshl_b32 s56, s58, 7
    s_add_u32 s6, s77, s56
    s_add_u32 s6, s6, 999424
    s_lshr_b32 s56, s58, 1
    s_mul_i32 s56, s56, 14336
    s_add_u32 s79, s77, s56
    s_and_b32 s56, s58, 1
    s_lshl_b32 s56, s56, 7
    s_add_u32 s79, s79, s56
    v_lshlrev_b32 v116, 8, v3
    v_lshl_add_u32 v116, v2, 4, v116
    s_branch L_setup
L_i1:
    s_mov_b32 s56, 0x92817000
    s_mov_b32 s57, 0x6d5c4b3a
    s_lshl_b32 s58, s5, 2
    s_lshr_b64 s[56:57], s[56:57], s58
    s_and_b32 s56, s56, 15
    s_cmp_lt_u32 s56, 7
    s_cselect_b32 s54, s54, 4
    s_cmp_eq_u32 s54, 3
    s_cbranch_scc1 L_i3
    s_mul_i32 s57, s3, 7
    s_lshr_b32 s57, s57, 1
    s_add_u32 s56, s56, s57
    s_sub_u32 s56, s56, 3
    s_lshl_b32 s56, s56, 4
    v_mul_u32_u24 v117, 37632, v3
    s_add_u32 s56, s56, s4
    v_mul_u32_u24 v9, 14, v3
    s_lshr_b32 s59, s56, 3
    s_and_b32 s60, s56, 7
    v_lshl_add_u32 v117, v2, 4, v117
    s_mul_i32 s68, s60, 301056
    s_lshl_b32 s57, s59, 7
    s_mul_i32 s65, s60, 112
    s_add_u32 s68, s68, s57
    s_waitcnt lgkmcnt(0)
    buffer_load_dwordx4 v[16:19], v117, s[36:39], s68 offen nt
    s_add_u32 s68, s68, 5376
    buffer_load_dwordx4 v[20:23], v117, s[36:39], s68 offen nt
    s_add_u32 s68, s68, 5376
    buffer_load_dwordx4 v[24:27], v117, s[36:39], s68 offen nt
    s_add_u32 s68, s68, 5376
    buffer_load_dwordx4 v[28:31], v117, s[36:39], s68 offen nt
    s_add_u32 s68, s68, 5376
    buffer_load_dwordx4 v[32:35], v117, s[36:39], s68 offen nt
    s_add_u32 s68, s68, 5376
    buffer_load_dwordx4 v[36:39], v117, s[36:39], s68 offen nt
    s_add_u32 s68, s68, 5376
    buffer_load_dwordx4 v[40:43], v117, s[36:39], s68 offen nt
L_i1b:
    buffer_load_ushort v44, v9, s[32:35], s65 offen offset:0
    buffer_load_ushort v45, v9, s[32:35], s65 offen offset:2
    buffer_load_ushort v46, v9, s[32:35], s65 offen offset:4
    buffer_load_ushort v47, v9, s[32:35], s65 offen offset:6
    buffer_load_ushort v48, v9, s[32:35], s65 offen offset:8
    buffer_load_ushort v49, v9, s[32:35], s65 offen offset:10
    buffer_load_ushort v50, v9, s[32:35], s65 offen offset:12
    v_lshrrev_b32 v116, 5, v0
    s_mul_i32 s57, s60, 10752
    v_lshlrev_b32 v116, 4, v116
    s_lshl_b32 s56, s59, 8
    v_lshl_add_u32 v116, v2, 5, v116
    s_add_u32 s57, s57, s56
    s_add_u32 s79, s57, 16777216
    v_mov_b32 v64, 0
    v_mov_b32 v65, 0
    v_mov_b32 v66, 0
    v_mov_b32 v67, 0
    v_mov_b32 v68, 0
    v_mov_b32 v69, 0
    v_mov_b32 v70, 0
    v_mov_b32 v71, 0
    s_branch L_setup
L_i2:
    s_cmp_ge_u32 s4, 14
    s_cselect_b32 s54, 3, s54
    s_cbranch_scc1 L_i3
    v_lshrrev_b32 v6, 2, v0
    v_and_b32 v8, 2, v5
    v_and_b32 v9, 3, v0
    v_mul_u32_u24 v6, 2688, v6
    v_xor_b32 v8, v8, v9
    s_mul_i32 s56, s5, 56
    s_mul_i32 s57, s4, 86016
    v_lshl_add_u32 v6, v8, 4, v6
    s_and_b32 s56, s56, 0xfff0
    s_add_u32 s57, s57, s56
    s_waitcnt lgkmcnt(0)
    s_mov_b32 m0, 77824
    s_add_u32 s60, s57, 0
    buffer_load_dwordx4 v6, s[12:15], s60 offen nt lds
    s_mov_b32 m0, 78848
    s_add_u32 s60, s57, 43008
    buffer_load_dwordx4 v6, s[12:15], s60 offen nt lds
    s_mov_b32 m0, 79872
    s_add_u32 s60, s57, 896
    buffer_load_dwordx4 v6, s[12:15], s60 offen nt lds
    s_mov_b32 m0, 80896
    s_add_u32 s60, s57, 43904
    buffer_load_dwordx4 v6, s[12:15], s60 offen nt lds
    s_mov_b32 m0, 81920
    s_add_u32 s60, s57, 1792
    buffer_load_dwordx4 v6, s[12:15], s60 offen nt lds
    s_mov_b32 m0, 82944
    s_add_u32 s60, s57, 44800
    buffer_load_dwordx4 v6, s[12:15], s60 offen nt lds
    s_and_b32 s56, s5, 1
    v_add_u32 v8, s56, v9
    v_and_b32 v9, 1, v5
    v_lshlrev_b32 v9, 2, v9
    v_xor_b32 v8, v8, v9
    v_lshlrev_b32 v8, 3, v8
    v_lshrrev_b32 v9, 2, v4
    v_lshl_add_u32 v9, v5, 3, v9
    v_lshl_add_u32 v8, v9, 6, v8
    v_add_u32 v116, 77824, v8
    v_xor_b32 v117, 32, v116
    s_mul_i32 s79, s5, 86016
    s_mul_i32 s56, s4, 6144
    s_add_u32 s79, s79, s56
    s_add_u32 s79, s79, 18874368
    s_lshl_b32 s6, s5, 4
    s_add_u32 s6, s6, s4
    s_lshl_b32 s6, s6, 7
    s_add_u32 s6, s6, 20447232
L_i3:
    s_waitcnt lgkmcnt(0)
L_setup:
    s_lshr_b32 s62, s5, 3
    s_and_b32 s63, s5, 7
    s_sub_u32 s64, s5, s62
    s_lshl_b32 s56, s3, 6
    v_add_u32 v13, s56, v0
    v_mov_b32 v14, 112
    v_cmp_ge_u32 s[58:59], v13, v14
    v_subrev_u32 v14, 112, v13
    s_nop 0
    v_cndmask_b32 v14, v13, v14, s[58:59]
    v_lshrrev_b32 v15, 1, v14
    v_lshlrev_b32 v15, 6, v15
    v_and_b32 v14, 1, v14
    v_lshl_add_u32 v15, v14, 4, v15
    v_cndmask_b32 v14, 32, 0, s[58:59]
    v_add_u32 v15, v15, v14
    v_lshlrev_b32 v14, 4, v13
    v_mov_b32 v235, 224
    v_cmp_lt_u32 s[66:67], v13, v235
    s_nop 1
    v_cndmask_b32 v238, v14, v15, s[66:67]
    v_cndmask_b32 v239, 0, 1.0, s[58:59]
    s_min_u32 s56, s5, 13
    s_lshl_b32 s56, s56, 9
    v_add_u32 v235, s56, v14
    v_cndmask_b32 v235, v235, v14, s[66:67]
    s_mul_i32 s57, s3, 28672
    s_add_u32 s72, s77, s57
    s_add_u32 s73, s72, 28672
    s_add_u32 s72, s72, 14336
    s_lshl_b32 s74, s3, 10
    s_add_u32 s74, s74, s77
    s_mul_i32 s75, s5, 86016
    s_mul_i32 s76, s3, 3072
    s_add_u32 s75, s75, s76
    s_add_u32 s75, s75, 18874368
    s_add_u32 s76, s76, 77824
    v_add_u32 v8, 77824, v7
    v_add_u32 v9, 126976, v7
    s_mul_i32 s56, s3, 6144
    v_add_u32 v10, s56, v8
    v_add_u32 v11, 49152, v10
    s_min_u32 s56, s56, 6144
    s_add_u32 s56, s56, 73728
    v_add_u32 v1, s56, v8
    v_lshlrev_b32 v12, 6, v5
    s_lshl_b32 s56, s3, 8
    v_add_u32 v6, s56, v12
    v_lshlrev_b32 v13, 2, v5
    v_sub_u32 v13, v4, v13
    s_mov_b32 s56, 0x80000001
    s_mov_b32 s57, 0x80000000
    v_mov_b32 v15, 0xf149f2ca
    s_or_b32 s58, s4, s3
    s_cmp_eq_u32 s58, 0
    s_cselect_b32 s58, 0xf149f2ca, 0
    v_subrev_u32 v14, 0, v13
    v_and_b32 v14, s56, v14
    v_cmp_eq_u32 vcc, s57, v14
    v_cmp_eq_u32 s[60:61], 0, v14
    s_nop 0
    v_cndmask_b32 v240, v15, 0, vcc
    v_cndmask_b32 v244, v15, 0, s[60:61]
    v_min_f32 v248, s58, v240
    v_subrev_u32 v14, 1, v13
    v_and_b32 v14, s56, v14
    v_cmp_eq_u32 vcc, s57, v14
    v_cmp_eq_u32 s[60:61], 0, v14
    s_nop 0
    v_cndmask_b32 v241, v15, 0, vcc
    v_cndmask_b32 v245, v15, 0, s[60:61]
    v_min_f32 v249, s58, v241
    v_subrev_u32 v14, 2, v13
    v_and_b32 v14, s56, v14
    v_cmp_eq_u32 vcc, s57, v14
    v_cmp_eq_u32 s[60:61], 0, v14
    s_nop 0
    v_cndmask_b32 v242, v15, 0, vcc
    v_cndmask_b32 v246, v15, 0, s[60:61]
    v_min_f32 v250, s58, v242
    v_subrev_u32 v14, 3, v13
    v_and_b32 v14, s56, v14
    v_cmp_eq_u32 vcc, s57, v14
    v_cmp_eq_u32 s[60:61], 0, v14
    s_nop 0
    v_cndmask_b32 v243, v15, 0, vcc
    v_cndmask_b32 v247, v15, 0, s[60:61]
    v_min_f32 v251, s58, v243
    v_lshrrev_b32 v252, 2, v4
    v_lshrrev_b32 v13, 1, v252
    v_lshlrev_b32 v13, 6, v13
    v_lshl_add_u32 v13, v252, 7, v13
    v_lshrrev_b32 v252, 5, v0
    v_lshl_add_u32 v252, v252, 9, v13
    v_and_b32 v13, 1, v5
    v_lshl_add_u32 v252, v13, 5, v252
    v_and_b32 v13, 3, v0
    v_lshl_add_u32 v252, v13, 3, v252
    s_and_b32 s56, s3, 1
    s_lshl_b32 s56, s56, 6
    v_xor_b32 v252, s56, v252
    s_mul_i32 s56, s56, 448
    v_add_u32 v252, s56, v252
    v_add_u32 v252, 16384, v252
    v_min_u32 v13, 13, v0
    v_lshrrev_b32 v14, 1, v13
    v_mul_u32_u24 v14, 3584, v14
    v_and_b32 v253, 1, v13
    v_lshl_add_u32 v253, v253, 7, v14
    s_lshl_b32 s56, s4, 2
    s_add_u32 s56, s56, s3
    s_mul_i32 s56, s56, 25088
    s_lshl_b32 s57, s64, 8
    s_add_u32 s56, s56, s57
    v_add_u32 v253, s56, v253
    v_mov_b32 v254, v253
    s_lshl_b32 s56, s7, 2
    s_add_u32 s56, s56, s3
    s_mul_i32 s56, s56, 49
    v_min_u32 v14, 48, v0
    v_add_u32 v14, s56, v14
    v_mul_u32_u24 v253, 9363, v14
    v_lshrrev_b32 v253, 17, v253
    v_lshlrev_b32 v14, 7, v14
    v_mul_u32_u24 v253, 1792, v253
    s_mul_i32 s56, s62, 1792
    v_add3_u32 v253, v253, v14, s56
    v_and_b32 v232, 1, v5
    v_lshlrev_b32 v232, 2, v232
    v_xor_b32 v232, v232, v2
    v_mul_u32_u24 v233, 896, v3
    v_lshl_add_u32 v232, v232, 4, v233
    s_lshl_b32 s71, s63, 7
    s_mul_i32 s56, s3, 7168
    s_add_u32 s71, s71, s56
    s_lshl_b32 s70, s3, 10
    s_add_u32 s70, s70, 16384
    s_lshr_b32 s69, s7, 3
    s_lshl_b32 s69, s69, 3
    s_and_b32 s56, s2, 7
    s_add_u32 s69, s69, s56
    s_mul_i32 s69, s69, 15
    s_lshr_b32 s69, s69, 5
    s_lshl_b32 s69, s69, 12
    v_mov_b32 v228, 4096
    v_lshlrev_b32 v229, 3, v0
    v_min_u32 v234, 17, v0
    v_lshlrev_b32 v234, 7, v234
    s_add_u32 s57, s77, 999424
    v_add_u32 v234, s57, v234
    v_min_u32 v233, 13, v4
    v_lshlrev_b32 v233, 7, v233
    s_lshl_b32 s57, s5, 11
    s_add_u32 s57, s57, 20447232
    v_add_u32 v233, s57, v233
    v_cmp_gt_u32 vcc, 32, v0
    s_nop 1
    v_cndmask_b32 v234, v233, v234, vcc
    s_cmp_lg_u32 s3, 2
    s_cbranch_scc1 L_nowt
    v_min_u32 v13, 12, v0
    s_mul_i32 s56, s2, 1664
    v_lshlrev_b32 v13, 7, v13
    buffer_load_dword v255, v13, s[16:19], s56 offen
L_nowt:
    v_mov_b32 v236, 0
    v_mov_b32 v237, 0
    s_cmp_eq_u32 s6, 0
    s_cselect_b32 s56, 0x40000000, s6
    s_mov_b64 exec, 0xffff
    buffer_store_dwordx2 v[236:237], v229, s[48:51], s56 offen sc1
    s_mov_b64 exec, -1
    s_and_b32 s58, s3, 1
    s_and_b32 s57, s3, 2
    s_lshl_b32 s65, s63, 1
    s_add_u32 s57, s57, s62
    s_add_u32 s65, s65, s58
    s_lshl_b32 s56, s4, 2
    s_lshl_b32 s13, s3, 12
    s_add_u32 s56, s56, s57
    s_lshl_b32 s12, s3, 11
    s_mul_i32 s59, s56, 28672
    s_lshl_b32 s56, s65, 6
    s_add_u32 s13, s13, 16384
    s_add_u32 s59, s59, s56
    s_add_u32 s60, s13, 2048
    s_lshl_b32 s56, s5, 7
    s_add_u32 s0, s77, s56
    s_add_u32 s0, s0, s12
    s_add_u32 s0, s0, 1003520
    s_lshl_b32 s1, s3, 15
    s_lshl_b32 s56, s5, 11
    s_add_u32 s1, s1, s77
    s_add_u32 s1, s1, s56
    s_add_u32 s1, s1, 131072
    s_lshl_b32 s7, s64, 8
    s_mul_i32 s56, s3, 28672
    s_add_u32 s7, s7, s56
    s_lshl_b32 s14, s57, 11
    s_lshl_b32 s56, s58, 10
    s_add_u32 s14, s14, s77
    s_add_u32 s14, s14, s56
    s_add_u32 s14, s14, 1003520
    s_lshl_b32 s15, s57, 15
    s_lshl_b32 s56, s58, 14
    s_add_u32 s15, s15, s77
    s_add_u32 s15, s15, s56
    s_add_u32 s15, s15, 131072
    s_mul_i32 s32, s3, 7168
    s_add_u32 s33, s32, s77
    s_lshl_b32 s56, s62, 15
    s_add_u32 s33, s33, 262144
    s_sub_u32 s34, s33, s56
    s_add_u32 s33, s33, s56
    s_add_u32 s34, s34, 0x8000
    s_lshl_b32 s35, s3, 12
    s_mul_i32 s56, s63, 229376
    s_add_u32 s35, s35, 20971520
    s_add_u32 s35, s35, s56
    s_mul_i32 s56, s62, 114688
    s_sub_u32 s36, s35, s56
    s_add_u32 s35, s35, s56
    s_add_u32 s36, s36, 114688
    s_lshl_b32 s37, s64, 13
    s_add_u32 s37, s37, s12
    s_mul_i32 s56, s62, 114688
    s_add_u32 s37, s37, s77
    s_add_u32 s37, s37, 524288
    s_sub_u32 s38, s37, s56
    s_add_u32 s37, s37, s56
    s_add_u32 s38, s38, 114688
    s_lshl_b32 s39, s64, 9
    s_lshl_b32 s56, s3, 7
    s_add_u32 s39, s39, s77
    s_add_u32 s39, s39, s56
    s_lshl_b32 s56, s62, 13
    s_add_u32 s39, s39, 1015808
    s_sub_u32 s61, s39, s56
    s_add_u32 s39, s39, s56
    s_add_u32 s61, s61, 8192
    s_cmp_eq_u32 s54, 3
    s_cbranch_scc1 L_noflag
    s_cmp_eq_u32 s54, 2
    s_cbranch_scc1 L_c2
    s_cmp_eq_u32 s54, 0
    s_cbranch_scc1 L_c0
    s_waitcnt vmcnt(1)
    buffer_load_dwordx2 v[230:231], off, s[44:47], 0 sc1
    v_lshlrev_b32 v44, 16, v44
    v_mul_f32 v56, 0xbfb8aa3b, v44
    v_lshlrev_b32 v45, 16, v45
    v_mul_f32 v57, 0xbfb8aa3b, v45
    v_lshlrev_b32 v46, 16, v46
    v_mul_f32 v58, 0xbfb8aa3b, v46
    v_lshlrev_b32 v47, 16, v47
    v_mul_f32 v59, 0xbfb8aa3b, v47
    v_lshlrev_b32 v48, 16, v48
    v_mul_f32 v60, 0xbfb8aa3b, v48
    v_lshlrev_b32 v49, 16, v49
    v_mul_f32 v61, 0xbfb8aa3b, v49
    v_lshlrev_b32 v50, 16, v50
    v_mul_f32 v62, 0xbfb8aa3b, v50
    v_exp_f32 v56, v56
    v_exp_f32 v57, v57
    v_exp_f32 v58, v58
    v_exp_f32 v59, v59
    v_exp_f32 v60, v60
    v_exp_f32 v61, v61
    v_exp_f32 v62, v62
    v_add_f32 v56, 1.0, v56
    v_add_f32 v57, 1.0, v57
    v_add_f32 v58, 1.0, v58
    v_add_f32 v59, 1.0, v59
    v_add_f32 v60, 1.0, v60
    v_add_f32 v61, 1.0, v61
    v_add_f32 v62, 1.0, v62
    v_rcp_f32 v56, v56
    v_rcp_f32 v57, v57
    v_rcp_f32 v58, v58
    v_rcp_f32 v59, v59
    v_rcp_f32 v60, v60
    v_rcp_f32 v61, v61
    v_rcp_f32 v62, v62
    v_mul_f32 v44, v44, v56
    v_mul_f32 v45, v45, v57
    v_mul_f32 v46, v46, v58
    v_mul_f32 v47, v47, v59
    v_mul_f32 v48, v48, v60
    v_mul_f32 v49, v49, v61
    v_mul_f32 v50, v50, v62
    v_cvt_pk_bf16_f32 v44, v44, 0
    v_cvt_pk_bf16_f32 v45, v45, 0
    v_cvt_pk_bf16_f32 v46, v46, 0
    v_cvt_pk_bf16_f32 v47, v47, 0
    v_cvt_pk_bf16_f32 v48, v48, 0
    v_cvt_pk_bf16_f32 v49, v49, 0
    v_cvt_pk_bf16_f32 v50, v50, 0
    v_lshlrev_b32 v56, 16, v44
    v_lshlrev_b32 v57, 16, v45
    v_lshlrev_b32 v58, 16, v46
    v_lshlrev_b32 v59, 16, v47
    v_lshlrev_b32 v60, 16, v48
    v_lshlrev_b32 v61, 16, v49
    v_lshlrev_b32 v62, 16, v50
    v_dot2c_f32_bf16 v64, v16, v44
    v_dot2c_f32_bf16 v65, v16, v56
    v_dot2c_f32_bf16 v66, v17, v44
    v_dot2c_f32_bf16 v67, v17, v56
    v_dot2c_f32_bf16 v68, v18, v44
    v_dot2c_f32_bf16 v69, v18, v56
    v_dot2c_f32_bf16 v70, v19, v44
    v_dot2c_f32_bf16 v71, v19, v56
    v_dot2c_f32_bf16 v64, v20, v45
    v_dot2c_f32_bf16 v65, v20, v57
    v_dot2c_f32_bf16 v66, v21, v45
    v_dot2c_f32_bf16 v67, v21, v57
    v_dot2c_f32_bf16 v68, v22, v45
    v_dot2c_f32_bf16 v69, v22, v57
    v_dot2c_f32_bf16 v70, v23, v45
    v_dot2c_f32_bf16 v71, v23, v57
    v_dot2c_f32_bf16 v64, v24, v46
    v_dot2c_f32_bf16 v65, v24, v58
    v_dot2c_f32_bf16 v66, v25, v46
    v_dot2c_f32_bf16 v67, v25, v58
    v_dot2c_f32_bf16 v68, v26, v46
    v_dot2c_f32_bf16 v69, v26, v58
    v_dot2c_f32_bf16 v70, v27, v46
    v_dot2c_f32_bf16 v71, v27, v58
    v_dot2c_f32_bf16 v64, v28, v47
    v_dot2c_f32_bf16 v65, v28, v59
    v_dot2c_f32_bf16 v66, v29, v47
    v_dot2c_f32_bf16 v67, v29, v59
    v_dot2c_f32_bf16 v68, v30, v47
    v_dot2c_f32_bf16 v69, v30, v59
    v_dot2c_f32_bf16 v70, v31, v47
    v_dot2c_f32_bf16 v71, v31, v59
    v_dot2c_f32_bf16 v64, v32, v48
    v_dot2c_f32_bf16 v65, v32, v60
    v_dot2c_f32_bf16 v66, v33, v48
    v_dot2c_f32_bf16 v67, v33, v60
    v_dot2c_f32_bf16 v68, v34, v48
    v_dot2c_f32_bf16 v69, v34, v60
    v_dot2c_f32_bf16 v70, v35, v48
    v_dot2c_f32_bf16 v71, v35, v60
    v_dot2c_f32_bf16 v64, v36, v49
    v_dot2c_f32_bf16 v65, v36, v61
    v_dot2c_f32_bf16 v66, v37, v49
    v_dot2c_f32_bf16 v67, v37, v61
    v_dot2c_f32_bf16 v68, v38, v49
    v_dot2c_f32_bf16 v69, v38, v61
    v_dot2c_f32_bf16 v70, v39, v49
    v_dot2c_f32_bf16 v71, v39, v61
    v_dot2c_f32_bf16 v64, v40, v50
    v_dot2c_f32_bf16 v65, v40, v62
    v_dot2c_f32_bf16 v66, v41, v50
    v_dot2c_f32_bf16 v67, v41, v62
    v_dot2c_f32_bf16 v68, v42, v50
    v_dot2c_f32_bf16 v69, v42, v62
    v_dot2c_f32_bf16 v70, v43, v50
    v_dot2c_f32_bf16 v71, v43, v62
    v_permlane32_swap_b32 v64, v68
    v_permlane32_swap_b32 v65, v69
    v_permlane32_swap_b32 v66, v70
    v_permlane32_swap_b32 v67, v71
    v_add_f32 v64, v64, v68
    v_add_f32 v65, v65, v69
    v_add_f32 v66, v66, v70
    v_add_f32 v67, v67, v71
    v_add_f32_dpp v64, v64, v64 row_ror:8 row_mask:0xf bank_mask:0xf
    v_add_f32_dpp v65, v65, v65 row_ror:8 row_mask:0xf bank_mask:0xf
    v_add_f32_dpp v66, v66, v66 row_ror:8 row_mask:0xf bank_mask:0xf
    v_add_f32_dpp v67, v67, v67 row_ror:8 row_mask:0xf bank_mask:0xf
    v_mov_b32 v68, v64
    v_mov_b32 v69, v65
    v_mov_b32 v70, v66
    v_mov_b32 v71, v67
    v_permlane16_swap_b32 v64, v68
    v_permlane16_swap_b32 v65, v69
    v_permlane16_swap_b32 v66, v70
    v_permlane16_swap_b32 v67, v71
    v_add_f32 v64, v64, v68
    v_add_f32 v65, v65, v69
    v_add_f32 v66, v66, v70
    v_add_f32 v67, v67, v71
    s_waitcnt vmcnt(0)
    s_mov_b32 s54, 0
    s_branch L_tagchk_3
L_tag_1:
    buffer_load_dwordx2 v[230:231], off, s[44:47], 0 sc1
    s_waitcnt vmcnt(0)
L_tagchk_3:
    v_readfirstlane_b32 s52, v230
    v_readfirstlane_b32 s53, v231
    s_nop 0
    s_cmp_lg_u64 s[52:53], 0
    s_cbranch_scc1 L_tagok_2
    s_add_u32 s54, s54, 1
    s_cmp_lt_u32 s54, 16384
    s_cbranch_scc1 L_tag_1
L_tagok_2:
    s_mov_b32 s56, 0xff
    v_bfi_b32 v64, s56, v230, v64
    v_lshrrev_b32 v69, 8, v230
    v_bfi_b32 v65, s56, v69, v65
    v_lshrrev_b32 v70, 16, v230
    v_bfi_b32 v66, s56, v70, v66
    v_lshrrev_b32 v71, 24, v230
    v_bfi_b32 v67, s56, v71, v67
    s_mov_b32 exec_lo, 0xff
    s_mov_b32 exec_hi, 0xff
    buffer_store_dwordx4 v[64:67], v116, s[48:51], s79 offen sc1
    s_mov_b64 exec, -1
    s_branch L_noflag
L_c2:
    s_waitcnt vmcnt(2)
    ds_read_b64_tr_b16 v[16:17], v116 offset:0
    ds_read_b64_tr_b16 v[18:19], v116 offset:256
    ds_read_b64_tr_b16 v[20:21], v117 offset:0
    ds_read_b64_tr_b16 v[22:23], v117 offset:256
    ds_read_b64_tr_b16 v[24:25], v116 offset:2048
    ds_read_b64_tr_b16 v[26:27], v116 offset:2304
    ds_read_b64_tr_b16 v[28:29], v117 offset:2048
    ds_read_b64_tr_b16 v[30:31], v117 offset:2304
    ds_read_b64_tr_b16 v[32:33], v116 offset:4096
    ds_read_b64_tr_b16 v[34:35], v116 offset:4352
    ds_read_b64_tr_b16 v[36:37], v117 offset:4096
    ds_read_b64_tr_b16 v[38:39], v117 offset:4352
    s_waitcnt lgkmcnt(10)
    buffer_store_dwordx4 v[16:19], v7, s[48:51], s79 offen offset:0 sc1
    s_waitcnt lgkmcnt(8)
    buffer_store_dwordx4 v[20:23], v7, s[48:51], s79 offen offset:1024 sc1
    s_waitcnt lgkmcnt(6)
    buffer_store_dwordx4 v[24:27], v7, s[48:51], s79 offen offset:2048 sc1
    s_waitcnt lgkmcnt(4)
    buffer_store_dwordx4 v[28:31], v7, s[48:51], s79 offen offset:3072 sc1
    s_add_u32 s79, s79, 4096
    s_waitcnt lgkmcnt(2)
    buffer_store_dwordx4 v[32:35], v7, s[48:51], s79 offen offset:0 sc1
    s_waitcnt lgkmcnt(0)
    buffer_store_dwordx4 v[36:39], v7, s[48:51], s79 offen offset:1024 sc1
    buffer_load_dwordx2 v[230:231], off, s[44:47], 0 sc1
    s_branch L_pub
L_c0:
    v_mov_b32 v112, 0x3f803f80
    v_mov_b32 v104, 0
    v_mov_b32 v105, 0
    v_mov_b32 v106, 0
    v_mov_b32 v107, 0
    s_waitcnt vmcnt(7)
    v_dot2c_f32_bf16 v104, v16, v112
    v_dot2c_f32_bf16 v105, v16, v16
    v_dot2c_f32_bf16 v106, v17, v112
    v_dot2c_f32_bf16 v107, v17, v17
    v_dot2c_f32_bf16 v104, v18, v112
    v_dot2c_f32_bf16 v105, v18, v18
    v_dot2c_f32_bf16 v106, v19, v112
    v_dot2c_f32_bf16 v107, v19, v19
    v_lshlrev_b32 v48, 16, v16
    v_and_b32 v49, s55, v16
    v_lshlrev_b32 v50, 16, v17
    v_and_b32 v51, s55, v17
    v_lshlrev_b32 v52, 16, v18
    v_and_b32 v53, s55, v18
    v_lshlrev_b32 v54, 16, v19
    v_and_b32 v55, s55, v19
    s_waitcnt vmcnt(6)
    v_dot2c_f32_bf16 v104, v20, v112
    v_dot2c_f32_bf16 v105, v20, v20
    v_dot2c_f32_bf16 v106, v21, v112
    v_dot2c_f32_bf16 v107, v21, v21
    v_dot2c_f32_bf16 v104, v22, v112
    v_dot2c_f32_bf16 v105, v22, v22
    v_dot2c_f32_bf16 v106, v23, v112
    v_dot2c_f32_bf16 v107, v23, v23
    v_lshlrev_b32 v56, 16, v20
    v_and_b32 v57, s55, v20
    v_lshlrev_b32 v58, 16, v21
    v_and_b32 v59, s55, v21
    v_lshlrev_b32 v60, 16, v22
    v_and_b32 v61, s55, v22
    v_lshlrev_b32 v62, 16, v23
    v_and_b32 v63, s55, v23
    s_waitcnt vmcnt(5)
    v_dot2c_f32_bf16 v104, v24, v112
    v_dot2c_f32_bf16 v105, v24, v24
    v_dot2c_f32_bf16 v106, v25, v112
    v_dot2c_f32_bf16 v107, v25, v25
    v_dot2c_f32_bf16 v104, v26, v112
    v_dot2c_f32_bf16 v105, v26, v26
    v_dot2c_f32_bf16 v106, v27, v112
    v_dot2c_f32_bf16 v107, v27, v27
    v_lshlrev_b32 v64, 16, v24
    v_and_b32 v65, s55, v24
    v_lshlrev_b32 v66, 16, v25
    v_and_b32 v67, s55, v25
    v_lshlrev_b32 v68, 16, v26
    v_and_b32 v69, s55, v26
    v_lshlrev_b32 v70, 16, v27
    v_and_b32 v71, s55, v27
    s_waitcnt vmcnt(4)
    v_dot2c_f32_bf16 v104, v28, v112
    v_dot2c_f32_bf16 v105, v28, v28
    v_dot2c_f32_bf16 v106, v29, v112
    v_dot2c_f32_bf16 v107, v29, v29
    v_dot2c_f32_bf16 v104, v30, v112
    v_dot2c_f32_bf16 v105, v30, v30
    v_dot2c_f32_bf16 v106, v31, v112
    v_dot2c_f32_bf16 v107, v31, v31
    v_lshlrev_b32 v72, 16, v28
    v_and_b32 v73, s55, v28
    v_lshlrev_b32 v74, 16, v29
    v_and_b32 v75, s55, v29
    v_lshlrev_b32 v76, 16, v30
    v_and_b32 v77, s55, v30
    v_lshlrev_b32 v78, 16, v31
    v_and_b32 v79, s55, v31
    s_waitcnt vmcnt(3)
    v_dot2c_f32_bf16 v104, v32, v112
    v_dot2c_f32_bf16 v105, v32, v32
    v_dot2c_f32_bf16 v106, v33, v112
    v_dot2c_f32_bf16 v107, v33, v33
    v_dot2c_f32_bf16 v104, v34, v112
    v_dot2c_f32_bf16 v105, v34, v34
    v_dot2c_f32_bf16 v106, v35, v112
    v_dot2c_f32_bf16 v107, v35, v35
    v_lshlrev_b32 v80, 16, v32
    v_and_b32 v81, s55, v32
    v_lshlrev_b32 v82, 16, v33
    v_and_b32 v83, s55, v33
    v_lshlrev_b32 v84, 16, v34
    v_and_b32 v85, s55, v34
    v_lshlrev_b32 v86, 16, v35
    v_and_b32 v87, s55, v35
    s_waitcnt vmcnt(2)
    v_dot2c_f32_bf16 v104, v36, v112
    v_dot2c_f32_bf16 v105, v36, v36
    v_dot2c_f32_bf16 v106, v37, v112
    v_dot2c_f32_bf16 v107, v37, v37
    v_dot2c_f32_bf16 v104, v38, v112
    v_dot2c_f32_bf16 v105, v38, v38
    v_dot2c_f32_bf16 v106, v39, v112
    v_dot2c_f32_bf16 v107, v39, v39
    v_lshlrev_b32 v88, 16, v36
    v_and_b32 v89, s55, v36
    v_lshlrev_b32 v90, 16, v37
    v_and_b32 v91, s55, v37
    v_lshlrev_b32 v92, 16, v38
    v_and_b32 v93, s55, v38
    v_lshlrev_b32 v94, 16, v39
    v_and_b32 v95, s55, v39
    s_waitcnt vmcnt(1)
    buffer_load_dwordx2 v[230:231], off, s[44:47], 0 sc1
    v_dot2c_f32_bf16 v104, v40, v112
    v_dot2c_f32_bf16 v105, v40, v40
    v_dot2c_f32_bf16 v106, v41, v112
    v_dot2c_f32_bf16 v107, v41, v41
    v_dot2c_f32_bf16 v104, v42, v112
    v_dot2c_f32_bf16 v105, v42, v42
    v_dot2c_f32_bf16 v106, v43, v112
    v_dot2c_f32_bf16 v107, v43, v43
    v_lshlrev_b32 v96, 16, v40
    v_and_b32 v97, s55, v40
    v_lshlrev_b32 v98, 16, v41
    v_pk_add_f32 v[104:105], v[104:105], v[106:107]
    v_and_b32 v99, s55, v41
    v_lshlrev_b32 v100, 16, v42
    v_add_f32_dpp v104, v104, v104 row_ror:8 row_mask:0xf bank_mask:0xf
    v_add_f32_dpp v105, v105, v105 row_ror:8 row_mask:0xf bank_mask:0xf
    v_mov_b32 v106, v104
    v_mov_b32 v107, v105
    s_nop 0
    v_permlane16_swap_b32 v104, v106
    v_permlane16_swap_b32 v105, v107
    v_add_f32 v104, v104, v106
    v_add_f32 v105, v105, v107
    v_mov_b32 v106, v104
    v_mov_b32 v107, v105
    s_nop 0
    v_permlane32_swap_b32 v104, v106
    v_permlane32_swap_b32 v105, v107
    v_add_f32 v104, v104, v106
    v_add_f32 v105, v105, v107
    v_mul_f32 v104, 0xbb124925, v104
    v_mul_f32 v105, 0x3b124925, v105
    v_and_b32 v101, s55, v42
    v_fma_f32 v105, -v104, v104, v105
    v_lshlrev_b32 v102, 16, v43
    v_max_f32 v105, 0, v105
    v_and_b32 v103, s55, v43
    v_add_f32 v105, 0x3727c5ac, v105
    v_rsq_f32 v106, v105
    s_nop 0
    v_mul_f32 v104, v104, v106
    v_pk_fma_f32 v[48:49], v[48:49], v[106:107], v[104:105] op_sel_hi:[1,0,0]
    v_pk_fma_f32 v[50:51], v[50:51], v[106:107], v[104:105] op_sel_hi:[1,0,0]
    v_pk_fma_f32 v[52:53], v[52:53], v[106:107], v[104:105] op_sel_hi:[1,0,0]
    v_pk_fma_f32 v[54:55], v[54:55], v[106:107], v[104:105] op_sel_hi:[1,0,0]
    v_cvt_pk_f16_f32 v16, v48, v49
    v_cvt_pk_f16_f32 v17, v50, v51
    v_cvt_pk_f16_f32 v18, v52, v53
    v_cvt_pk_f16_f32 v19, v54, v55
    buffer_store_dwordx4 v[16:19], v116, s[48:51], s79 offen sc1
    s_add_u32 s79, s79, 2048
    v_pk_fma_f32 v[56:57], v[56:57], v[106:107], v[104:105] op_sel_hi:[1,0,0]
    v_pk_fma_f32 v[58:59], v[58:59], v[106:107], v[104:105] op_sel_hi:[1,0,0]
    v_pk_fma_f32 v[60:61], v[60:61], v[106:107], v[104:105] op_sel_hi:[1,0,0]
    v_pk_fma_f32 v[62:63], v[62:63], v[106:107], v[104:105] op_sel_hi:[1,0,0]
    v_cvt_pk_f16_f32 v20, v56, v57
    v_cvt_pk_f16_f32 v21, v58, v59
    v_cvt_pk_f16_f32 v22, v60, v61
    v_cvt_pk_f16_f32 v23, v62, v63
    buffer_store_dwordx4 v[20:23], v116, s[48:51], s79 offen sc1
    s_add_u32 s79, s79, 2048
    v_pk_fma_f32 v[64:65], v[64:65], v[106:107], v[104:105] op_sel_hi:[1,0,0]
    v_pk_fma_f32 v[66:67], v[66:67], v[106:107], v[104:105] op_sel_hi:[1,0,0]
    v_pk_fma_f32 v[68:69], v[68:69], v[106:107], v[104:105] op_sel_hi:[1,0,0]
    v_pk_fma_f32 v[70:71], v[70:71], v[106:107], v[104:105] op_sel_hi:[1,0,0]
    v_cvt_pk_f16_f32 v24, v64, v65
    v_cvt_pk_f16_f32 v25, v66, v67
    v_cvt_pk_f16_f32 v26, v68, v69
    v_cvt_pk_f16_f32 v27, v70, v71
    buffer_store_dwordx4 v[24:27], v116, s[48:51], s79 offen sc1
    s_add_u32 s79, s79, 2048
    v_pk_fma_f32 v[72:73], v[72:73], v[106:107], v[104:105] op_sel_hi:[1,0,0]
    v_pk_fma_f32 v[74:75], v[74:75], v[106:107], v[104:105] op_sel_hi:[1,0,0]
    v_pk_fma_f32 v[76:77], v[76:77], v[106:107], v[104:105] op_sel_hi:[1,0,0]
    v_pk_fma_f32 v[78:79], v[78:79], v[106:107], v[104:105] op_sel_hi:[1,0,0]
    v_cvt_pk_f16_f32 v28, v72, v73
    v_cvt_pk_f16_f32 v29, v74, v75
    v_cvt_pk_f16_f32 v30, v76, v77
    v_cvt_pk_f16_f32 v31, v78, v79
    buffer_store_dwordx4 v[28:31], v116, s[48:51], s79 offen sc1
    s_add_u32 s79, s79, 2048
    v_pk_fma_f32 v[80:81], v[80:81], v[106:107], v[104:105] op_sel_hi:[1,0,0]
    v_pk_fma_f32 v[82:83], v[82:83], v[106:107], v[104:105] op_sel_hi:[1,0,0]
    v_pk_fma_f32 v[84:85], v[84:85], v[106:107], v[104:105] op_sel_hi:[1,0,0]
    v_pk_fma_f32 v[86:87], v[86:87], v[106:107], v[104:105] op_sel_hi:[1,0,0]
    v_cvt_pk_f16_f32 v32, v80, v81
    v_cvt_pk_f16_f32 v33, v82, v83
    v_cvt_pk_f16_f32 v34, v84, v85
    v_cvt_pk_f16_f32 v35, v86, v87
    buffer_store_dwordx4 v[32:35], v116, s[48:51], s79 offen sc1
    s_add_u32 s79, s79, 2048
    v_pk_fma_f32 v[88:89], v[88:89], v[106:107], v[104:105] op_sel_hi:[1,0,0]
    v_pk_fma_f32 v[90:91], v[90:91], v[106:107], v[104:105] op_sel_hi:[1,0,0]
    v_pk_fma_f32 v[92:93], v[92:93], v[106:107], v[104:105] op_sel_hi:[1,0,0]
    v_pk_fma_f32 v[94:95], v[94:95], v[106:107], v[104:105] op_sel_hi:[1,0,0]
    v_cvt_pk_f16_f32 v36, v88, v89
    v_cvt_pk_f16_f32 v37, v90, v91
    v_cvt_pk_f16_f32 v38, v92, v93
    v_cvt_pk_f16_f32 v39, v94, v95
    buffer_store_dwordx4 v[36:39], v116, s[48:51], s79 offen sc1
    s_add_u32 s79, s79, 2048
    v_pk_fma_f32 v[96:97], v[96:97], v[106:107], v[104:105] op_sel_hi:[1,0,0]
    v_pk_fma_f32 v[98:99], v[98:99], v[106:107], v[104:105] op_sel_hi:[1,0,0]
    v_pk_fma_f32 v[100:101], v[100:101], v[106:107], v[104:105] op_sel_hi:[1,0,0]
    v_pk_fma_f32 v[102:103], v[102:103], v[106:107], v[104:105] op_sel_hi:[1,0,0]
    v_cvt_pk_f16_f32 v40, v96, v97
    v_cvt_pk_f16_f32 v41, v98, v99
    v_cvt_pk_f16_f32 v42, v100, v101
    v_cvt_pk_f16_f32 v43, v102, v103
    buffer_store_dwordx4 v[40:43], v116, s[48:51], s79 offen sc1
    s_add_u32 s79, s79, 2048
L_pub:
    s_waitcnt vmcnt(0)
    s_mov_b32 s54, 0
    s_branch L_tagchk_6
L_tag_4:
    buffer_load_dwordx2 v[230:231], off, s[44:47], 0 sc1
    s_waitcnt vmcnt(0)
L_tagchk_6:
    v_readfirstlane_b32 s52, v230
    v_readfirstlane_b32 s53, v231
    s_nop 0
    s_cmp_lg_u64 s[52:53], 0
    s_cbranch_scc1 L_tagok_5
    s_add_u32 s54, s54, 1
    s_cmp_lt_u32 s54, 16384
    s_cbranch_scc1 L_tag_4
L_tagok_5:
    s_mov_b64 exec, 0xffff
    buffer_store_dwordx2 v[230:231], v229, s[48:51], s6 offen sc1
    s_mov_b64 exec, -1
    ds_write_b64 v228, v[230:231]
L_noflag:
    s_waitcnt lgkmcnt(0)
    s_barrier
    ds_read_b64 v[230:231], v228
    s_mov_b32 s68, 15
L_wol:
    s_add_u32 m0, s70, s69
    s_mul_i32 s56, s69, 7
    s_add_u32 s56, s56, s71
    buffer_load_dwordx4 v232, s[16:19], s56 offen lds
    s_add_u32 s69, s69, 4096
    s_cmp_eq_u32 s69, 61440
    s_cselect_b32 s69, 0, s69
    s_sub_u32 s68, s68, 1
    s_cmp_lg_u32 s68, 0
    s_cbranch_scc1 L_wol
    s_waitcnt lgkmcnt(0)
    v_readfirstlane_b32 s52, v230
    v_readfirstlane_b32 s53, v231
    s_and_b32 s57, s3, 2
    s_lshl_b32 s56, s5, 7
    s_add_u32 s57, s57, s62
    s_add_u32 s18, s77, s56
    s_lshl_b32 s16, s57, 15
    s_add_u32 s18, s18, 1011712
    s_cmp_lg_u32 s3, 0
    s_cselect_b32 s18, 0x40000000, s18
    s_add_u32 s16, s16, s77
    s_lshl_b32 s56, s65, 11
    s_lshl_b32 s17, s57, 12
    s_add_u32 s16, s16, s56
    s_lshl_b32 s56, s65, 8
    s_add_u32 s16, s16, 262144
    s_add_u32 s17, s17, s77
    s_xor_b32 s19, s3, s62
    s_add_u32 s17, s17, s56
    s_lshl_b32 s19, s19, 12
    s_add_u32 s17, s17, 983040
    s_add_u32 s19, s19, s77
    s_add_u32 s19, s19, 983040
    v_mov_b32 v232, 0
    v_mov_b32 v233, 0
    v_lshlrev_b32 v228, 13, v5
    v_lshl_add_u32 v228, v4, 3, v228
    s_min_u32 s56, s39, s61
    buffer_store_dwordx2 v[232:233], v228, s[48:51], s56 offen sc1
    s_mov_b64 exec, 0xffff
    buffer_store_dwordx2 v[232:233], v229, s[48:51], s0 offen sc1
    buffer_store_dwordx2 v[232:233], v229, s[48:51], s18 offen sc1
    s_mov_b64 exec, -1
    v_mov_b32 v224, -1
    v_mov_b32 v225, -1
    v_mov_b32 v226, -1
    v_mov_b32 v227, -1
    buffer_store_dwordx4 v[224:227], v7, s[48:51], s1 offen offset:0 sc1
    buffer_store_dwordx4 v[224:227], v7, s[48:51], s1 offen offset:1024 sc1
    s_lshl_b32 s64, s4, 13
    s_lshl_b32 s56, s5, 9
    s_lshl_b32 s57, s3, 7
    s_add_u32 s64, s64, s56
    s_cmp_eq_u32 s63, 7
    s_cselect_b32 s56, 0x40000000, s16
    s_add_u32 s64, s64, s57
    buffer_store_dwordx4 v[224:227], v7, s[48:51], s56 offen offset:0 sc1
    buffer_store_dwordx4 v[224:227], v7, s[48:51], s56 offen offset:1024 sc1
    s_add_u32 s64, s64, 17039360
    s_mov_b64 exec, 0xffff
    buffer_store_dwordx4 v[224:227], v7, s[48:51], s17 offen sc1
    buffer_store_dwordx2 v[232:233], v229, s[48:51], s64 offen sc1
    s_mov_b64 exec, -1
    v_xor_b32 v13, 64, v252
    s_cmp_eq_u32 s3, 0
    s_cselect_b32 s57, 0, 0x40000000
    s_waitcnt vmcnt(9)
    s_barrier
    buffer_load_dwordx2 v[216:217], v234, s[48:51], s57 offen sc1
    ds_read_b64_tr_b16 a[128:129], v252 offset:0
    ds_read_b64_tr_b16 a[130:131], v252 offset:2048
    ds_read_b64_tr_b16 a[132:133], v13 offset:0
    ds_read_b64_tr_b16 a[134:135], v13 offset:2048
    ds_read_b64_tr_b16 a[136:137], v252 offset:1024
    ds_read_b64_tr_b16 a[138:139], v252 offset:3072
    ds_read_b64_tr_b16 a[140:141], v13 offset:1024
    ds_read_b64_tr_b16 a[142:143], v13 offset:3072
    ds_read_b64_tr_b16 a[144:145], v252 offset:3584
    ds_read_b64_tr_b16 a[146:147], v252 offset:5632
    ds_read_b64_tr_b16 a[148:149], v13 offset:3584
    ds_read_b64_tr_b16 a[150:151], v13 offset:5632
    ds_read_b64_tr_b16 a[152:153], v252 offset:4608
    ds_read_b64_tr_b16 a[154:155], v252 offset:6656
    ds_read_b64_tr_b16 a[156:157], v13 offset:4608
    ds_read_b64_tr_b16 a[158:159], v13 offset:6656
    ds_read_b64_tr_b16 a[160:161], v252 offset:7168
    ds_read_b64_tr_b16 a[162:163], v252 offset:9216
    ds_read_b64_tr_b16 a[164:165], v13 offset:7168
    ds_read_b64_tr_b16 a[166:167], v13 offset:9216
    ds_read_b64_tr_b16 a[168:169], v252 offset:8192
    ds_read_b64_tr_b16 a[170:171], v252 offset:10240
    ds_read_b64_tr_b16 a[172:173], v13 offset:8192
    ds_read_b64_tr_b16 a[174:175], v13 offset:10240
    ds_read_b64_tr_b16 a[176:177], v252 offset:10752
    ds_read_b64_tr_b16 a[178:179], v252 offset:12800
    ds_read_b64_tr_b16 a[180:181], v13 offset:10752
    ds_read_b64_tr_b16 a[182:183], v13 offset:12800
    ds_read_b64_tr_b16 a[184:185], v252 offset:11776
    ds_read_b64_tr_b16 a[186:187], v252 offset:13824
    ds_read_b64_tr_b16 a[188:189], v13 offset:11776
    ds_read_b64_tr_b16 a[190:191], v13 offset:13824
    ds_read_b64_tr_b16 a[192:193], v252 offset:14336
    ds_read_b64_tr_b16 a[194:195], v252 offset:16384
    ds_read_b64_tr_b16 a[196:197], v13 offset:14336
    ds_read_b64_tr_b16 a[198:199], v13 offset:16384
    ds_read_b64_tr_b16 a[200:201], v252 offset:15360
    ds_read_b64_tr_b16 a[202:203], v252 offset:17408
    ds_read_b64_tr_b16 a[204:205], v13 offset:15360
    ds_read_b64_tr_b16 a[206:207], v13 offset:17408
    ds_read_b64_tr_b16 a[208:209], v252 offset:17920
    ds_read_b64_tr_b16 a[210:211], v252 offset:19968
    ds_read_b64_tr_b16 a[212:213], v13 offset:17920
    ds_read_b64_tr_b16 a[214:215], v13 offset:19968
    ds_read_b64_tr_b16 a[216:217], v252 offset:18944
    ds_read_b64_tr_b16 a[218:219], v252 offset:20992
    ds_read_b64_tr_b16 a[220:221], v13 offset:18944
    ds_read_b64_tr_b16 a[222:223], v13 offset:20992
    ds_read_b64_tr_b16 a[224:225], v252 offset:21504
    ds_read_b64_tr_b16 a[226:227], v252 offset:23552
    ds_read_b64_tr_b16 a[228:229], v13 offset:21504
    ds_read_b64_tr_b16 a[230:231], v13 offset:23552
    ds_read_b64_tr_b16 a[232:233], v252 offset:22528
    ds_read_b64_tr_b16 a[234:235], v252 offset:24576
    ds_read_b64_tr_b16 a[236:237], v13 offset:22528
    ds_read_b64_tr_b16 a[238:239], v13 offset:24576
    ds_read_b64_tr_b16 a[240:241], v252 offset:25088
    ds_read_b64_tr_b16 a[242:243], v252 offset:27136
    ds_read_b64_tr_b16 a[244:245], v13 offset:25088
    ds_read_b64_tr_b16 a[246:247], v13 offset:27136
    ds_read_b64_tr_b16 a[248:249], v252 offset:26112
    ds_read_b64_tr_b16 a[250:251], v252 offset:28160
    ds_read_b64_tr_b16 a[252:253], v13 offset:26112
    ds_read_b64_tr_b16 a[254:255], v13 offset:28160
    s_waitcnt vmcnt(0)
    s_cmp_eq_u32 s3, 0
    s_cbranch_scc0 L_barA2
    v_cmp_ne_u64 vcc, s[52:53], v[216:217]
    s_cbranch_vccz L_barA2
    s_mov_b32 s54, 0
L_poll_7:
    buffer_load_dwordx2 v[216:217], v234, s[48:51], 0 offen sc1
    s_waitcnt vmcnt(0)
    v_cmp_ne_u64 vcc, s[52:53], v[216:217]
    s_cbranch_vccz L_pdone_8
    s_add_u32 s54, s54, 1
    s_cmp_lt_u32 s54, 16384
    s_cbranch_scc1 L_poll_7
    s_waitcnt vmcnt(0)
    v_mov_b32 v216, 1
    buffer_store_dword v216, off, s[44:47], 0 offset:16
    s_waitcnt vmcnt(0)
L_pdone_8:
L_barA2:
    s_barrier
    s_mov_b32 s56, 16777216
    buffer_load_dwordx4 v[192:195], v235, s[48:51], s56 offen offset:0 sc1
    s_add_u32 s56, s56, 10752
    buffer_load_dwordx4 v[196:199], v235, s[48:51], s56 offen offset:0 sc1
    s_add_u32 s56, s56, 10752
    buffer_load_dwordx4 v[200:203], v235, s[48:51], s56 offen offset:0 sc1
    s_add_u32 s56, s56, 10752
    buffer_load_dwordx4 v[204:207], v235, s[48:51], s56 offen offset:0 sc1
    s_add_u32 s56, s56, 10752
    buffer_load_dwordx4 v[208:211], v235, s[48:51], s56 offen offset:0 sc1
    s_add_u32 s56, s56, 10752
    buffer_load_dwordx4 v[212:215], v235, s[48:51], s56 offen offset:0 sc1
    s_add_u32 s56, s56, 10752
    buffer_load_dwordx4 v[216:219], v235, s[48:51], s56 offen offset:0 sc1
    s_add_u32 s56, s56, 10752
    buffer_load_dwordx4 v[220:223], v235, s[48:51], s56 offen offset:0 sc1
    s_bfe_u32 s68, s52, 524288
    s_bfe_u32 s69, s52, 524296
    s_bfe_u32 s70, s52, 524304
    s_bfe_u32 s71, s52, 524312
    s_mov_b32 m0, s76
    s_nop 0
    buffer_load_dwordx4 v7, s[48:51], s75 offen offset:0 sc1 lds
    buffer_load_dwordx4 v7, s[48:51], s75 offen offset:1024 sc1 lds
    buffer_load_dwordx4 v7, s[48:51], s75 offen offset:2048 sc1 lds
    s_add_u32 s75, s75, 12288
    s_add_u32 s76, s76, 12288
    buffer_load_dwordx4 v[16:19], v7, s[48:51], s72 offen offset:0 sc1
    buffer_load_dwordx4 v[20:23], v7, s[48:51], s73 offen offset:0 sc1
    buffer_load_dwordx4 v[24:27], v7, s[48:51], s72 offen offset:1024 sc1
    buffer_load_dwordx4 v[28:31], v7, s[48:51], s73 offen offset:1024 sc1
    v_lshrrev_b32 v252, 2, v0
    v_xor_b32 v13, v0, v5
    v_mul_u32_u24 v252, 896, v252
    v_and_b32 v13, 3, v13
    v_lshl_add_u32 v252, v13, 4, v252
    s_mov_b32 s54, 0
L_gc_9:
    s_waitcnt vmcnt(14)
    v_xor_b32 v192, s68, v192
    v_xor_b32 v193, s69, v193
    v_xor_b32 v194, s70, v194
    v_xor_b32 v195, s71, v195
    s_waitcnt vmcnt(13)
    v_xor_b32 v196, s68, v196
    v_xor_b32 v197, s69, v197
    v_xor_b32 v198, s70, v198
    v_xor_b32 v199, s71, v199
    v_or_b32 v224, v192, v196
    v_or_b32 v225, v193, v197
    v_or_b32 v226, v194, v198
    v_or_b32 v227, v195, v199
    v_pk_add_f32 v[192:193], v[192:193], v[196:197]
    v_pk_add_f32 v[194:195], v[194:195], v[198:199]
    s_waitcnt vmcnt(12)
    v_xor_b32 v200, s68, v200
    v_xor_b32 v201, s69, v201
    v_xor_b32 v202, s70, v202
    v_xor_b32 v203, s71, v203
    s_waitcnt vmcnt(11)
    v_xor_b32 v204, s68, v204
    v_xor_b32 v205, s69, v205
    v_xor_b32 v206, s70, v206
    v_xor_b32 v207, s71, v207
    v_or3_b32 v224, v224, v200, v204
    v_or3_b32 v225, v225, v201, v205
    v_or3_b32 v226, v226, v202, v206
    v_or3_b32 v227, v227, v203, v207
    v_pk_add_f32 v[200:201], v[200:201], v[204:205]
    v_pk_add_f32 v[202:203], v[202:203], v[206:207]
    s_waitcnt vmcnt(10)
    v_xor_b32 v208, s68, v208
    v_xor_b32 v209, s69, v209
    v_xor_b32 v210, s70, v210
    v_xor_b32 v211, s71, v211
    s_waitcnt vmcnt(9)
    v_xor_b32 v212, s68, v212
    v_xor_b32 v213, s69, v213
    v_xor_b32 v214, s70, v214
    v_xor_b32 v215, s71, v215
    v_or3_b32 v224, v224, v208, v212
    v_or3_b32 v225, v225, v209, v213
    v_or3_b32 v226, v226, v210, v214
    v_or3_b32 v227, v227, v211, v215
    v_pk_add_f32 v[208:209], v[208:209], v[212:213]
    v_pk_add_f32 v[210:211], v[210:211], v[214:215]
    s_waitcnt vmcnt(8)
    v_xor_b32 v216, s68, v216
    v_xor_b32 v217, s69, v217
    v_xor_b32 v218, s70, v218
    v_xor_b32 v219, s71, v219
    s_waitcnt vmcnt(7)
    v_xor_b32 v220, s68, v220
    v_xor_b32 v221, s69, v221
    v_xor_b32 v222, s70, v222
    v_xor_b32 v223, s71, v223
    v_or3_b32 v224, v224, v216, v220
    v_or3_b32 v225, v225, v217, v221
    v_or3_b32 v226, v226, v218, v222
    v_or3_b32 v227, v227, v219, v223
    v_pk_add_f32 v[216:217], v[216:217], v[220:221]
    v_pk_add_f32 v[218:219], v[218:219], v[222:223]
    v_or_b32 v224, v224, v225
    v_pk_add_f32 v[192:193], v[192:193], v[200:201]
    v_pk_add_f32 v[194:195], v[194:195], v[202:203]
    v_pk_add_f32 v[208:209], v[208:209], v[216:217]
    v_pk_add_f32 v[210:211], v[210:211], v[218:219]
    v_or3_b32 v224, v224, v226, v227
    v_pk_add_f32 v[192:193], v[192:193], v[208:209]
    v_pk_add_f32 v[194:195], v[194:195], v[210:211]
    v_and_b32 v224, 0xff, v224
    v_cmp_ne_u32 vcc, 0, v224
    s_cbranch_vccz L_gok_10
    s_mov_b32 s56, 16777216
    buffer_load_dwordx4 v[192:195], v235, s[48:51], s56 offen offset:0 sc1
    s_add_u32 s56, s56, 10752
    buffer_load_dwordx4 v[196:199], v235, s[48:51], s56 offen offset:0 sc1
    s_add_u32 s56, s56, 10752
    buffer_load_dwordx4 v[200:203], v235, s[48:51], s56 offen offset:0 sc1
    s_add_u32 s56, s56, 10752
    buffer_load_dwordx4 v[204:207], v235, s[48:51], s56 offen offset:0 sc1
    s_add_u32 s56, s56, 10752
    buffer_load_dwordx4 v[208:211], v235, s[48:51], s56 offen offset:0 sc1
    s_add_u32 s56, s56, 10752
    buffer_load_dwordx4 v[212:215], v235, s[48:51], s56 offen offset:0 sc1
    s_add_u32 s56, s56, 10752
    buffer_load_dwordx4 v[216:219], v235, s[48:51], s56 offen offset:0 sc1
    s_add_u32 s56, s56, 10752
    buffer_load_dwordx4 v[220:223], v235, s[48:51], s56 offen offset:0 sc1
    s_waitcnt vmcnt(0)
    s_add_u32 s54, s54, 1
    s_cmp_lt_u32 s54, 16384
    s_cbranch_scc1 L_gc_9
    v_mov_b32 v224, 2
    buffer_store_dword v224, off, s[44:47], 0 offset:16
    s_waitcnt vmcnt(0)
L_gok_10:
    v_cvt_pk_bf16_f32 v196, v192, v193
    v_cvt_pk_bf16_f32 v197, v194, v195
    v_lshlrev_b32 v192, 16, v196
    v_and_b32 v193, s55, v196
    v_lshlrev_b32 v194, 16, v197
    v_and_b32 v195, s55, v197
    v_or_b32 v200, s68, v192
    v_or_b32 v201, s69, v193
    v_or_b32 v202, s70, v194
    v_or_b32 v203, s71, v195
    v_add_f32 v192, v192, v239
    v_add_f32 v193, v193, v239
    v_add_f32 v194, v194, v239
    v_add_f32 v195, v195, v239
    v_cvt_pk_bf16_f32 v196, v192, v193
    v_cvt_pk_bf16_f32 v197, v194, v195
    v_lshlrev_b32 v192, 16, v196
    v_and_b32 v193, s55, v196
    v_lshlrev_b32 v194, 16, v197
    v_and_b32 v195, s55, v197
    v_cndmask_b32 v192, 0, v192, s[66:67]
    v_cndmask_b32 v193, 0, v193, s[66:67]
    v_cndmask_b32 v194, 0, v194, s[66:67]
    v_cndmask_b32 v195, 0, v195, s[66:67]
    ds_write_b128 v238, v[192:195]
    s_lshl_b32 s79, s4, 13
    s_andn2_b64 exec, exec, s[66:67]
    s_add_u32 s79, s79, 16904704
    s_cbranch_execz L_nopub
    buffer_store_dwordx4 v[200:203], v235, s[48:51], s79 offen sc1
L_nopub:
    s_mov_b64 exec, -1
    s_mov_b32 m0, s76
    s_nop 0
    buffer_load_dwordx4 v7, s[48:51], s75 offen offset:0 sc1 lds
    buffer_load_dwordx4 v7, s[48:51], s75 offen offset:1024 sc1 lds
    buffer_load_dwordx4 v7, s[48:51], s75 offen offset:2048 sc1 lds
    s_add_u32 s75, s75, 12288
    s_add_u32 s76, s76, 12288
    buffer_load_dwordx4 v[32:35], v7, s[48:51], s72 offen offset:2048 sc1
    buffer_load_dwordx4 v[36:39], v7, s[48:51], s73 offen offset:2048 sc1
    buffer_load_dwordx4 v[40:43], v7, s[48:51], s72 offen offset:3072 sc1
    buffer_load_dwordx4 v[44:47], v7, s[48:51], s73 offen offset:3072 sc1
    s_add_u32 s72, s72, 4096
    s_add_u32 s73, s73, 4096
    s_waitcnt lgkmcnt(0)
    s_waitcnt vmcnt(11)
    s_barrier
    ds_read_b128 v[192:195], v12 offset:0
    ds_read_b128 v[196:199], v12 offset:16
    ds_read_b128 v[200:203], v12 offset:32
    ds_read_b128 v[204:207], v12 offset:48
    ds_read_b128 a[24:27], v8 offset:2048
    ds_read_b128 a[28:31], v8 offset:3072
    ds_read_b128 a[32:35], v8 offset:4096
    ds_read_b128 a[36:39], v8 offset:5120
    ds_read_b128 a[16:19], v8 offset:0
    ds_read_b128 a[20:23], v8 offset:1024
    ds_read_b128 v[208:211], v12 offset:256
    ds_read_b128 v[212:215], v12 offset:272
    ds_read_b128 v[216:219], v12 offset:288
    ds_read_b128 v[220:223], v12 offset:304
    s_waitcnt vmcnt(10) lgkmcnt(11)
    v_fma_mix_f32 v224, v16, v192, v200 op_sel:[0,0,0] op_sel_hi:[1,0,0]
    v_fma_mix_f32 v225, v16, v193, v201 op_sel:[1,0,0] op_sel_hi:[1,0,0]
    v_fma_mix_f32 v226, v17, v194, v202 op_sel:[0,0,0] op_sel_hi:[1,0,0]
    v_fma_mix_f32 v227, v17, v195, v203 op_sel:[1,0,0] op_sel_hi:[1,0,0]
    s_waitcnt lgkmcnt(10)
    v_fma_mix_f32 v228, v18, v196, v204 op_sel:[0,0,0] op_sel_hi:[1,0,0]
    v_fma_mix_f32 v229, v18, v197, v205 op_sel:[1,0,0] op_sel_hi:[1,0,0]
    v_fma_mix_f32 v230, v19, v198, v206 op_sel:[0,0,0] op_sel_hi:[1,0,0]
    v_fma_mix_f32 v231, v19, v199, v207 op_sel:[1,0,0] op_sel_hi:[1,0,0]
    v_cvt_pk_bf16_f32 v16, v224, v225
    v_cvt_pk_bf16_f32 v17, v226, v227
    v_cvt_pk_bf16_f32 v18, v228, v229
    v_cvt_pk_bf16_f32 v19, v230, v231
    s_waitcnt vmcnt(9)
    v_fma_mix_f32 v232, v20, v192, v200 op_sel:[0,0,0] op_sel_hi:[1,0,0]
    v_fma_mix_f32 v233, v20, v193, v201 op_sel:[1,0,0] op_sel_hi:[1,0,0]
    v_fma_mix_f32 v234, v21, v194, v202 op_sel:[0,0,0] op_sel_hi:[1,0,0]
    v_fma_mix_f32 v235, v21, v195, v203 op_sel:[1,0,0] op_sel_hi:[1,0,0]
    v_fma_mix_f32 v236, v22, v196, v204 op_sel:[0,0,0] op_sel_hi:[1,0,0]
    v_fma_mix_f32 v237, v22, v197, v205 op_sel:[1,0,0] op_sel_hi:[1,0,0]
    v_fma_mix_f32 v238, v23, v198, v206 op_sel:[0,0,0] op_sel_hi:[1,0,0]
    v_fma_mix_f32 v239, v23, v199, v207 op_sel:[1,0,0] op_sel_hi:[1,0,0]
    v_cvt_pk_bf16_f32 v20, v232, v233
    v_cvt_pk_bf16_f32 v21, v234, v235
    v_cvt_pk_bf16_f32 v22, v236, v237
    v_cvt_pk_bf16_f32 v23, v238, v239
    s_waitcnt lgkmcnt(0)
    s_waitcnt vmcnt(7)
    v_mfma_f32_16x16x32_bf16 v[160:163], a[24:27], v[16:19], 0
    ds_read_b128 a[48:51], v8 offset:8192
    v_fma_mix_f32 v224, v24, v208, v216 op_sel:[0,0,0] op_sel_hi:[1,0,0]
    v_fma_mix_f32 v225, v24, v209, v217 op_sel:[1,0,0] op_sel_hi:[1,0,0]
    v_mfma_f32_16x16x32_bf16 v[164:167], a[28:31], v[16:19], 0
    s_mov_b32 m0, s76
    s_nop 0
    buffer_load_dwordx4 v7, s[48:51], s75 offen offset:0 sc1 lds
    ds_read_b128 a[52:55], v8 offset:9216
    v_fma_mix_f32 v226, v25, v210, v218 op_sel:[0,0,0] op_sel_hi:[1,0,0]
    v_fma_mix_f32 v227, v25, v211, v219 op_sel:[1,0,0] op_sel_hi:[1,0,0]
    v_mfma_f32_16x16x32_bf16 v[176:179], v[16:19], a[32:35], 0
    ds_read_b128 a[56:59], v8 offset:10240
    v_fma_mix_f32 v228, v26, v212, v220 op_sel:[0,0,0] op_sel_hi:[1,0,0]
    v_fma_mix_f32 v229, v26, v213, v221 op_sel:[1,0,0] op_sel_hi:[1,0,0]
    v_mfma_f32_16x16x32_bf16 v[180:183], v[16:19], a[36:39], 0
    buffer_load_dwordx4 v7, s[48:51], s75 offen offset:1024 sc1 lds
    ds_read_b128 a[60:63], v8 offset:11264
    v_fma_mix_f32 v230, v27, v214, v222 op_sel:[0,0,0] op_sel_hi:[1,0,0]
    v_fma_mix_f32 v231, v27, v215, v223 op_sel:[1,0,0] op_sel_hi:[1,0,0]
    v_mfma_f32_16x16x32_bf16 v[144:147], a[16:19], v[16:19], 0
    ds_read_b128 a[40:43], v8 offset:6144
    v_cvt_pk_bf16_f32 v24, v224, v225
    v_cvt_pk_bf16_f32 v25, v226, v227
    v_mfma_f32_16x16x32_bf16 v[148:151], a[20:23], v[16:19], 0
    buffer_load_dwordx4 v7, s[48:51], s75 offen offset:2048 sc1 lds
    s_add_u32 s75, s75, 12288
    s_add_u32 s76, s76, 12288
    ds_read_b128 a[44:47], v8 offset:7168
    v_cvt_pk_bf16_f32 v26, v228, v229
    v_cvt_pk_bf16_f32 v27, v230, v231
    v_mfma_f32_16x16x32_bf16 v[168:171], a[24:27], v[20:23], 0
    ds_read_b128 v[192:195], v12 offset:512
    v_fma_mix_f32 v232, v28, v208, v216 op_sel:[0,0,0] op_sel_hi:[1,0,0]
    v_fma_mix_f32 v233, v28, v209, v217 op_sel:[1,0,0] op_sel_hi:[1,0,0]
    v_mfma_f32_16x16x32_bf16 v[172:175], a[28:31], v[20:23], 0
    buffer_load_dwordx4 v[48:51], v7, s[48:51], s72 offen offset:0 sc1
    ds_read_b128 v[196:199], v12 offset:528
    v_fma_mix_f32 v234, v29, v210, v218 op_sel:[0,0,0] op_sel_hi:[1,0,0]
    v_fma_mix_f32 v235, v29, v211, v219 op_sel:[1,0,0] op_sel_hi:[1,0,0]
    v_mfma_f32_16x16x32_bf16 v[184:187], v[20:23], a[32:35], 0
    ds_read_b128 v[200:203], v12 offset:544
    v_fma_mix_f32 v236, v30, v212, v220 op_sel:[0,0,0] op_sel_hi:[1,0,0]
    v_fma_mix_f32 v237, v30, v213, v221 op_sel:[1,0,0] op_sel_hi:[1,0,0]
    v_mfma_f32_16x16x32_bf16 v[188:191], v[20:23], a[36:39], 0
    buffer_load_dwordx4 v[52:55], v7, s[48:51], s73 offen offset:0 sc1
    ds_read_b128 v[204:207], v12 offset:560
    v_fma_mix_f32 v238, v31, v214, v222 op_sel:[0,0,0] op_sel_hi:[1,0,0]
    v_fma_mix_f32 v239, v31, v215, v223 op_sel:[1,0,0] op_sel_hi:[1,0,0]
    v_mfma_f32_16x16x32_bf16 v[152:155], a[16:19], v[20:23], 0
    v_cvt_pk_bf16_f32 v28, v232, v233
    v_cvt_pk_bf16_f32 v29, v234, v235
    v_mfma_f32_16x16x32_bf16 v[156:159], a[20:23], v[20:23], 0
    v_cvt_pk_bf16_f32 v30, v236, v237
    v_cvt_pk_bf16_f32 v31, v238, v239
    s_waitcnt vmcnt(9)
    s_barrier
    s_waitcnt lgkmcnt(0)
    s_waitcnt vmcnt(7)
    v_mfma_f32_16x16x32_bf16 v[160:163], a[48:51], v[24:27], v[160:163]
    ds_read_b128 a[24:27], v8 offset:14336
    v_fma_mix_f32 v224, v32, v192, v200 op_sel:[0,0,0] op_sel_hi:[1,0,0]
    v_fma_mix_f32 v225, v32, v193, v201 op_sel:[1,0,0] op_sel_hi:[1,0,0]
    v_mfma_f32_16x16x32_bf16 v[164:167], a[52:55], v[24:27], v[164:167]
    buffer_load_dwordx4 v[56:59], v7, s[48:51], s72 offen offset:1024 sc1
    ds_read_b128 a[28:31], v8 offset:15360
    v_fma_mix_f32 v226, v33, v194, v202 op_sel:[0,0,0] op_sel_hi:[1,0,0]
    v_fma_mix_f32 v227, v33, v195, v203 op_sel:[1,0,0] op_sel_hi:[1,0,0]
    v_mfma_f32_16x16x32_bf16 v[176:179], v[24:27], a[56:59], v[176:179]
    ds_read_b128 a[32:35], v8 offset:16384
    v_fma_mix_f32 v228, v34, v196, v204 op_sel:[0,0,0] op_sel_hi:[1,0,0]
    v_fma_mix_f32 v229, v34, v197, v205 op_sel:[1,0,0] op_sel_hi:[1,0,0]
    v_mfma_f32_16x16x32_bf16 v[180:183], v[24:27], a[60:63], v[180:183]
    buffer_load_dwordx4 v[60:63], v7, s[48:51], s73 offen offset:1024 sc1
    ds_read_b128 a[36:39], v8 offset:17408
    v_fma_mix_f32 v230, v35, v198, v206 op_sel:[0,0,0] op_sel_hi:[1,0,0]
    v_fma_mix_f32 v231, v35, v199, v207 op_sel:[1,0,0] op_sel_hi:[1,0,0]
    v_mfma_f32_16x16x32_bf16 v[144:147], a[40:43], v[24:27], v[144:147]
    ds_read_b128 a[16:19], v8 offset:12288
    v_cvt_pk_bf16_f32 v32, v224, v225
    v_cvt_pk_bf16_f32 v33, v226, v227
    v_mfma_f32_16x16x32_bf16 v[148:151], a[44:47], v[24:27], v[148:151]
    s_mov_b32 m0, s76
    s_nop 0
    buffer_load_dwordx4 v7, s[48:51], s75 offen offset:0 sc1 lds
    ds_read_b128 a[20:23], v8 offset:13312
    v_cvt_pk_bf16_f32 v34, v228, v229
    v_cvt_pk_bf16_f32 v35, v230, v231
    v_mfma_f32_16x16x32_bf16 v[168:171], a[48:51], v[28:31], v[168:171]
    ds_read_b128 v[208:211], v12 offset:768
    v_fma_mix_f32 v232, v36, v192, v200 op_sel:[0,0,0] op_sel_hi:[1,0,0]
    v_fma_mix_f32 v233, v36, v193, v201 op_sel:[1,0,0] op_sel_hi:[1,0,0]
    v_mfma_f32_16x16x32_bf16 v[172:175], a[52:55], v[28:31], v[172:175]
    buffer_load_dwordx4 v7, s[48:51], s75 offen offset:1024 sc1 lds
    ds_read_b128 v[212:215], v12 offset:784
    v_fma_mix_f32 v234, v37, v194, v202 op_sel:[0,0,0] op_sel_hi:[1,0,0]
    v_fma_mix_f32 v235, v37, v195, v203 op_sel:[1,0,0] op_sel_hi:[1,0,0]
    v_mfma_f32_16x16x32_bf16 v[184:187], v[28:31], a[56:59], v[184:187]
    ds_read_b128 v[216:219], v12 offset:800
    v_fma_mix_f32 v236, v38, v196, v204 op_sel:[0,0,0] op_sel_hi:[1,0,0]
    v_fma_mix_f32 v237, v38, v197, v205 op_sel:[1,0,0] op_sel_hi:[1,0,0]
    v_mfma_f32_16x16x32_bf16 v[188:191], v[28:31], a[60:63], v[188:191]
    buffer_load_dwordx4 v7, s[48:51], s75 offen offset:2048 sc1 lds
    s_add_u32 s75, s75, 12288
    s_add_u32 s76, s76, 12288
    ds_read_b128 v[220:223], v12 offset:816
    v_fma_mix_f32 v238, v39, v198, v206 op_sel:[0,0,0] op_sel_hi:[1,0,0]
    v_fma_mix_f32 v239, v39, v199, v207 op_sel:[1,0,0] op_sel_hi:[1,0,0]
    v_mfma_f32_16x16x32_bf16 v[152:155], a[40:43], v[28:31], v[152:155]
    v_cvt_pk_bf16_f32 v36, v232, v233
    v_cvt_pk_bf16_f32 v37, v234, v235
    v_mfma_f32_16x16x32_bf16 v[156:159], a[44:47], v[28:31], v[156:159]
    v_cvt_pk_bf16_f32 v38, v236, v237
    v_cvt_pk_bf16_f32 v39, v238, v239
    s_waitcnt lgkmcnt(0)
    s_waitcnt vmcnt(10)
    v_mfma_f32_16x16x32_bf16 v[160:163], a[24:27], v[32:35], v[160:163]
    ds_read_b128 a[48:51], v8 offset:20480
    v_fma_mix_f32 v224, v40, v208, v216 op_sel:[0,0,0] op_sel_hi:[1,0,0]
    v_fma_mix_f32 v225, v40, v209, v217 op_sel:[1,0,0] op_sel_hi:[1,0,0]
    v_mfma_f32_16x16x32_bf16 v[164:167], a[28:31], v[32:35], v[164:167]
    buffer_load_dwordx4 v[64:67], v7, s[48:51], s72 offen offset:2048 sc1
    ds_read_b128 a[52:55], v8 offset:21504
    v_fma_mix_f32 v226, v41, v210, v218 op_sel:[0,0,0] op_sel_hi:[1,0,0]
    v_fma_mix_f32 v227, v41, v211, v219 op_sel:[1,0,0] op_sel_hi:[1,0,0]
    v_mfma_f32_16x16x32_bf16 v[176:179], v[32:35], a[32:35], v[176:179]
    ds_read_b128 a[56:59], v8 offset:22528
    v_fma_mix_f32 v228, v42, v212, v220 op_sel:[0,0,0] op_sel_hi:[1,0,0]
    v_fma_mix_f32 v229, v42, v213, v221 op_sel:[1,0,0] op_sel_hi:[1,0,0]
    v_mfma_f32_16x16x32_bf16 v[180:183], v[32:35], a[36:39], v[180:183]
    buffer_load_dwordx4 v[68:71], v7, s[48:51], s73 offen offset:2048 sc1
    ds_read_b128 a[60:63], v8 offset:23552
    v_fma_mix_f32 v230, v43, v214, v222 op_sel:[0,0,0] op_sel_hi:[1,0,0]
    v_fma_mix_f32 v231, v43, v215, v223 op_sel:[1,0,0] op_sel_hi:[1,0,0]
    v_mfma_f32_16x16x32_bf16 v[144:147], a[16:19], v[32:35], v[144:147]
    ds_read_b128 a[40:43], v8 offset:18432
    v_cvt_pk_bf16_f32 v40, v224, v225
    v_cvt_pk_bf16_f32 v41, v226, v227
    v_mfma_f32_16x16x32_bf16 v[148:151], a[20:23], v[32:35], v[148:151]
    buffer_load_dwordx4 v[72:75], v7, s[48:51], s72 offen offset:3072 sc1
    ds_read_b128 a[44:47], v8 offset:19456
    v_cvt_pk_bf16_f32 v42, v228, v229
    v_cvt_pk_bf16_f32 v43, v230, v231
    v_mfma_f32_16x16x32_bf16 v[168:171], a[24:27], v[36:39], v[168:171]
    ds_read_b128 v[192:195], v12 offset:1024
    v_fma_mix_f32 v232, v44, v208, v216 op_sel:[0,0,0] op_sel_hi:[1,0,0]
    v_fma_mix_f32 v233, v44, v209, v217 op_sel:[1,0,0] op_sel_hi:[1,0,0]
    v_mfma_f32_16x16x32_bf16 v[172:175], a[28:31], v[36:39], v[172:175]
    buffer_load_dwordx4 v[76:79], v7, s[48:51], s73 offen offset:3072 sc1
    s_add_u32 s72, s72, 4096
    s_add_u32 s73, s73, 4096
    ds_read_b128 v[196:199], v12 offset:1040
    v_fma_mix_f32 v234, v45, v210, v218 op_sel:[0,0,0] op_sel_hi:[1,0,0]
    v_fma_mix_f32 v235, v45, v211, v219 op_sel:[1,0,0] op_sel_hi:[1,0,0]
    v_mfma_f32_16x16x32_bf16 v[184:187], v[36:39], a[32:35], v[184:187]
    ds_read_b128 v[200:203], v12 offset:1056
    v_fma_mix_f32 v236, v46, v212, v220 op_sel:[0,0,0] op_sel_hi:[1,0,0]
    v_fma_mix_f32 v237, v46, v213, v221 op_sel:[1,0,0] op_sel_hi:[1,0,0]
    v_mfma_f32_16x16x32_bf16 v[188:191], v[36:39], a[36:39], v[188:191]
    buffer_load_dwordx4 v[128:131], v7, s[48:51], s74 offen sc1
    s_add_u32 s74, s74, 4096
    ds_read_b128 v[204:207], v12 offset:1072
    v_fma_mix_f32 v238, v47, v214, v222 op_sel:[0,0,0] op_sel_hi:[1,0,0]
    v_fma_mix_f32 v239, v47, v215, v223 op_sel:[1,0,0] op_sel_hi:[1,0,0]
    v_mfma_f32_16x16x32_bf16 v[152:155], a[16:19], v[36:39], v[152:155]
    v_cvt_pk_bf16_f32 v44, v232, v233
    v_cvt_pk_bf16_f32 v45, v234, v235
    v_mfma_f32_16x16x32_bf16 v[156:159], a[20:23], v[36:39], v[156:159]
    v_cvt_pk_bf16_f32 v46, v236, v237
    v_cvt_pk_bf16_f32 v47, v238, v239
    s_waitcnt vmcnt(12)
    s_barrier
    s_waitcnt lgkmcnt(0)
    s_waitcnt vmcnt(10)
    v_mfma_f32_16x16x32_bf16 v[160:163], a[48:51], v[40:43], v[160:163]
    ds_read_b128 a[24:27], v8 offset:26624
    v_fma_mix_f32 v224, v48, v192, v200 op_sel:[0,0,0] op_sel_hi:[1,0,0]
    v_fma_mix_f32 v225, v48, v193, v201 op_sel:[1,0,0] op_sel_hi:[1,0,0]
    v_mfma_f32_16x16x32_bf16 v[164:167], a[52:55], v[40:43], v[164:167]
    buffer_load_dwordx4 v[132:135], v7, s[48:51], s74 offen sc1
    s_add_u32 s74, s74, 4096
    ds_read_b128 a[28:31], v8 offset:27648
    v_fma_mix_f32 v226, v49, v194, v202 op_sel:[0,0,0] op_sel_hi:[1,0,0]
    v_fma_mix_f32 v227, v49, v195, v203 op_sel:[1,0,0] op_sel_hi:[1,0,0]
    v_mfma_f32_16x16x32_bf16 v[176:179], v[40:43], a[56:59], v[176:179]
    ds_read_b128 a[32:35], v8 offset:28672
    v_fma_mix_f32 v228, v50, v196, v204 op_sel:[0,0,0] op_sel_hi:[1,0,0]
    v_fma_mix_f32 v229, v50, v197, v205 op_sel:[1,0,0] op_sel_hi:[1,0,0]
    v_mfma_f32_16x16x32_bf16 v[180:183], v[40:43], a[60:63], v[180:183]
    s_mov_b32 m0, s76
    s_nop 0
    buffer_load_dwordx4 v7, s[48:51], s75 offen offset:0 sc1 lds
    ds_read_b128 a[36:39], v8 offset:29696
    v_fma_mix_f32 v230, v51, v198, v206 op_sel:[0,0,0] op_sel_hi:[1,0,0]
    v_fma_mix_f32 v231, v51, v199, v207 op_sel:[1,0,0] op_sel_hi:[1,0,0]
    v_mfma_f32_16x16x32_bf16 v[144:147], a[40:43], v[40:43], v[144:147]
    ds_read_b128 a[16:19], v8 offset:24576
    v_cvt_pk_bf16_f32 v48, v224, v225
    v_cvt_pk_bf16_f32 v49, v226, v227
    v_mfma_f32_16x16x32_bf16 v[148:151], a[44:47], v[40:43], v[148:151]
    buffer_load_dwordx4 v7, s[48:51], s75 offen offset:1024 sc1 lds
    ds_read_b128 a[20:23], v8 offset:25600
    v_cvt_pk_bf16_f32 v50, v228, v229
    v_cvt_pk_bf16_f32 v51, v230, v231
    v_mfma_f32_16x16x32_bf16 v[168:171], a[48:51], v[44:47], v[168:171]
    ds_read_b128 v[208:211], v12 offset:1280
    v_fma_mix_f32 v232, v52, v192, v200 op_sel:[0,0,0] op_sel_hi:[1,0,0]
    v_fma_mix_f32 v233, v52, v193, v201 op_sel:[1,0,0] op_sel_hi:[1,0,0]
    v_mfma_f32_16x16x32_bf16 v[172:175], a[52:55], v[44:47], v[172:175]
    buffer_load_dwordx4 v7, s[48:51], s75 offen offset:2048 sc1 lds
    s_add_u32 s75, s75, 12288
    s_add_u32 s76, s76, 12288
    ds_read_b128 v[212:215], v12 offset:1296
    v_fma_mix_f32 v234, v53, v194, v202 op_sel:[0,0,0] op_sel_hi:[1,0,0]
    v_fma_mix_f32 v235, v53, v195, v203 op_sel:[1,0,0] op_sel_hi:[1,0,0]
    v_mfma_f32_16x16x32_bf16 v[184:187], v[44:47], a[56:59], v[184:187]
    ds_read_b128 v[216:219], v12 offset:1312
    v_fma_mix_f32 v236, v54, v196, v204 op_sel:[0,0,0] op_sel_hi:[1,0,0]
    v_fma_mix_f32 v237, v54, v197, v205 op_sel:[1,0,0] op_sel_hi:[1,0,0]
    v_mfma_f32_16x16x32_bf16 v[188:191], v[44:47], a[60:63], v[188:191]
    buffer_load_dwordx4 v[80:83], v7, s[48:51], s72 offen offset:0 sc1
    ds_read_b128 v[220:223], v12 offset:1328
    v_fma_mix_f32 v238, v55, v198, v206 op_sel:[0,0,0] op_sel_hi:[1,0,0]
    v_fma_mix_f32 v239, v55, v199, v207 op_sel:[1,0,0] op_sel_hi:[1,0,0]
    v_mfma_f32_16x16x32_bf16 v[152:155], a[40:43], v[44:47], v[152:155]
    v_cvt_pk_bf16_f32 v52, v232, v233
    v_cvt_pk_bf16_f32 v53, v234, v235
    v_mfma_f32_16x16x32_bf16 v[156:159], a[44:47], v[44:47], v[156:159]
    v_cvt_pk_bf16_f32 v54, v236, v237
    v_cvt_pk_bf16_f32 v55, v238, v239
    s_waitcnt lgkmcnt(0)
    s_waitcnt vmcnt(13)
    v_mfma_f32_16x16x32_bf16 v[160:163], a[24:27], v[48:51], v[160:163]
    ds_read_b128 a[48:51], v8 offset:32768
    v_fma_mix_f32 v224, v56, v208, v216 op_sel:[0,0,0] op_sel_hi:[1,0,0]
    v_fma_mix_f32 v225, v56, v209, v217 op_sel:[1,0,0] op_sel_hi:[1,0,0]
    v_mfma_f32_16x16x32_bf16 v[164:167], a[28:31], v[48:51], v[164:167]
    buffer_load_dwordx4 v[84:87], v7, s[48:51], s73 offen offset:0 sc1
    ds_read_b128 a[52:55], v8 offset:33792
    v_fma_mix_f32 v226, v57, v210, v218 op_sel:[0,0,0] op_sel_hi:[1,0,0]
    v_fma_mix_f32 v227, v57, v211, v219 op_sel:[1,0,0] op_sel_hi:[1,0,0]
    v_mfma_f32_16x16x32_bf16 v[176:179], v[48:51], a[32:35], v[176:179]
    ds_read_b128 a[56:59], v8 offset:34816
    v_fma_mix_f32 v228, v58, v212, v220 op_sel:[0,0,0] op_sel_hi:[1,0,0]
    v_fma_mix_f32 v229, v58, v213, v221 op_sel:[1,0,0] op_sel_hi:[1,0,0]
    v_mfma_f32_16x16x32_bf16 v[180:183], v[48:51], a[36:39], v[180:183]
    buffer_load_dwordx4 v[88:91], v7, s[48:51], s72 offen offset:1024 sc1
    ds_read_b128 a[60:63], v8 offset:35840
    v_fma_mix_f32 v230, v59, v214, v222 op_sel:[0,0,0] op_sel_hi:[1,0,0]
    v_fma_mix_f32 v231, v59, v215, v223 op_sel:[1,0,0] op_sel_hi:[1,0,0]
    v_mfma_f32_16x16x32_bf16 v[144:147], a[16:19], v[48:51], v[144:147]
    ds_read_b128 a[40:43], v8 offset:30720
    v_cvt_pk_bf16_f32 v56, v224, v225
    v_cvt_pk_bf16_f32 v57, v226, v227
    v_mfma_f32_16x16x32_bf16 v[148:151], a[20:23], v[48:51], v[148:151]
    buffer_load_dwordx4 v[92:95], v7, s[48:51], s73 offen offset:1024 sc1
    ds_read_b128 a[44:47], v8 offset:31744
    v_cvt_pk_bf16_f32 v58, v228, v229
    v_cvt_pk_bf16_f32 v59, v230, v231
    v_mfma_f32_16x16x32_bf16 v[168:171], a[24:27], v[52:55], v[168:171]
    ds_read_b128 v[192:195], v12 offset:1536
    v_fma_mix_f32 v232, v60, v208, v216 op_sel:[0,0,0] op_sel_hi:[1,0,0]
    v_fma_mix_f32 v233, v60, v209, v217 op_sel:[1,0,0] op_sel_hi:[1,0,0]
    v_mfma_f32_16x16x32_bf16 v[172:175], a[28:31], v[52:55], v[172:175]
    buffer_load_dwordx4 v[136:139], v7, s[48:51], s74 offen sc1
    s_add_u32 s74, s74, 4096
    ds_read_b128 v[196:199], v12 offset:1552
    v_fma_mix_f32 v234, v61, v210, v218 op_sel:[0,0,0] op_sel_hi:[1,0,0]
    v_fma_mix_f32 v235, v61, v211, v219 op_sel:[1,0,0] op_sel_hi:[1,0,0]
    v_mfma_f32_16x16x32_bf16 v[184:187], v[52:55], a[32:35], v[184:187]
    ds_read_b128 v[200:203], v12 offset:1568
    v_fma_mix_f32 v236, v62, v212, v220 op_sel:[0,0,0] op_sel_hi:[1,0,0]
    v_fma_mix_f32 v237, v62, v213, v221 op_sel:[1,0,0] op_sel_hi:[1,0,0]
    v_mfma_f32_16x16x32_bf16 v[188:191], v[52:55], a[36:39], v[188:191]
    buffer_load_dwordx4 v[140:143], v7, s[48:51], s74 offen sc1
    s_add_u32 s74, s74, 4096
    ds_read_b128 v[204:207], v12 offset:1584
    v_fma_mix_f32 v238, v63, v214, v222 op_sel:[0,0,0] op_sel_hi:[1,0,0]
    v_fma_mix_f32 v239, v63, v215, v223 op_sel:[1,0,0] op_sel_hi:[1,0,0]
    v_mfma_f32_16x16x32_bf16 v[152:155], a[16:19], v[52:55], v[152:155]
    v_cvt_pk_bf16_f32 v60, v232, v233
    v_cvt_pk_bf16_f32 v61, v234, v235
    v_mfma_f32_16x16x32_bf16 v[156:159], a[20:23], v[52:55], v[156:159]
    v_cvt_pk_bf16_f32 v62, v236, v237
    v_cvt_pk_bf16_f32 v63, v238, v239
    s_waitcnt vmcnt(15)
    s_barrier
    s_waitcnt lgkmcnt(0)
    s_waitcnt vmcnt(13)
    v_mfma_f32_16x16x32_bf16 v[160:163], a[48:51], v[56:59], v[160:163]
    ds_read_b128 a[24:27], v8 offset:38912
    v_fma_mix_f32 v224, v64, v192, v200 op_sel:[0,0,0] op_sel_hi:[1,0,0]
    v_fma_mix_f32 v225, v64, v193, v201 op_sel:[1,0,0] op_sel_hi:[1,0,0]
    v_mfma_f32_16x16x32_bf16 v[164:167], a[52:55], v[56:59], v[164:167]
    s_mov_b32 m0, s76
    s_nop 0
    buffer_load_dwordx4 v7, s[48:51], s75 offen offset:0 sc1 lds
    ds_read_b128 a[28:31], v8 offset:39936
    v_fma_mix_f32 v226, v65, v194, v202 op_sel:[0,0,0] op_sel_hi:[1,0,0]
    v_fma_mix_f32 v227, v65, v195, v203 op_sel:[1,0,0] op_sel_hi:[1,0,0]
    v_mfma_f32_16x16x32_bf16 v[176:179], v[56:59], a[56:59], v[176:179]
    ds_read_b128 a[32:35], v8 offset:40960
    v_fma_mix_f32 v228, v66, v196, v204 op_sel:[0,0,0] op_sel_hi:[1,0,0]
    v_fma_mix_f32 v229, v66, v197, v205 op_sel:[1,0,0] op_sel_hi:[1,0,0]
    v_mfma_f32_16x16x32_bf16 v[180:183], v[56:59], a[60:63], v[180:183]
    buffer_load_dwordx4 v7, s[48:51], s75 offen offset:1024 sc1 lds
    ds_read_b128 a[36:39], v8 offset:41984
    v_fma_mix_f32 v230, v67, v198, v206 op_sel:[0,0,0] op_sel_hi:[1,0,0]
    v_fma_mix_f32 v231, v67, v199, v207 op_sel:[1,0,0] op_sel_hi:[1,0,0]
    v_mfma_f32_16x16x32_bf16 v[144:147], a[40:43], v[56:59], v[144:147]
    ds_read_b128 a[16:19], v8 offset:36864
    v_cvt_pk_bf16_f32 v64, v224, v225
    v_cvt_pk_bf16_f32 v65, v226, v227
    v_mfma_f32_16x16x32_bf16 v[148:151], a[44:47], v[56:59], v[148:151]
    buffer_load_dwordx4 v7, s[48:51], s75 offen offset:2048 sc1 lds
    s_add_u32 s75, s75, 12288
    s_add_u32 s76, s76, 12288
    ds_read_b128 a[20:23], v8 offset:37888
    v_cvt_pk_bf16_f32 v66, v228, v229
    v_cvt_pk_bf16_f32 v67, v230, v231
    v_mfma_f32_16x16x32_bf16 v[168:171], a[48:51], v[60:63], v[168:171]
    ds_read_b128 v[208:211], v12 offset:1792
    v_fma_mix_f32 v232, v68, v192, v200 op_sel:[0,0,0] op_sel_hi:[1,0,0]
    v_fma_mix_f32 v233, v68, v193, v201 op_sel:[1,0,0] op_sel_hi:[1,0,0]
    v_mfma_f32_16x16x32_bf16 v[172:175], a[52:55], v[60:63], v[172:175]
    buffer_load_dwordx4 v[96:99], v7, s[48:51], s72 offen offset:2048 sc1
    ds_read_b128 v[212:215], v12 offset:1808
    v_fma_mix_f32 v234, v69, v194, v202 op_sel:[0,0,0] op_sel_hi:[1,0,0]
    v_fma_mix_f32 v235, v69, v195, v203 op_sel:[1,0,0] op_sel_hi:[1,0,0]
    v_mfma_f32_16x16x32_bf16 v[184:187], v[60:63], a[56:59], v[184:187]
    ds_read_b128 v[216:219], v12 offset:1824
    v_fma_mix_f32 v236, v70, v196, v204 op_sel:[0,0,0] op_sel_hi:[1,0,0]
    v_fma_mix_f32 v237, v70, v197, v205 op_sel:[1,0,0] op_sel_hi:[1,0,0]
    v_mfma_f32_16x16x32_bf16 v[188:191], v[60:63], a[60:63], v[188:191]
    buffer_load_dwordx4 v[100:103], v7, s[48:51], s73 offen offset:2048 sc1
    ds_read_b128 v[220:223], v12 offset:1840
    v_fma_mix_f32 v238, v71, v198, v206 op_sel:[0,0,0] op_sel_hi:[1,0,0]
    v_fma_mix_f32 v239, v71, v199, v207 op_sel:[1,0,0] op_sel_hi:[1,0,0]
    v_mfma_f32_16x16x32_bf16 v[152:155], a[40:43], v[60:63], v[152:155]
    v_cvt_pk_bf16_f32 v68, v232, v233
    v_cvt_pk_bf16_f32 v69, v234, v235
    v_mfma_f32_16x16x32_bf16 v[156:159], a[44:47], v[60:63], v[156:159]
    v_cvt_pk_bf16_f32 v70, v236, v237
    v_cvt_pk_bf16_f32 v71, v238, v239
    s_waitcnt lgkmcnt(0)
    s_waitcnt vmcnt(16)
    v_mfma_f32_16x16x32_bf16 v[160:163], a[24:27], v[64:67], v[160:163]
    ds_read_b128 a[48:51], v8 offset:45056
    v_fma_mix_f32 v224, v72, v208, v216 op_sel:[0,0,0] op_sel_hi:[1,0,0]
    v_fma_mix_f32 v225, v72, v209, v217 op_sel:[1,0,0] op_sel_hi:[1,0,0]
    v_mfma_f32_16x16x32_bf16 v[164:167], a[28:31], v[64:67], v[164:167]
    buffer_load_dwordx4 v[104:107], v7, s[48:51], s72 offen offset:3072 sc1
    ds_read_b128 a[52:55], v8 offset:46080
    v_fma_mix_f32 v226, v73, v210, v218 op_sel:[0,0,0] op_sel_hi:[1,0,0]
    v_fma_mix_f32 v227, v73, v211, v219 op_sel:[1,0,0] op_sel_hi:[1,0,0]
    v_mfma_f32_16x16x32_bf16 v[176:179], v[64:67], a[32:35], v[176:179]
    ds_read_b128 a[56:59], v8 offset:47104
    v_fma_mix_f32 v228, v74, v212, v220 op_sel:[0,0,0] op_sel_hi:[1,0,0]
    v_fma_mix_f32 v229, v74, v213, v221 op_sel:[1,0,0] op_sel_hi:[1,0,0]
    v_mfma_f32_16x16x32_bf16 v[180:183], v[64:67], a[36:39], v[180:183]
    buffer_load_dwordx4 v[108:111], v7, s[48:51], s73 offen offset:3072 sc1
    s_add_u32 s72, s72, 4096
    s_add_u32 s73, s73, 4096
    ds_read_b128 a[60:63], v8 offset:48128
    v_fma_mix_f32 v230, v75, v214, v222 op_sel:[0,0,0] op_sel_hi:[1,0,0]
    v_fma_mix_f32 v231, v75, v215, v223 op_sel:[1,0,0] op_sel_hi:[1,0,0]
    v_mfma_f32_16x16x32_bf16 v[144:147], a[16:19], v[64:67], v[144:147]
    ds_read_b128 a[40:43], v8 offset:43008
    v_cvt_pk_bf16_f32 v72, v224, v225
    v_cvt_pk_bf16_f32 v73, v226, v227
    v_mfma_f32_16x16x32_bf16 v[148:151], a[20:23], v[64:67], v[148:151]
    s_mov_b32 m0, s76
    s_nop 0
    buffer_load_dwordx4 v7, s[48:51], s75 offen offset:0 sc1 lds
    ds_read_b128 a[44:47], v8 offset:44032
    v_cvt_pk_bf16_f32 v74, v228, v229
    v_cvt_pk_bf16_f32 v75, v230, v231
    v_mfma_f32_16x16x32_bf16 v[168:171], a[24:27], v[68:71], v[168:171]
    ds_read_b128 v[192:195], v12 offset:2048
    v_fma_mix_f32 v232, v76, v208, v216 op_sel:[0,0,0] op_sel_hi:[1,0,0]
    v_fma_mix_f32 v233, v76, v209, v217 op_sel:[1,0,0] op_sel_hi:[1,0,0]
    v_mfma_f32_16x16x32_bf16 v[172:175], a[28:31], v[68:71], v[172:175]
    buffer_load_dwordx4 v7, s[48:51], s75 offen offset:1024 sc1 lds
    ds_read_b128 v[196:199], v12 offset:2064
    v_fma_mix_f32 v234, v77, v210, v218 op_sel:[0,0,0] op_sel_hi:[1,0,0]
    v_fma_mix_f32 v235, v77, v211, v219 op_sel:[1,0,0] op_sel_hi:[1,0,0]
    v_mfma_f32_16x16x32_bf16 v[184:187], v[68:71], a[32:35], v[184:187]
    ds_read_b128 v[200:203], v12 offset:2080
    v_fma_mix_f32 v236, v78, v212, v220 op_sel:[0,0,0] op_sel_hi:[1,0,0]
    v_fma_mix_f32 v237, v78, v213, v221 op_sel:[1,0,0] op_sel_hi:[1,0,0]
    v_mfma_f32_16x16x32_bf16 v[188:191], v[68:71], a[36:39], v[188:191]
    buffer_load_dwordx4 v7, s[48:51], s75 offen offset:2048 sc1 lds
    s_add_u32 s75, s75, 12288
    s_add_u32 s76, s76, 12288
    ds_read_b128 v[204:207], v12 offset:2096
    v_fma_mix_f32 v238, v79, v214, v222 op_sel:[0,0,0] op_sel_hi:[1,0,0]
    v_fma_mix_f32 v239, v79, v215, v223 op_sel:[1,0,0] op_sel_hi:[1,0,0]
    v_mfma_f32_16x16x32_bf16 v[152:155], a[16:19], v[68:71], v[152:155]
    v_cvt_pk_bf16_f32 v76, v232, v233
    v_cvt_pk_bf16_f32 v77, v234, v235
    v_mfma_f32_16x16x32_bf16 v[156:159], a[20:23], v[68:71], v[156:159]
    v_cvt_pk_bf16_f32 v78, v236, v237
    v_cvt_pk_bf16_f32 v79, v238, v239
    s_waitcnt vmcnt(16)
    s_barrier
    s_waitcnt lgkmcnt(0)
    s_waitcnt vmcnt(14)
    v_mfma_f32_16x16x32_bf16 v[160:163], a[48:51], v[72:75], v[160:163]
    ds_read_b128 a[24:27], v9 offset:2048
    ds_read_b128 a[28:31], v9 offset:3072
    v_fma_mix_f32 v224, v80, v192, v200 op_sel:[0,0,0] op_sel_hi:[1,0,0]
    v_fma_mix_f32 v225, v80, v193, v201 op_sel:[1,0,0] op_sel_hi:[1,0,0]
    v_mfma_f32_16x16x32_bf16 v[164:167], a[52:55], v[72:75], v[164:167]
    buffer_load_dwordx4 v[112:115], v7, s[48:51], s72 offen offset:0 sc1
    ds_read_b128 a[32:35], v9 offset:4096
    ds_read_b128 a[36:39], v9 offset:5120
    v_fma_mix_f32 v226, v81, v194, v202 op_sel:[0,0,0] op_sel_hi:[1,0,0]
    v_fma_mix_f32 v227, v81, v195, v203 op_sel:[1,0,0] op_sel_hi:[1,0,0]
    v_mfma_f32_16x16x32_bf16 v[176:179], v[72:75], a[56:59], v[176:179]
    ds_read_b128 a[16:19], v9 offset:0
    v_fma_mix_f32 v228, v82, v196, v204 op_sel:[0,0,0] op_sel_hi:[1,0,0]
    v_fma_mix_f32 v229, v82, v197, v205 op_sel:[1,0,0] op_sel_hi:[1,0,0]
    v_mfma_f32_16x16x32_bf16 v[180:183], v[72:75], a[60:63], v[180:183]
    buffer_load_dwordx4 v[116:119], v7, s[48:51], s73 offen offset:0 sc1
    ds_read_b128 a[20:23], v9 offset:1024
    ds_read_b128 v[208:211], v12 offset:2304
    v_fma_mix_f32 v230, v83, v198, v206 op_sel:[0,0,0] op_sel_hi:[1,0,0]
    v_fma_mix_f32 v231, v83, v199, v207 op_sel:[1,0,0] op_sel_hi:[1,0,0]
    v_mfma_f32_16x16x32_bf16 v[144:147], a[40:43], v[72:75], v[144:147]
    ds_read_b128 v[212:215], v12 offset:2320
    v_cvt_pk_bf16_f32 v80, v224, v225
    v_cvt_pk_bf16_f32 v81, v226, v227
    v_mfma_f32_16x16x32_bf16 v[148:151], a[44:47], v[72:75], v[148:151]
    buffer_load_dwordx4 v[120:123], v7, s[48:51], s72 offen offset:1024 sc1
    ds_read_b128 v[216:219], v12 offset:2336
    ds_read_b128 v[220:223], v12 offset:2352
    v_cvt_pk_bf16_f32 v82, v228, v229
    v_cvt_pk_bf16_f32 v83, v230, v231
    v_mfma_f32_16x16x32_bf16 v[168:171], a[48:51], v[76:79], v[168:171]
    ds_read_b128 v[16:19], v6 offset:0
    v_fma_mix_f32 v232, v84, v192, v200 op_sel:[0,0,0] op_sel_hi:[1,0,0]
    v_fma_mix_f32 v233, v84, v193, v201 op_sel:[1,0,0] op_sel_hi:[1,0,0]
    v_mfma_f32_16x16x32_bf16 v[172:175], a[52:55], v[76:79], v[172:175]
    buffer_load_dwordx4 v[124:127], v7, s[48:51], s73 offen offset:1024 sc1
    ds_read_b128 v[20:23], v6 offset:16
    ds_read_b128 v[24:27], v6 offset:32
    v_fma_mix_f32 v234, v85, v194, v202 op_sel:[0,0,0] op_sel_hi:[1,0,0]
    v_fma_mix_f32 v235, v85, v195, v203 op_sel:[1,0,0] op_sel_hi:[1,0,0]
    v_mfma_f32_16x16x32_bf16 v[184:187], v[76:79], a[56:59], v[184:187]
    ds_read_b128 v[28:31], v6 offset:48
    v_fma_mix_f32 v236, v86, v196, v204 op_sel:[0,0,0] op_sel_hi:[1,0,0]
    v_fma_mix_f32 v237, v86, v197, v205 op_sel:[1,0,0] op_sel_hi:[1,0,0]
    v_mfma_f32_16x16x32_bf16 v[188:191], v[76:79], a[60:63], v[188:191]
    buffer_load_dword v255, v253, s[24:27], 0 offen
    ds_read_b128 a[64:67], v10 offset:2048
    ds_read_b128 a[68:71], v10 offset:3072
    v_fma_mix_f32 v238, v87, v198, v206 op_sel:[0,0,0] op_sel_hi:[1,0,0]
    v_fma_mix_f32 v239, v87, v199, v207 op_sel:[1,0,0] op_sel_hi:[1,0,0]
    v_mfma_f32_16x16x32_bf16 v[152:155], a[40:43], v[76:79], v[152:155]
    ds_read_b128 a[72:75], v10 offset:4096
    v_cvt_pk_bf16_f32 v84, v232, v233
    v_cvt_pk_bf16_f32 v85, v234, v235
    v_mfma_f32_16x16x32_bf16 v[156:159], a[44:47], v[76:79], v[156:159]
    ds_read_b128 a[76:79], v10 offset:5120
    v_cvt_pk_bf16_f32 v86, v236, v237
    v_cvt_pk_bf16_f32 v87, v238, v239
    s_waitcnt lgkmcnt(0)
    s_waitcnt vmcnt(17)
    v_mfma_f32_16x16x32_bf16 v[160:163], a[24:27], v[80:83], v[160:163]
    ds_read_b128 a[48:51], v9 offset:8192
    ds_read_b128 a[52:55], v9 offset:9216
    v_fma_mix_f32 v224, v88, v208, v216 op_sel:[0,0,0] op_sel_hi:[1,0,0]
    v_fma_mix_f32 v225, v88, v209, v217 op_sel:[1,0,0] op_sel_hi:[1,0,0]
    v_fma_mix_f32 v226, v89, v210, v218 op_sel:[0,0,0] op_sel_hi:[1,0,0]
    v_mfma_f32_16x16x32_bf16 v[164:167], a[28:31], v[80:83], v[164:167]
    buffer_load_dword v255, v253, s[20:23], 0 offen
    ds_read_b128 a[56:59], v9 offset:10240
    ds_read_b128 a[60:63], v9 offset:11264
    v_fma_mix_f32 v227, v89, v211, v219 op_sel:[1,0,0] op_sel_hi:[1,0,0]
    v_fma_mix_f32 v228, v90, v212, v220 op_sel:[0,0,0] op_sel_hi:[1,0,0]
    v_fma_mix_f32 v229, v90, v213, v221 op_sel:[1,0,0] op_sel_hi:[1,0,0]
    v_mfma_f32_16x16x32_bf16 v[176:179], v[80:83], a[32:35], v[176:179]
    ds_read_b128 a[40:43], v9 offset:6144
    v_fma_mix_f32 v230, v91, v214, v222 op_sel:[0,0,0] op_sel_hi:[1,0,0]
    v_fma_mix_f32 v231, v91, v215, v223 op_sel:[1,0,0] op_sel_hi:[1,0,0]
    v_cvt_pk_bf16_f32 v88, v224, v225
    v_mfma_f32_16x16x32_bf16 v[180:183], v[80:83], a[36:39], v[180:183]
    ds_read_b128 a[44:47], v9 offset:7168
    ds_read_b128 v[192:195], v12 offset:2560
    v_cvt_pk_bf16_f32 v89, v226, v227
    v_cvt_pk_bf16_f32 v90, v228, v229
    v_cvt_pk_bf16_f32 v91, v230, v231
    v_mfma_f32_16x16x32_bf16 v[144:147], a[16:19], v[80:83], v[144:147]
    ds_read_b128 v[196:199], v12 offset:2576
    v_fma_mix_f32 v232, v92, v208, v216 op_sel:[0,0,0] op_sel_hi:[1,0,0]
    v_fma_mix_f32 v233, v92, v209, v217 op_sel:[1,0,0] op_sel_hi:[1,0,0]
    v_fma_mix_f32 v234, v93, v210, v218 op_sel:[0,0,0] op_sel_hi:[1,0,0]
    v_mfma_f32_16x16x32_bf16 v[148:151], a[20:23], v[80:83], v[148:151]
    ds_read_b128 v[200:203], v12 offset:2592
    ds_read_b128 v[204:207], v12 offset:2608
    v_fma_mix_f32 v235, v93, v211, v219 op_sel:[1,0,0] op_sel_hi:[1,0,0]
    v_fma_mix_f32 v236, v94, v212, v220 op_sel:[0,0,0] op_sel_hi:[1,0,0]
    v_fma_mix_f32 v237, v94, v213, v221 op_sel:[1,0,0] op_sel_hi:[1,0,0]
    v_mfma_f32_16x16x32_bf16 v[168:171], a[24:27], v[84:87], v[168:171]
    ds_read_b128 v[32:35], v6 offset:1024
    v_fma_mix_f32 v238, v95, v214, v222 op_sel:[0,0,0] op_sel_hi:[1,0,0]
    v_fma_mix_f32 v239, v95, v215, v223 op_sel:[1,0,0] op_sel_hi:[1,0,0]
    v_cvt_pk_bf16_f32 v92, v232, v233
    v_mfma_f32_16x16x32_bf16 v[172:175], a[28:31], v[84:87], v[172:175]
    ds_read_b128 v[36:39], v6 offset:1040
    ds_read_b128 v[40:43], v6 offset:1056
    v_cvt_pk_bf16_f32 v93, v234, v235
    v_cvt_pk_bf16_f32 v94, v236, v237
    v_cvt_pk_bf16_f32 v95, v238, v239
    v_mfma_f32_16x16x32_bf16 v[184:187], v[84:87], a[32:35], v[184:187]
    ds_read_b128 v[44:47], v6 offset:1072
    v_fma_mix_f32 v48, v128, v16, v24 op_sel:[0,0,0] op_sel_hi:[1,0,0]
    v_fma_mix_f32 v49, v128, v17, v25 op_sel:[1,0,0] op_sel_hi:[1,0,0]
    v_fma_mix_f32 v50, v129, v18, v26 op_sel:[0,0,0] op_sel_hi:[1,0,0]
    v_mfma_f32_16x16x32_bf16 v[188:191], v[84:87], a[36:39], v[188:191]
    ds_read_b128 a[80:83], v10 offset:26624
    ds_read_b128 a[84:87], v10 offset:27648
    v_fma_mix_f32 v51, v129, v19, v27 op_sel:[1,0,0] op_sel_hi:[1,0,0]
    v_fma_mix_f32 v52, v130, v20, v28 op_sel:[0,0,0] op_sel_hi:[1,0,0]
    v_fma_mix_f32 v53, v130, v21, v29 op_sel:[1,0,0] op_sel_hi:[1,0,0]
    v_mfma_f32_16x16x32_bf16 v[152:155], a[16:19], v[84:87], v[152:155]
    ds_read_b128 a[88:91], v10 offset:28672
    v_fma_mix_f32 v54, v131, v22, v30 op_sel:[0,0,0] op_sel_hi:[1,0,0]
    v_fma_mix_f32 v55, v131, v23, v31 op_sel:[1,0,0] op_sel_hi:[1,0,0]
    v_cvt_pk_bf16_f32 v128, v48, v49
    v_mfma_f32_16x16x32_bf16 v[156:159], a[20:23], v[84:87], v[156:159]
    ds_read_b128 a[92:95], v10 offset:29696
    v_cvt_pk_bf16_f32 v129, v50, v51
    v_cvt_pk_bf16_f32 v130, v52, v53
    v_cvt_pk_bf16_f32 v131, v54, v55
    s_waitcnt vmcnt(13)
    s_barrier
    s_waitcnt lgkmcnt(0)
    s_waitcnt vmcnt(11)
    v_mfma_f32_16x16x32_bf16 a[0:3], a[64:67], v[128:131], 0
    ds_read_b128 a[24:27], v9 offset:14336
    ds_read_b128 a[28:31], v9 offset:15360
    v_fma_mix_f32 v224, v96, v192, v200 op_sel:[0,0,0] op_sel_hi:[1,0,0]
    v_fma_mix_f32 v225, v96, v193, v201 op_sel:[1,0,0] op_sel_hi:[1,0,0]
    v_fma_mix_f32 v226, v97, v194, v202 op_sel:[0,0,0] op_sel_hi:[1,0,0]
    v_mfma_f32_16x16x32_bf16 a[8:11], v[128:131], a[72:75], 0
    ds_read_b128 a[32:35], v9 offset:16384
    v_fma_mix_f32 v227, v97, v195, v203 op_sel:[1,0,0] op_sel_hi:[1,0,0]
    v_fma_mix_f32 v228, v98, v196, v204 op_sel:[0,0,0] op_sel_hi:[1,0,0]
    v_mfma_f32_16x16x32_bf16 a[4:7], a[68:71], v[128:131], 0
    ds_read_b128 a[36:39], v9 offset:17408
    v_fma_mix_f32 v229, v98, v197, v205 op_sel:[1,0,0] op_sel_hi:[1,0,0]
    v_fma_mix_f32 v230, v99, v198, v206 op_sel:[0,0,0] op_sel_hi:[1,0,0]
    v_mfma_f32_16x16x32_bf16 a[12:15], v[128:131], a[76:79], 0
    ds_read_b128 a[16:19], v9 offset:12288
    v_fma_mix_f32 v231, v99, v199, v207 op_sel:[1,0,0] op_sel_hi:[1,0,0]
    v_cvt_pk_bf16_f32 v96, v224, v225
    v_mfma_f32_16x16x32_bf16 v[160:163], a[48:51], v[88:91], v[160:163]
    ds_read_b128 a[20:23], v9 offset:13312
    v_cvt_pk_bf16_f32 v97, v226, v227
    v_cvt_pk_bf16_f32 v98, v228, v229
    v_cvt_pk_bf16_f32 v99, v230, v231
    v_mfma_f32_16x16x32_bf16 v[164:167], a[52:55], v[88:91], v[164:167]
    ds_read_b128 v[208:211], v12 offset:2816
    v_fma_mix_f32 v232, v100, v192, v200 op_sel:[0,0,0] op_sel_hi:[1,0,0]
    v_fma_mix_f32 v233, v100, v193, v201 op_sel:[1,0,0] op_sel_hi:[1,0,0]
    v_mfma_f32_16x16x32_bf16 v[176:179], v[88:91], a[56:59], v[176:179]
    ds_read_b128 v[212:215], v12 offset:2832
    v_fma_mix_f32 v234, v101, v194, v202 op_sel:[0,0,0] op_sel_hi:[1,0,0]
    v_fma_mix_f32 v235, v101, v195, v203 op_sel:[1,0,0] op_sel_hi:[1,0,0]
    v_mfma_f32_16x16x32_bf16 v[180:183], v[88:91], a[60:63], v[180:183]
    ds_read_b128 v[216:219], v12 offset:2848
    ds_read_b128 v[220:223], v12 offset:2864
    v_fma_mix_f32 v236, v102, v196, v204 op_sel:[0,0,0] op_sel_hi:[1,0,0]
    v_fma_mix_f32 v237, v102, v197, v205 op_sel:[1,0,0] op_sel_hi:[1,0,0]
    v_mfma_f32_16x16x32_bf16 v[144:147], a[40:43], v[88:91], v[144:147]
    ds_read_b128 v[16:19], v6 offset:2048
    v_fma_mix_f32 v238, v103, v198, v206 op_sel:[0,0,0] op_sel_hi:[1,0,0]
    v_fma_mix_f32 v239, v103, v199, v207 op_sel:[1,0,0] op_sel_hi:[1,0,0]
    v_cvt_pk_bf16_f32 v100, v232, v233
    v_mfma_f32_16x16x32_bf16 v[148:151], a[44:47], v[88:91], v[148:151]
    ds_read_b128 v[20:23], v6 offset:2064
    v_cvt_pk_bf16_f32 v101, v234, v235
    v_cvt_pk_bf16_f32 v102, v236, v237
    v_mfma_f32_16x16x32_bf16 v[168:171], a[48:51], v[92:95], v[168:171]
    ds_read_b128 v[24:27], v6 offset:2080
    v_cvt_pk_bf16_f32 v103, v238, v239
    v_fma_mix_f32 v48, v132, v32, v40 op_sel:[0,0,0] op_sel_hi:[1,0,0]
    v_mfma_f32_16x16x32_bf16 v[172:175], a[52:55], v[92:95], v[172:175]
    ds_read_b128 v[28:31], v6 offset:2096
    v_fma_mix_f32 v49, v132, v33, v41 op_sel:[1,0,0] op_sel_hi:[1,0,0]
    v_fma_mix_f32 v50, v133, v34, v42 op_sel:[0,0,0] op_sel_hi:[1,0,0]
    v_mfma_f32_16x16x32_bf16 v[184:187], v[92:95], a[56:59], v[184:187]
    ds_read_b128 a[96:99], v11 offset:2048
    v_fma_mix_f32 v51, v133, v35, v43 op_sel:[1,0,0] op_sel_hi:[1,0,0]
    v_fma_mix_f32 v52, v134, v36, v44 op_sel:[0,0,0] op_sel_hi:[1,0,0]
    v_fma_mix_f32 v53, v134, v37, v45 op_sel:[1,0,0] op_sel_hi:[1,0,0]
    v_mfma_f32_16x16x32_bf16 v[188:191], v[92:95], a[60:63], v[188:191]
    ds_read_b128 a[100:103], v11 offset:3072
    v_fma_mix_f32 v54, v135, v38, v46 op_sel:[0,0,0] op_sel_hi:[1,0,0]
    v_fma_mix_f32 v55, v135, v39, v47 op_sel:[1,0,0] op_sel_hi:[1,0,0]
    v_mfma_f32_16x16x32_bf16 v[152:155], a[40:43], v[92:95], v[152:155]
    ds_read_b128 a[104:107], v11 offset:4096
    v_cvt_pk_bf16_f32 v132, v48, v49
    v_cvt_pk_bf16_f32 v133, v50, v51
    v_mfma_f32_16x16x32_bf16 v[156:159], a[44:47], v[92:95], v[156:159]
    ds_read_b128 a[108:111], v11 offset:5120
    v_cvt_pk_bf16_f32 v134, v52, v53
    v_cvt_pk_bf16_f32 v135, v54, v55
    s_waitcnt vmcnt(6)
    s_barrier
    s_waitcnt lgkmcnt(0)
    v_mfma_f32_16x16x32_bf16 a[0:3], a[80:83], v[132:135], a[0:3]
    ds_read_b128 a[48:51], v9 offset:20480
    ds_read_b128 a[52:55], v9 offset:21504
    v_fma_mix_f32 v224, v104, v208, v216 op_sel:[0,0,0] op_sel_hi:[1,0,0]
    v_fma_mix_f32 v225, v104, v209, v217 op_sel:[1,0,0] op_sel_hi:[1,0,0]
    v_fma_mix_f32 v226, v105, v210, v218 op_sel:[0,0,0] op_sel_hi:[1,0,0]
    v_mfma_f32_16x16x32_bf16 a[8:11], v[132:135], a[88:91], a[8:11]
    ds_read_b128 a[56:59], v9 offset:22528
    v_fma_mix_f32 v227, v105, v211, v219 op_sel:[1,0,0] op_sel_hi:[1,0,0]
    v_fma_mix_f32 v228, v106, v212, v220 op_sel:[0,0,0] op_sel_hi:[1,0,0]
    v_mfma_f32_16x16x32_bf16 a[4:7], a[84:87], v[132:135], a[4:7]
    ds_read_b128 a[60:63], v9 offset:23552
    v_fma_mix_f32 v229, v106, v213, v221 op_sel:[1,0,0] op_sel_hi:[1,0,0]
    v_fma_mix_f32 v230, v107, v214, v222 op_sel:[0,0,0] op_sel_hi:[1,0,0]
    v_mfma_f32_16x16x32_bf16 a[12:15], v[132:135], a[92:95], a[12:15]
    ds_read_b128 a[40:43], v9 offset:18432
    v_fma_mix_f32 v231, v107, v215, v223 op_sel:[1,0,0] op_sel_hi:[1,0,0]
    v_cvt_pk_bf16_f32 v104, v224, v225
    v_mfma_f32_16x16x32_bf16 v[160:163], a[24:27], v[96:99], v[160:163]
    ds_read_b128 a[44:47], v9 offset:19456
    v_cvt_pk_bf16_f32 v105, v226, v227
    v_cvt_pk_bf16_f32 v106, v228, v229
    v_cvt_pk_bf16_f32 v107, v230, v231
    v_mfma_f32_16x16x32_bf16 v[164:167], a[28:31], v[96:99], v[164:167]
    ds_read_b128 v[192:195], v12 offset:3072
    v_fma_mix_f32 v232, v108, v208, v216 op_sel:[0,0,0] op_sel_hi:[1,0,0]
    v_fma_mix_f32 v233, v108, v209, v217 op_sel:[1,0,0] op_sel_hi:[1,0,0]
    v_mfma_f32_16x16x32_bf16 v[176:179], v[96:99], a[32:35], v[176:179]
    ds_read_b128 v[196:199], v12 offset:3088
    v_fma_mix_f32 v234, v109, v210, v218 op_sel:[0,0,0] op_sel_hi:[1,0,0]
    v_fma_mix_f32 v235, v109, v211, v219 op_sel:[1,0,0] op_sel_hi:[1,0,0]
    v_mfma_f32_16x16x32_bf16 v[180:183], v[96:99], a[36:39], v[180:183]
    ds_read_b128 v[200:203], v12 offset:3104
    ds_read_b128 v[204:207], v12 offset:3120
    v_fma_mix_f32 v236, v110, v212, v220 op_sel:[0,0,0] op_sel_hi:[1,0,0]
    v_fma_mix_f32 v237, v110, v213, v221 op_sel:[1,0,0] op_sel_hi:[1,0,0]
    v_mfma_f32_16x16x32_bf16 v[144:147], a[16:19], v[96:99], v[144:147]
    ds_read_b128 v[32:35], v6 offset:3072
    v_fma_mix_f32 v238, v111, v214, v222 op_sel:[0,0,0] op_sel_hi:[1,0,0]
    v_fma_mix_f32 v239, v111, v215, v223 op_sel:[1,0,0] op_sel_hi:[1,0,0]
    v_cvt_pk_bf16_f32 v108, v232, v233
    v_mfma_f32_16x16x32_bf16 v[148:151], a[20:23], v[96:99], v[148:151]
    ds_read_b128 v[36:39], v6 offset:3088
    v_cvt_pk_bf16_f32 v109, v234, v235
    v_cvt_pk_bf16_f32 v110, v236, v237
    v_mfma_f32_16x16x32_bf16 v[168:171], a[24:27], v[100:103], v[168:171]
    ds_read_b128 v[40:43], v6 offset:3104
    v_cvt_pk_bf16_f32 v111, v238, v239
    v_fma_mix_f32 v48, v136, v16, v24 op_sel:[0,0,0] op_sel_hi:[1,0,0]
    v_mfma_f32_16x16x32_bf16 v[172:175], a[28:31], v[100:103], v[172:175]
    ds_read_b128 v[44:47], v6 offset:3120
    v_fma_mix_f32 v49, v136, v17, v25 op_sel:[1,0,0] op_sel_hi:[1,0,0]
    v_fma_mix_f32 v50, v137, v18, v26 op_sel:[0,0,0] op_sel_hi:[1,0,0]
    v_mfma_f32_16x16x32_bf16 v[184:187], v[100:103], a[32:35], v[184:187]
    ds_read_b128 a[112:115], v1 offset:2048
    v_fma_mix_f32 v51, v137, v19, v27 op_sel:[1,0,0] op_sel_hi:[1,0,0]
    v_fma_mix_f32 v52, v138, v20, v28 op_sel:[0,0,0] op_sel_hi:[1,0,0]
    v_fma_mix_f32 v53, v138, v21, v29 op_sel:[1,0,0] op_sel_hi:[1,0,0]
    v_mfma_f32_16x16x32_bf16 v[188:191], v[100:103], a[36:39], v[188:191]
    ds_read_b128 a[116:119], v1 offset:3072
    v_fma_mix_f32 v54, v139, v22, v30 op_sel:[0,0,0] op_sel_hi:[1,0,0]
    v_fma_mix_f32 v55, v139, v23, v31 op_sel:[1,0,0] op_sel_hi:[1,0,0]
    v_mfma_f32_16x16x32_bf16 v[152:155], a[16:19], v[100:103], v[152:155]
    ds_read_b128 a[120:123], v1 offset:4096
    v_cvt_pk_bf16_f32 v136, v48, v49
    v_cvt_pk_bf16_f32 v137, v50, v51
    v_mfma_f32_16x16x32_bf16 v[156:159], a[20:23], v[100:103], v[156:159]
    ds_read_b128 a[124:127], v1 offset:5120
    v_cvt_pk_bf16_f32 v138, v52, v53
    v_cvt_pk_bf16_f32 v139, v54, v55
    s_waitcnt lgkmcnt(0)
    s_waitcnt vmcnt(4)
    v_mfma_f32_16x16x32_bf16 a[0:3], a[96:99], v[136:139], a[0:3]
    ds_read_b128 a[24:27], v9 offset:26624
    v_fma_mix_f32 v224, v112, v192, v200 op_sel:[0,0,0] op_sel_hi:[1,0,0]
    v_fma_mix_f32 v225, v112, v193, v201 op_sel:[1,0,0] op_sel_hi:[1,0,0]
    v_fma_mix_f32 v226, v113, v194, v202 op_sel:[0,0,0] op_sel_hi:[1,0,0]
    v_mfma_f32_16x16x32_bf16 a[8:11], v[136:139], a[104:107], a[8:11]
    ds_read_b128 a[28:31], v9 offset:27648
    v_fma_mix_f32 v227, v113, v195, v203 op_sel:[1,0,0] op_sel_hi:[1,0,0]
    v_fma_mix_f32 v228, v114, v196, v204 op_sel:[0,0,0] op_sel_hi:[1,0,0]
    v_fma_mix_f32 v229, v114, v197, v205 op_sel:[1,0,0] op_sel_hi:[1,0,0]
    v_mfma_f32_16x16x32_bf16 a[4:7], a[100:103], v[136:139], a[4:7]
    ds_read_b128 a[32:35], v9 offset:28672
    v_fma_mix_f32 v230, v115, v198, v206 op_sel:[0,0,0] op_sel_hi:[1,0,0]
    v_fma_mix_f32 v231, v115, v199, v207 op_sel:[1,0,0] op_sel_hi:[1,0,0]
    v_cvt_pk_bf16_f32 v112, v224, v225
    v_mfma_f32_16x16x32_bf16 a[12:15], v[136:139], a[108:111], a[12:15]
    ds_read_b128 a[36:39], v9 offset:29696
    v_cvt_pk_bf16_f32 v113, v226, v227
    v_cvt_pk_bf16_f32 v114, v228, v229
    v_cvt_pk_bf16_f32 v115, v230, v231
    v_mfma_f32_16x16x32_bf16 v[160:163], a[48:51], v[104:107], v[160:163]
    ds_read_b128 a[16:19], v9 offset:24576
    v_fma_mix_f32 v232, v116, v192, v200 op_sel:[0,0,0] op_sel_hi:[1,0,0]
    v_fma_mix_f32 v233, v116, v193, v201 op_sel:[1,0,0] op_sel_hi:[1,0,0]
    v_fma_mix_f32 v234, v117, v194, v202 op_sel:[0,0,0] op_sel_hi:[1,0,0]
    v_mfma_f32_16x16x32_bf16 v[164:167], a[52:55], v[104:107], v[164:167]
    ds_read_b128 a[20:23], v9 offset:25600
    v_fma_mix_f32 v235, v117, v195, v203 op_sel:[1,0,0] op_sel_hi:[1,0,0]
    v_fma_mix_f32 v236, v118, v196, v204 op_sel:[0,0,0] op_sel_hi:[1,0,0]
    v_mfma_f32_16x16x32_bf16 v[176:179], v[104:107], a[56:59], v[176:179]
    ds_read_b128 v[208:211], v12 offset:3328
    v_fma_mix_f32 v237, v118, v197, v205 op_sel:[1,0,0] op_sel_hi:[1,0,0]
    v_fma_mix_f32 v238, v119, v198, v206 op_sel:[0,0,0] op_sel_hi:[1,0,0]
    v_fma_mix_f32 v239, v119, v199, v207 op_sel:[1,0,0] op_sel_hi:[1,0,0]
    v_mfma_f32_16x16x32_bf16 v[180:183], v[104:107], a[60:63], v[180:183]
    ds_read_b128 v[212:215], v12 offset:3344
    v_cvt_pk_bf16_f32 v116, v232, v233
    v_cvt_pk_bf16_f32 v117, v234, v235
    v_cvt_pk_bf16_f32 v118, v236, v237
    v_mfma_f32_16x16x32_bf16 v[144:147], a[40:43], v[104:107], v[144:147]
    ds_read_b128 v[216:219], v12 offset:3360
    v_cvt_pk_bf16_f32 v119, v238, v239
    v_fma_mix_f32 v48, v140, v32, v40 op_sel:[0,0,0] op_sel_hi:[1,0,0]
    v_fma_mix_f32 v49, v140, v33, v41 op_sel:[1,0,0] op_sel_hi:[1,0,0]
    v_mfma_f32_16x16x32_bf16 v[148:151], a[44:47], v[104:107], v[148:151]
    ds_read_b128 v[220:223], v12 offset:3376
    v_fma_mix_f32 v50, v141, v34, v42 op_sel:[0,0,0] op_sel_hi:[1,0,0]
    v_fma_mix_f32 v51, v141, v35, v43 op_sel:[1,0,0] op_sel_hi:[1,0,0]
    v_fma_mix_f32 v52, v142, v36, v44 op_sel:[0,0,0] op_sel_hi:[1,0,0]
    v_mfma_f32_16x16x32_bf16 v[168:171], a[48:51], v[108:111], v[168:171]
    v_fma_mix_f32 v53, v142, v37, v45 op_sel:[1,0,0] op_sel_hi:[1,0,0]
    v_fma_mix_f32 v54, v143, v38, v46 op_sel:[0,0,0] op_sel_hi:[1,0,0]
    v_mfma_f32_16x16x32_bf16 v[172:175], a[52:55], v[108:111], v[172:175]
    v_fma_mix_f32 v55, v143, v39, v47 op_sel:[1,0,0] op_sel_hi:[1,0,0]
    v_cvt_pk_bf16_f32 v140, v48, v49
    v_cvt_pk_bf16_f32 v141, v50, v51
    v_mfma_f32_16x16x32_bf16 v[184:187], v[108:111], a[56:59], v[184:187]
    v_cvt_pk_bf16_f32 v142, v52, v53
    v_cvt_pk_bf16_f32 v143, v54, v55
    s_lshl_b32 s56, s3, 12
    v_mfma_f32_16x16x32_bf16 v[188:191], v[108:111], a[60:63], v[188:191]
    s_cselect_b32 s56, s56, 32768
    v_add_u32 v62, s56, v7
    s_add_u32 s56, s3, 1
    v_mfma_f32_16x16x32_bf16 v[152:155], a[40:43], v[108:111], v[152:155]
    s_and_b32 s56, s56, 3
    s_lshl_b32 s56, s56, 12
    v_add_u32 v63, s56, v7
    v_mfma_f32_16x16x32_bf16 v[156:159], a[44:47], v[108:111], v[156:159]
    v_cmp_gt_u32 s[66:67], 48, v0
    v_add_u32 v14, s13, v7
    s_waitcnt lgkmcnt(0)
    s_waitcnt vmcnt(2)
    v_mfma_f32_16x16x32_bf16 a[0:3], a[112:115], v[140:143], a[0:3]
    ds_read_b128 a[48:51], v9 offset:32768
    v_fma_mix_f32 v224, v120, v208, v216 op_sel:[0,0,0] op_sel_hi:[1,0,0]
    v_fma_mix_f32 v225, v120, v209, v217 op_sel:[1,0,0] op_sel_hi:[1,0,0]
    v_fma_mix_f32 v226, v121, v210, v218 op_sel:[0,0,0] op_sel_hi:[1,0,0]
    v_mfma_f32_16x16x32_bf16 a[8:11], v[140:143], a[120:123], a[8:11]
    ds_read_b128 a[52:55], v9 offset:33792
    v_fma_mix_f32 v227, v121, v211, v219 op_sel:[1,0,0] op_sel_hi:[1,0,0]
    v_fma_mix_f32 v228, v122, v212, v220 op_sel:[0,0,0] op_sel_hi:[1,0,0]
    v_fma_mix_f32 v229, v122, v213, v221 op_sel:[1,0,0] op_sel_hi:[1,0,0]
    v_mfma_f32_16x16x32_bf16 a[4:7], a[116:119], v[140:143], a[4:7]
    ds_read_b128 a[56:59], v9 offset:34816
    v_fma_mix_f32 v230, v123, v214, v222 op_sel:[0,0,0] op_sel_hi:[1,0,0]
    v_fma_mix_f32 v231, v123, v215, v223 op_sel:[1,0,0] op_sel_hi:[1,0,0]
    v_cvt_pk_bf16_f32 v120, v224, v225
    v_mfma_f32_16x16x32_bf16 a[12:15], v[140:143], a[124:127], a[12:15]
    ds_read_b128 a[60:63], v9 offset:35840
    v_cvt_pk_bf16_f32 v121, v226, v227
    v_cvt_pk_bf16_f32 v122, v228, v229
    v_cvt_pk_bf16_f32 v123, v230, v231
    v_mfma_f32_16x16x32_bf16 v[160:163], a[24:27], v[112:115], v[160:163]
    ds_read_b128 a[40:43], v9 offset:30720
    v_fma_mix_f32 v232, v124, v208, v216 op_sel:[0,0,0] op_sel_hi:[1,0,0]
    v_fma_mix_f32 v233, v124, v209, v217 op_sel:[1,0,0] op_sel_hi:[1,0,0]
    v_fma_mix_f32 v234, v125, v210, v218 op_sel:[0,0,0] op_sel_hi:[1,0,0]
    v_mfma_f32_16x16x32_bf16 v[164:167], a[28:31], v[112:115], v[164:167]
    ds_read_b128 a[44:47], v9 offset:31744
    v_fma_mix_f32 v235, v125, v211, v219 op_sel:[1,0,0] op_sel_hi:[1,0,0]
    v_fma_mix_f32 v236, v126, v212, v220 op_sel:[0,0,0] op_sel_hi:[1,0,0]
    v_fma_mix_f32 v237, v126, v213, v221 op_sel:[1,0,0] op_sel_hi:[1,0,0]
    v_mfma_f32_16x16x32_bf16 v[176:179], v[112:115], a[32:35], v[176:179]
    ds_write_b128 v62, a[0:3] offset:0
    v_fma_mix_f32 v238, v127, v214, v222 op_sel:[0,0,0] op_sel_hi:[1,0,0]
    v_fma_mix_f32 v239, v127, v215, v223 op_sel:[1,0,0] op_sel_hi:[1,0,0]
    v_cvt_pk_bf16_f32 v124, v232, v233
    v_mfma_f32_16x16x32_bf16 v[180:183], v[112:115], a[36:39], v[180:183]
    v_cvt_pk_bf16_f32 v125, v234, v235
    v_cvt_pk_bf16_f32 v126, v236, v237
    v_cvt_pk_bf16_f32 v127, v238, v239
    v_mfma_f32_16x16x32_bf16 v[144:147], a[16:19], v[112:115], v[144:147]
    v_cmp_eq_u32 vcc, 0, v240
    v_cmp_eq_u32 s[72:73], 0, v241
    v_mov_b32 v60, 0xffff
    v_mfma_f32_16x16x32_bf16 v[148:151], a[20:23], v[112:115], v[148:151]
    ds_write_b128 v62, a[4:7] offset:1024
    v_mov_b32 v61, s55
    v_cndmask_b32 v60, 0, v60, vcc
    v_cndmask_b32 v56, v60, v61, s[72:73]
    v_mfma_f32_16x16x32_bf16 v[168:171], a[24:27], v[116:119], v[168:171]
    v_cmp_eq_u32 vcc, 0, v242
    v_cmp_eq_u32 s[72:73], 0, v243
    v_mov_b32 v60, 0xffff
    v_mfma_f32_16x16x32_bf16 v[172:175], a[28:31], v[116:119], v[172:175]
    v_mov_b32 v61, s55
    v_cndmask_b32 v60, 0, v60, vcc
    v_cndmask_b32 v57, v60, v61, s[72:73]
    v_mfma_f32_16x16x32_bf16 v[184:187], v[116:119], a[32:35], v[184:187]
    ds_write_b128 v62, a[8:11] offset:2048
    v_cmp_eq_u32 vcc, 0, v244
    v_cmp_eq_u32 s[72:73], 0, v245
    v_mov_b32 v60, 0xffff
    v_mfma_f32_16x16x32_bf16 v[188:191], v[116:119], a[36:39], v[188:191]
    v_mov_b32 v61, s55
    v_cndmask_b32 v60, 0, v60, vcc
    v_cndmask_b32 v58, v60, v61, s[72:73]
    v_mfma_f32_16x16x32_bf16 v[152:155], a[16:19], v[116:119], v[152:155]
    v_cmp_eq_u32 vcc, 0, v246
    v_cmp_eq_u32 s[72:73], 0, v247
    v_mov_b32 v60, 0xffff
    v_mfma_f32_16x16x32_bf16 v[156:159], a[20:23], v[116:119], v[156:159]
    ds_write_b128 v62, a[12:15] offset:3072
    v_mov_b32 v61, s55
    v_cndmask_b32 v60, 0, v60, vcc
    v_cndmask_b32 v59, v60, v61, s[72:73]
    s_waitcnt lgkmcnt(0)
    v_mfma_f32_16x16x32_bf16 v[168:171], a[48:51], v[124:127], v[168:171]
    v_mfma_f32_16x16x32_bf16 v[172:175], a[52:55], v[124:127], v[172:175]
    v_mfma_f32_16x16x32_bf16 v[184:187], v[124:127], a[56:59], v[184:187]
    v_mfma_f32_16x16x32_bf16 v[188:191], v[124:127], a[60:63], v[188:191]
    v_mfma_f32_16x16x32_bf16 v[160:163], a[48:51], v[120:123], v[160:163]
    v_mfma_f32_16x16x32_bf16 v[164:167], a[52:55], v[120:123], v[164:167]
    v_mfma_f32_16x16x32_bf16 v[144:147], a[40:43], v[120:123], v[144:147]
    s_nop 1
    v_cvt_pk_bf16_f32 v96, v168, v169
    v_cvt_pk_bf16_f32 v97, v170, v171
    v_mfma_f32_16x16x32_bf16 v[148:151], a[44:47], v[120:123], v[148:151]
    v_cvt_pk_bf16_f32 v98, v172, v173
    v_cvt_pk_bf16_f32 v99, v174, v175
    v_mfma_f32_16x16x32_bf16 v[152:155], a[40:43], v[124:127], v[152:155]
    ds_write_b128 v63, v[96:99] offset:16384
    v_cvt_pk_bf16_f32 v104, v184, v185
    v_cvt_pk_bf16_f32 v105, v186, v187
    v_mfma_f32_16x16x32_bf16 v[156:159], a[44:47], v[124:127], v[156:159]
    v_cvt_pk_bf16_f32 v110, v188, v189
    v_cvt_pk_bf16_f32 v111, v190, v191
    v_mfma_f32_16x16x32_bf16 v[176:179], v[120:123], a[56:59], v[176:179]
    ds_write_b64 v63, v[104:105] offset:17408
    v_cvt_pk_bf16_f32 v92, v160, v161
    v_cvt_pk_bf16_f32 v93, v162, v163
    v_mfma_f32_16x16x32_bf16 v[180:183], v[120:123], a[60:63], v[180:183]
    ds_write_b64 v63, v[110:111] offset:17416
    v_cvt_pk_bf16_f32 v94, v164, v165
    v_cvt_pk_bf16_f32 v95, v166, v167
    v_cvt_pk_bf16_f32 v80, v144, v145
    v_cvt_pk_bf16_f32 v81, v146, v147
    v_cvt_pk_bf16_f32 v82, v148, v149
    v_cvt_pk_bf16_f32 v83, v150, v151
    v_cvt_pk_bf16_f32 v84, v152, v153
    v_cvt_pk_bf16_f32 v85, v154, v155
    v_cvt_pk_bf16_f32 v86, v156, v157
    v_cvt_pk_bf16_f32 v87, v158, v159
    v_cndmask_b32 v82, 0, v82, s[66:67]
    v_cndmask_b32 v83, 0, v83, s[66:67]
    v_cndmask_b32 v86, 0, v86, s[66:67]
    v_cndmask_b32 v87, 0, v87, s[66:67]
    s_waitcnt lgkmcnt(0)
    v_mfma_f32_16x16x32_bf16 v[116:119], v[92:95], v[80:83], v[244:247]
    s_barrier
    s_mov_b32 m0, s60
    s_nop 0
    buffer_load_dwordx4 v252, s[8:11], s59 offen nt lds
    s_add_u32 m0, s60, 1024
    s_add_u32 s59, s59, 14336
    buffer_load_dwordx4 v252, s[8:11], s59 offen nt lds
    s_cmp_eq_u32 s3, 0
    s_cbranch_scc1 L_ex1
    ds_read_b128 v[88:91], v14
    ds_read_b64 v[100:101], v14 offset:1024
    ds_read_b64 v[106:107], v14 offset:1032
    s_branch L_ex2
L_ex1:
    ds_read_b128 v[192:195], v7 offset:4096
    ds_read_b128 v[208:211], v7 offset:8192
    ds_read_b128 v[224:227], v7 offset:12288
    ds_read_b128 v[196:199], v7 offset:5120
    ds_read_b128 v[212:215], v7 offset:9216
    ds_read_b128 v[228:231], v7 offset:13312
    ds_read_b128 v[200:203], v7 offset:6144
    ds_read_b128 v[216:219], v7 offset:10240
    ds_read_b128 v[232:235], v7 offset:14336
    ds_read_b128 v[204:207], v7 offset:7168
    ds_read_b128 v[220:223], v7 offset:11264
    ds_read_b128 v[236:239], v7 offset:15360
    v_accvgpr_read_b32 v64, a0
    v_accvgpr_read_b32 v65, a1
    v_accvgpr_read_b32 v66, a2
    v_accvgpr_read_b32 v67, a3
    v_accvgpr_read_b32 v68, a4
    v_accvgpr_read_b32 v69, a5
    v_accvgpr_read_b32 v70, a6
    v_accvgpr_read_b32 v71, a7
    v_accvgpr_read_b32 v72, a8
    v_accvgpr_read_b32 v73, a9
    v_accvgpr_read_b32 v74, a10
    v_accvgpr_read_b32 v75, a11
    v_accvgpr_read_b32 v76, a12
    v_accvgpr_read_b32 v77, a13
    v_accvgpr_read_b32 v78, a14
    v_accvgpr_read_b32 v79, a15
    s_waitcnt lgkmcnt(11)
    v_pk_add_f32 v[64:65], v[64:65], v[192:193]
    v_pk_add_f32 v[66:67], v[66:67], v[194:195]
    s_waitcnt lgkmcnt(8)
    v_pk_add_f32 v[68:69], v[68:69], v[196:197]
    v_pk_add_f32 v[70:71], v[70:71], v[198:199]
    v_pk_add_f32 v[208:209], v[208:209], v[224:225]
    v_pk_add_f32 v[210:211], v[210:211], v[226:227]
    s_waitcnt lgkmcnt(6)
    v_pk_add_f32 v[212:213], v[212:213], v[228:229]
    v_pk_add_f32 v[214:215], v[214:215], v[230:231]
    v_pk_add_f32 v[64:65], v[64:65], v[208:209]
    v_pk_add_f32 v[66:67], v[66:67], v[210:211]
    v_pk_add_f32 v[68:69], v[68:69], v[212:213]
    v_pk_add_f32 v[70:71], v[70:71], v[214:215]
    s_waitcnt lgkmcnt(5)
    v_pk_add_f32 v[72:73], v[72:73], v[200:201]
    v_pk_add_f32 v[74:75], v[74:75], v[202:203]
    s_waitcnt lgkmcnt(2)
    v_pk_add_f32 v[76:77], v[76:77], v[204:205]
    v_pk_add_f32 v[78:79], v[78:79], v[206:207]
    v_pk_add_f32 v[216:217], v[216:217], v[232:233]
    v_pk_add_f32 v[218:219], v[218:219], v[234:235]
    s_waitcnt lgkmcnt(0)
    v_pk_add_f32 v[220:221], v[220:221], v[236:237]
    v_pk_add_f32 v[222:223], v[222:223], v[238:239]
    v_pk_add_f32 v[72:73], v[72:73], v[216:217]
    v_pk_add_f32 v[74:75], v[74:75], v[218:219]
    v_pk_add_f32 v[76:77], v[76:77], v[220:221]
    v_pk_add_f32 v[78:79], v[78:79], v[222:223]
    v_cvt_pk_bf16_f32 v88, v64, v65
    v_cvt_pk_bf16_f32 v89, v66, v67
    v_cvt_pk_bf16_f32 v90, v68, v69
    v_cvt_pk_bf16_f32 v91, v70, v71
    v_cvt_pk_bf16_f32 v100, v72, v73
    v_cvt_pk_bf16_f32 v101, v74, v75
    v_cvt_pk_bf16_f32 v106, v76, v77
    v_cvt_pk_bf16_f32 v107, v78, v79
L_ex2:
    v_mfma_f32_16x16x32_bf16 v[120:123], v[92:95], v[84:87], v[240:243]
    v_mfma_f32_16x16x32_bf16 v[124:127], v[96:99], v[84:87], v[244:247]
    v_cvt_pk_bf16_f32 v102, v176, v177
    v_cvt_pk_bf16_f32 v103, v178, v179
    v_cvt_pk_bf16_f32 v108, v180, v181
    v_cvt_pk_bf16_f32 v109, v182, v183
    s_waitcnt lgkmcnt(0)
    v_mfma_f32_16x16x32_bf16 v[112:115], v[88:91], v[80:83], v[248:251]
    s_mov_b32 s56, 0x3e8b97f6
    v_lshlrev_b32 v14, 9, v5
    s_lshl_b32 s74, s3, 6
    s_lshl_b32 s57, s63, 8
    v_lshl_add_u32 v14, v4, 4, v14
    v_max3_f32 v130, v120, v121, v124
    v_max3_f32 v131, v122, v123, v126
    v_max_f32 v130, v130, v125
    v_max_f32 v131, v131, v127
    v_max3_f32 v128, v112, v113, v116
    v_max3_f32 v129, v114, v115, v118
    v_max_f32 v128, v128, v117
    v_max_f32 v129, v129, v119
    v_max_f32 v133, v130, v131
    v_max_f32 v132, v128, v129
    v_mov_b32 v134, v132
    v_mov_b32 v135, v133
    s_nop 0
    v_permlane16_swap_b32 v132, v134
    v_permlane16_swap_b32 v133, v135
    v_max_f32 v132, v132, v134
    v_max_f32 v133, v133, v135
    v_mov_b32 v134, v132
    v_mov_b32 v135, v133
    s_nop 0
    v_permlane32_swap_b32 v132, v134
    v_permlane32_swap_b32 v133, v135
    v_max_f32 v132, v132, v134
    v_max_f32 v133, v133, v135
    v_mul_f32 v132, 0xbe8b97f6, v132
    v_mul_f32 v133, 0xbe8b97f6, v133
    v_fma_f32 v128, v128, s56, v132
    v_fma_f32 v129, v129, s56, v132
    v_fma_f32 v130, v130, s56, v133
    v_fma_f32 v131, v131, s56, v133
    v_exp_f32 v128, v128
    v_exp_f32 v129, v129
    v_exp_f32 v130, v130
    v_exp_f32 v131, v131
    v_add_f32 v136, v128, v129
    v_add_f32 v137, v130, v131
    v_mov_b32 v134, v136
    v_mov_b32 v135, v137
    s_nop 0
    v_permlane16_swap_b32 v136, v134
    v_permlane16_swap_b32 v137, v135
    v_add_f32 v136, v136, v134
    v_add_f32 v137, v137, v135
    v_mov_b32 v134, v136
    v_mov_b32 v135, v137
    s_nop 0
    v_permlane32_swap_b32 v136, v134
    v_permlane32_swap_b32 v137, v135
    v_add_f32 v136, v136, v134
    v_add_f32 v137, v137, v135
    v_rcp_f32 v136, v136
    v_rcp_f32 v137, v137
    v_mul_f32 v128, v128, v136
    v_mul_f32 v129, v129, v136
    v_mul_f32 v130, v130, v137
    v_mul_f32 v131, v131, v137
    v_cvt_pk_bf16_f32 v128, v128, v128
    v_cvt_pk_bf16_f32 v129, v129, v129
    v_cvt_pk_bf16_f32 v130, v130, v130
    v_cvt_pk_bf16_f32 v131, v131, v131
    v_and_b32 v112, v128, v56
    v_and_b32 v113, v129, v57
    v_and_b32 v114, v128, v58
    v_and_b32 v115, v129, v59
    v_and_b32 v116, v130, v56
    v_and_b32 v117, v131, v57
    v_and_b32 v118, v130, v58
    v_and_b32 v119, v131, v59
    v_mfma_f32_16x16x32_bf16 v[144:147], v[100:103], v[112:115], 0
    v_mfma_f32_16x16x32_bf16 v[148:151], v[106:109], v[112:115], 0
    v_mfma_f32_16x16x32_bf16 v[152:155], v[102:105], v[116:119], 0
    v_mfma_f32_16x16x32_bf16 v[156:159], v[108:111], v[116:119], 0
    v_mov_b32 v26, s52
    v_mov_b32 v27, s53
    v_lshlrev_b32 v29, 3, v0
    v_add_u32 v56, s74, v0
    v_mov_b32 v59, 112
    v_lshlrev_b32 v13, 4, v56
    v_cmp_lt_u32 s[72:73], v56, v59
    s_add_u32 s56, s57, 0
    s_add_u32 s57, s57, 5120
    v_cvt_pk_bf16_f32 v160, v144, v145
    v_cvt_pk_bf16_f32 v161, v146, v147
    v_cvt_pk_bf16_f32 v162, v148, v149
    v_cvt_pk_bf16_f32 v163, v150, v151
    v_cndmask_b32 v162, 0, v162, s[66:67]
    v_cndmask_b32 v163, 0, v163, s[66:67]
    buffer_store_dwordx4 v[160:163], v14, s[48:51], s1 offen offset:0 sc1
    v_cvt_pk_bf16_f32 v164, v152, v153
    v_cvt_pk_bf16_f32 v165, v154, v155
    v_cvt_pk_bf16_f32 v166, v156, v157
    v_cvt_pk_bf16_f32 v167, v158, v159
    v_cndmask_b32 v166, 0, v166, s[66:67]
    v_cndmask_b32 v167, 0, v167, s[66:67]
    buffer_store_dwordx4 v[164:167], v14, s[48:51], s1 offen offset:256 sc1
    s_mov_b64 exec, 0xffff
    buffer_store_dwordx2 v[26:27], v29, s[48:51], s0 offen sc1
    s_mov_b64 exec, -1
    v_cmp_gt_u32 vcc, 240, v56
    v_add_u32 v59, 7168, v13
    v_add_u32 v15, 3584, v13
    v_add_u32 v57, s56, v13
    v_add_u32 v58, s57, v13
    v_cndmask_b32 v15, v15, v59, s[72:73]
    v_cndmask_b32 v57, v58, v57, vcc
    v_cmp_gt_u32 vcc, 224, v56
    s_nop 1
    v_cndmask_b32 v15, v57, v15, vcc
    s_cmp_eq_u32 s63, 7
    s_cbranch_scc1 L_idle
    s_mov_b32 s56, s79
    buffer_load_dwordx4 v[176:179], v15, s[48:51], s56 offen offset:0 sc1
    v_lshrrev_b32 v6, 5, v0
    v_and_b32 v1, 31, v0
    v_lshlrev_b32 v11, 2, v5
    v_lshrrev_b32 v8, 2, v4
    v_xor_b32 v11, v11, v4
    v_lshlrev_b32 v8, 4, v8
    v_mul_u32_u24 v9, 3584, v5
    v_lshl_add_u32 v8, v1, 6, v8
    v_xor_b32 v12, 2, v11
    v_lshl_add_u32 v8, v6, 3, v8
    v_lshl_add_u32 v11, v11, 4, v9
    v_add_u32 v8, s60, v8
    v_lshl_add_u32 v12, v12, 4, v9
    v_add_u32 v20, 13312, v11
    v_add_u32 v21, 13312, v12
    s_add_u32 m0, s12, 32768
    s_add_u32 s57, s7, 0
    buffer_load_dwordx4 v11, s[20:23], s57 offen lds
    v_xor_b32 v73, 16, v8
    v_xor_b32 v74, 32, v8
    v_xor_b32 v75, 48, v8
    v_subrev_u32 v59, 112, v56
    buffer_load_dwordx4 v20, s[20:23], s57 offen offset:1024 lds
    v_add_u32 v58, 7680, v13
    v_cndmask_b32 v59, v59, v56, s[72:73]
    v_cndmask_b32 v61, 32, 0, s[72:73]
    v_lshrrev_b32 v57, 2, v59
    s_add_u32 m0, s12, 40960
    s_nop 0
    buffer_load_dwordx4 v12, s[24:27], s57 offen lds
    v_cndmask_b32 v62, 0, 1.0, s[72:73]
    v_mul_u32_u24 v57, 80, v57
    s_andn2_b64 s[74:75], vcc, s[72:73]
    v_add_u32 v60, 9536, v57
    buffer_load_dwordx4 v21, s[24:27], s57 offen offset:1024 lds
    v_add_u32 v57, v57, v61
    v_cndmask_b32 v58, v60, v58, s[72:73]
    v_add_u32 v60, 512, v13
    v_and_b32 v61, 1, v59
    s_add_u32 m0, s12, 49152
    s_add_u32 s57, s7, 114688
    buffer_load_dwordx4 v11, s[20:23], s57 offen lds
    v_cndmask_b32 v58, v60, v58, vcc
    v_lshl_add_u32 v57, v61, 4, v57
    v_and_b32 v61, 2, v59
    v_mov_b32 v60, 6400
    buffer_load_dwordx4 v20, s[20:23], s57 offen offset:1024 lds
    v_lshl_add_u32 v57, v61, 2, v57
    v_lshlrev_b32 v13, 7, v2
    v_cndmask_b32 v57, v60, v57, vcc
    v_lshrrev_b32 v14, 2, v4
    s_add_u32 m0, s12, 57344
    s_nop 0
    buffer_load_dwordx4 v12, s[24:27], s57 offen lds
    v_and_b32 v9, 1, v5
    s_lshl_b32 s56, s3, 1
    v_lshl_add_u32 v10, v14, 1, v9
    v_lshl_add_u32 v14, v6, 2, v14
    buffer_load_dwordx4 v21, s[24:27], s57 offen offset:1024 lds
    v_xor_b32 v10, s56, v10
    v_lshlrev_b32 v14, 8, v14
    v_lshlrev_b32 v10, 5, v10
    v_lshl_add_u32 v14, v9, 13, v14
    s_add_u32 m0, s12, 65536
    s_add_u32 s57, s7, 229376
    buffer_load_dwordx4 v11, s[20:23], s57 offen lds
    v_and_b32 v9, 3, v0
    v_add_u32 v10, v10, v14
    v_lshl_add_u32 v10, v9, 3, v10
    v_add_u32 v16, 32768, v10
    buffer_load_dwordx4 v20, s[20:23], s57 offen offset:1024 lds
    v_add_u32 v18, 98304, v10
    v_xor_b32 v17, 32, v16
    v_xor_b32 v19, 32, v18
    v_add_u32 v24, 102400, v7
    s_add_u32 m0, s12, 73728
    s_nop 0
    buffer_load_dwordx4 v12, s[24:27], s57 offen lds
    v_add_u32 v25, 16384, v7
    v_min_u32 v28, 6, v0
    v_and_b32 v124, 2, v0
    v_lshlrev_b32 v28, 9, v28
    buffer_load_dwordx4 v21, s[24:27], s57 offen offset:1024 lds
    v_lshlrev_b32 v124, 4, v124
    v_xor_b32 v125, v0, v5
    v_lshl_add_u32 v124, v6, 4, v124
    v_and_b32 v125, 1, v125
    s_add_u32 m0, s12, 81920
    s_add_u32 s57, s7, 344064
    buffer_load_dwordx4 v11, s[20:23], s57 offen lds
    v_cmp_eq_u32 vcc, 0, v125
    v_mul_u32_u24 v125, 1792, v6
    v_min_u32 v126, 6, v2
    v_and_b32 v127, 8, v0
    buffer_load_dwordx4 v20, s[20:23], s57 offen offset:1024 lds
    v_add_lshl_u32 v126, v126, v127, 7
    v_min_u32 v147, 27, v1
    v_add_u32 v126, s77, v126
    v_cmp_gt_u32 s[66:67], 32, v0
    s_add_u32 m0, s12, 90112
    s_nop 0
    buffer_load_dwordx4 v12, s[24:27], s57 offen lds
    v_lshlrev_b32 v127, 7, v147
    v_add_u32 v126, 1011712, v126
    v_add_u32 v127, 22675456, v127
    v_lshl_add_u32 v147, v6, 5, v147
    buffer_load_dwordx4 v21, s[24:27], s57 offen offset:1024 lds
    v_cndmask_b32 v145, v127, v126, s[66:67]
    v_lshlrev_b32 v147, 7, v147
    v_cndmask_b32 v124, 64, v124, vcc
    v_lshl_add_u32 v125, v1, 3, v125
    v_lshlrev_b32 v23, 4, v1
    s_mov_b32 s54, 0
L_sp_11:
        s_buffer_load_dword s8, s[48:51], s14 offset:0 glc
        s_buffer_load_dword s9, s[48:51], s14 offset:128 glc
        s_buffer_load_dword s10, s[48:51], s14 offset:256 glc
        s_buffer_load_dword s11, s[48:51], s14 offset:384 glc
        s_buffer_load_dword s72, s[48:51], s14 offset:512 glc
        s_buffer_load_dword s73, s[48:51], s14 offset:640 glc
        s_buffer_load_dword s6, s[48:51], s14 offset:768 glc
        s_buffer_load_dword s59, s[48:51], s14 offset:896 glc
L_spc_13:
    s_waitcnt lgkmcnt(0)
    s_xor_b32 s8, s8, s52
    s_xor_b32 s9, s9, s52
    s_xor_b32 s10, s10, s52
    s_xor_b32 s11, s11, s52
    s_xor_b32 s72, s72, s52
    s_xor_b32 s73, s73, s52
    s_xor_b32 s6, s6, s52
    s_xor_b32 s59, s59, s52
    s_or_b32 s8, s8, s9
    s_or_b32 s10, s10, s11
    s_or_b32 s72, s72, s73
    s_or_b32 s6, s6, s59
    s_or_b32 s8, s8, s10
    s_or_b32 s72, s72, s6
    s_or_b32 s8, s8, s72
    s_cbranch_scc0 L_spd_12
    s_add_u32 s54, s54, 1
    s_cmp_lt_u32 s54, 16384
    s_cbranch_scc1 L_sp_11
    v_mov_b32 v146, 4
    buffer_store_dword v146, off, s[44:47], 0 offset:16
    s_waitcnt vmcnt(0)
L_spd_12:
    s_add_u32 s76, s15, 0
    buffer_load_dwordx4 v[192:195], v7, s[48:51], s76 offen offset:0 sc1
    buffer_load_dwordx4 v[196:199], v7, s[48:51], s76 offen offset:1024 sc1
    buffer_load_dwordx4 v[200:203], v7, s[48:51], s76 offen offset:2048 sc1
    buffer_load_dwordx4 v[204:207], v7, s[48:51], s76 offen offset:3072 sc1
    s_add_u32 s76, s15, 4096
    buffer_load_dwordx4 v[208:211], v7, s[48:51], s76 offen offset:0 sc1
    buffer_load_dwordx4 v[212:215], v7, s[48:51], s76 offen offset:1024 sc1
    buffer_load_dwordx4 v[216:219], v7, s[48:51], s76 offen offset:2048 sc1
    buffer_load_dwordx4 v[220:223], v7, s[48:51], s76 offen offset:3072 sc1
    s_mov_b32 s54, 0
L_gc_14:
    s_waitcnt vmcnt(24)
    v_xor_b32 v176, s68, v176
    v_xor_b32 v177, s69, v177
    v_xor_b32 v178, s70, v178
    v_xor_b32 v179, s71, v179
    v_or_b32 v180, v176, v177
    v_or3_b32 v180, v180, v178, v179
    v_and_b32 v180, 0xff, v180
    v_cmp_ne_u32 vcc, 0, v180
    s_cbranch_vccz L_gok_15
    s_mov_b32 s56, s79
    buffer_load_dwordx4 v[176:179], v15, s[48:51], s56 offen offset:0 sc1
    s_waitcnt vmcnt(0)
    s_add_u32 s54, s54, 1
    s_cmp_lt_u32 s54, 16384
    s_cbranch_scc1 L_gc_14
    v_mov_b32 v180, 3
    buffer_store_dword v180, off, s[44:47], 0 offset:16
    s_waitcnt vmcnt(0)
L_gok_15:
    s_add_u32 s76, s15, 8192
    buffer_load_dwordx4 v[224:227], v7, s[48:51], s76 offen offset:0 sc1
    v_add_f32 v176, v176, v62
    v_add_f32 v177, v177, v62
    v_add_f32 v178, v178, v62
    v_add_f32 v179, v179, v62
    v_cvt_pk_bf16_f32 v180, v176, v177
    v_cvt_pk_bf16_f32 v181, v178, v179
    buffer_load_dwordx4 v[228:231], v7, s[48:51], s76 offen offset:1024 sc1
    v_lshlrev_b32 v176, 16, v180
    v_and_b32 v177, s55, v180
    v_lshlrev_b32 v178, 16, v181
    v_and_b32 v179, s55, v181
    v_cndmask_b32 v176, v176, 0, s[74:75]
    v_cndmask_b32 v177, v177, 0, s[74:75]
    buffer_load_dwordx4 v[232:235], v7, s[48:51], s76 offen offset:2048 sc1
    v_cndmask_b32 v178, v178, 0, s[74:75]
    v_cndmask_b32 v179, v179, 0, s[74:75]
    s_lshl_b32 s56, s58, 7
    v_lshlrev_b32 v10, 4, v6
    v_add_u32 v9, s56, v10
    s_lshl_b32 s56, s65, 7
    buffer_load_dwordx4 v[236:239], v7, s[48:51], s76 offen offset:3072 sc1
    v_add_u32 v10, s56, v10
    v_lshlrev_b32 v14, 3, v1
    v_mov_b32 v15, 0x3f803f80
    v_add_u32 v13, s13, v7
    v_lshl_add_u32 v14, v6, 2, v14
    s_add_u32 s73, s16, 131072
    s_waitcnt vmcnt(12)
    s_barrier
    s_add_u32 s76, s15, 12288
    buffer_load_dwordx4 v[240:243], v7, s[48:51], s76 offen offset:0 sc1
    ds_write_b128 v58, v[176:179]
    ds_write_b64 v57, v[180:181] offset:9472
    ds_read_b64 v[64:65], v8
    ds_read_b64 v[66:67], v73
    buffer_load_dwordx4 v[244:247], v7, s[48:51], s76 offen offset:1024 sc1
    ds_read_b64 v[68:69], v74
    ds_read_b64 v[70:71], v75
    ds_read_b64_tr_b16 a[0:1], v16 offset:0
    ds_read_b64_tr_b16 a[2:3], v16 offset:2048
    ds_read_b64_tr_b16 a[4:5], v17 offset:0
    buffer_load_dwordx4 v[248:251], v7, s[48:51], s76 offen offset:2048 sc1
    ds_read_b64_tr_b16 a[6:7], v17 offset:2048
    ds_read_b64_tr_b16 a[8:9], v16 offset:4096
    ds_read_b64_tr_b16 a[10:11], v16 offset:6144
    ds_read_b64_tr_b16 a[12:13], v17 offset:4096
    ds_read_b64_tr_b16 a[14:15], v17 offset:6144
    buffer_load_dwordx4 v[252:255], v7, s[48:51], s76 offen offset:3072 sc1
    ds_read_b64_tr_b16 a[16:17], v16 offset:16384
    ds_read_b64_tr_b16 a[18:19], v16 offset:18432
    ds_read_b64_tr_b16 a[20:21], v17 offset:16384
    ds_read_b64_tr_b16 a[22:23], v17 offset:18432
    ds_read_b64_tr_b16 a[24:25], v16 offset:20480
    s_add_u32 m0, s12, 98304
    s_add_u32 s57, s7, 458752
    buffer_load_dwordx4 v11, s[20:23], s57 offen lds
    ds_read_b64_tr_b16 a[26:27], v16 offset:22528
    ds_read_b64_tr_b16 a[28:29], v17 offset:20480
    ds_read_b64_tr_b16 a[30:31], v17 offset:22528
    ds_read_b64_tr_b16 a[32:33], v16 offset:32768
    buffer_load_dwordx4 v20, s[20:23], s57 offen offset:1024 lds
    ds_read_b64_tr_b16 a[34:35], v16 offset:34816
    ds_read_b64_tr_b16 a[36:37], v17 offset:32768
    ds_read_b64_tr_b16 a[38:39], v17 offset:34816
    ds_read_b64_tr_b16 a[40:41], v16 offset:36864
    ds_read_b64_tr_b16 a[42:43], v16 offset:38912
    s_add_u32 m0, s12, 106496
    s_nop 0
    buffer_load_dwordx4 v12, s[24:27], s57 offen lds
    ds_read_b64_tr_b16 a[44:45], v17 offset:36864
    ds_read_b64_tr_b16 a[46:47], v17 offset:38912
    ds_read_b64_tr_b16 a[48:49], v16 offset:49152
    ds_read_b64_tr_b16 a[50:51], v16 offset:51200
    ds_read_b64_tr_b16 a[52:53], v17 offset:49152
    buffer_load_dwordx4 v21, s[24:27], s57 offen offset:1024 lds
    ds_read_b64_tr_b16 a[54:55], v17 offset:51200
    ds_read_b64_tr_b16 a[56:57], v16 offset:53248
    ds_read_b64_tr_b16 a[58:59], v16 offset:55296
    ds_read_b64_tr_b16 a[60:61], v17 offset:53248
    ds_read_b64_tr_b16 a[62:63], v17 offset:55296
    s_waitcnt vmcnt(19)
    v_mfma_f32_32x32x16_bf16 v[160:175], a[132:135], v[192:195], 0
    s_add_u32 m0, s12, 114688
    s_add_u32 s57, s7, 573440
    buffer_load_dwordx4 v11, s[20:23], s57 offen lds
    v_xor_b32 v8, 4096, v13
    v_mov_b32 v120, 0
    v_mfma_f32_32x32x16_bf16 v[128:143], a[128:131], v[192:195], 0
    v_mov_b32 v121, 0
    v_mov_b32 v122, 0
    v_mov_b32 v123, 0
    s_waitcnt lgkmcnt(14)
    v_lshlrev_b32 v72, 16, v64
    v_and_b32 v73, s55, v64
    v_lshlrev_b32 v74, 16, v65
    s_waitcnt vmcnt(19)
    v_mfma_f32_32x32x16_bf16 v[160:175], a[140:143], v[196:199], v[160:175]
    buffer_load_dwordx4 v20, s[20:23], s57 offen offset:1024 lds
    v_and_b32 v75, s55, v65
    v_lshlrev_b32 v76, 16, v66
    v_and_b32 v77, s55, v66
    v_lshlrev_b32 v78, 16, v67
    v_mfma_f32_32x32x16_bf16 v[128:143], a[136:139], v[196:199], v[128:143]
    v_and_b32 v79, s55, v67
    v_lshlrev_b32 v80, 16, v68
    v_and_b32 v81, s55, v68
    v_lshlrev_b32 v82, 16, v69
    v_and_b32 v83, s55, v69
    v_lshlrev_b32 v84, 16, v70
    s_waitcnt vmcnt(19)
    v_mfma_f32_32x32x16_bf16 v[160:175], a[148:151], v[200:203], v[160:175]
    s_add_u32 m0, s12, 122880
    s_nop 0
    buffer_load_dwordx4 v12, s[24:27], s57 offen lds
    s_waitcnt lgkmcnt(0)
    s_barrier
    v_and_b32 v85, s55, v70
    v_mfma_f32_32x32x16_bf16 v[128:143], a[144:147], v[200:203], v[128:143]
    v_lshlrev_b32 v86, 16, v71
    v_and_b32 v87, s55, v71
    s_lshl_b32 s6, s4, 13
    s_add_u32 s6, s6, 17039360
    s_lshl_b32 s68, s3, 7
    s_lshl_b32 s56, s62, 13
    s_waitcnt vmcnt(19)
    v_mfma_f32_32x32x16_bf16 v[160:175], a[156:159], v[204:207], v[160:175]
    buffer_load_dwordx4 v21, s[24:27], s57 offen offset:1024 lds
    s_add_u32 s68, s68, s77
    s_add_u32 s68, s68, s56
    s_mul_i32 s56, s62, 3584
    s_add_u32 s68, s68, 1015808
    v_mfma_f32_32x32x16_bf16 v[128:143], a[152:155], v[204:207], v[128:143]
    s_add_u32 s70, s12, s77
    s_sub_u32 s69, s68, s56
    s_add_u32 s68, s68, s56
    s_add_u32 s69, s69, 3584
    s_mul_i32 s56, s62, 114688
    s_add_u32 s70, s70, 524288
    s_waitcnt vmcnt(19)
    v_mfma_f32_32x32x16_bf16 v[160:175], a[164:167], v[208:211], v[160:175]
    s_add_u32 m0, s12, 131072
    s_add_u32 s57, s7, 688128
    buffer_load_dwordx4 v11, s[20:23], s57 offen lds
    s_add_u32 s72, s77, 1011712
    s_add_u32 s70, s70, s56
    v_mfma_f32_32x32x16_bf16 v[128:143], a[160:163], v[208:211], v[128:143]
    s_mul_i32 s56, s62, 57344
    s_sub_u32 s71, s70, s56
    s_add_u32 s70, s70, s56
    s_add_u32 s71, s71, 57344
    s_waitcnt vmcnt(19)
    v_mfma_f32_32x32x16_bf16 v[160:175], a[172:175], v[212:215], v[160:175]
    buffer_load_dwordx4 v20, s[20:23], s57 offen offset:1024 lds
    v_mfma_f32_32x32x16_bf16 v[128:143], a[168:171], v[212:215], v[128:143]
    s_waitcnt vmcnt(19)
    v_mfma_f32_32x32x16_bf16 v[160:175], a[180:183], v[216:219], v[160:175]
    s_add_u32 m0, s12, 139264
    s_nop 0
    buffer_load_dwordx4 v12, s[24:27], s57 offen lds
    ds_read_b128 v[88:91], v9 offset:4096
    v_mfma_f32_32x32x16_bf16 v[128:143], a[176:179], v[216:219], v[128:143]
    s_waitcnt vmcnt(19)
    v_mfma_f32_32x32x16_bf16 v[160:175], a[188:191], v[220:223], v[160:175]
    buffer_load_dwordx4 v21, s[24:27], s57 offen offset:1024 lds
    ds_read_b128 v[104:107], v10 offset:7680
    v_mfma_f32_32x32x16_bf16 v[128:143], a[184:187], v[220:223], v[128:143]
    s_waitcnt vmcnt(19)
    v_mfma_f32_32x32x16_bf16 v[160:175], a[196:199], v[224:227], v[160:175]
    ds_read_b128 v[92:95], v9 offset:4128
    v_mfma_f32_32x32x16_bf16 v[128:143], a[192:195], v[224:227], v[128:143]
    s_waitcnt vmcnt(18)
    v_mfma_f32_32x32x16_bf16 v[160:175], a[204:207], v[228:231], v[160:175]
    ds_read_b128 v[108:111], v10 offset:7712
    v_mfma_f32_32x32x16_bf16 v[128:143], a[200:203], v[228:231], v[128:143]
    s_waitcnt vmcnt(17)
    v_mfma_f32_32x32x16_bf16 v[160:175], a[212:215], v[232:235], v[160:175]
    ds_read_b128 v[96:99], v9 offset:4160
    v_mfma_f32_32x32x16_bf16 v[128:143], a[208:211], v[232:235], v[128:143]
    s_waitcnt vmcnt(16)
    v_mfma_f32_32x32x16_bf16 v[160:175], a[220:223], v[236:239], v[160:175]
    ds_read_b128 v[112:115], v10 offset:7744
    v_mfma_f32_32x32x16_bf16 v[128:143], a[216:219], v[236:239], v[128:143]
    s_waitcnt vmcnt(15)
    v_mfma_f32_32x32x16_bf16 v[160:175], a[228:231], v[240:243], v[160:175]
    ds_read_b128 v[100:103], v9 offset:4192
    v_mfma_f32_32x32x16_bf16 v[128:143], a[224:227], v[240:243], v[128:143]
    s_waitcnt vmcnt(14)
    v_mfma_f32_32x32x16_bf16 v[160:175], a[236:239], v[244:247], v[160:175]
    ds_read_b128 v[116:119], v10 offset:7776
    v_mfma_f32_32x32x16_bf16 v[128:143], a[232:235], v[244:247], v[128:143]
    s_waitcnt vmcnt(13)
    v_mfma_f32_32x32x16_bf16 v[160:175], a[244:247], v[248:251], v[160:175]
    v_mfma_f32_32x32x16_bf16 v[128:143], a[240:243], v[248:251], v[128:143]
    s_waitcnt vmcnt(12)
    v_mfma_f32_32x32x16_bf16 v[160:175], a[252:255], v[252:255], v[160:175]
    v_mfma_f32_32x32x16_bf16 v[128:143], a[248:251], v[252:255], v[128:143]
    s_nop 10
    v_cmp_u_f32 vcc, v160, v160
    s_cbranch_vccnz L_p2redo
L_p2ok:
    ds_write_b128 v13, v[160:163] offset:0
    ds_write_b128 v13, v[164:167] offset:1024
    ds_write_b128 v13, v[168:171] offset:2048
    ds_write_b128 v13, v[172:175] offset:3072
    s_waitcnt lgkmcnt(11)
    v_fmac_f32 v72, v88, v128
    v_fmac_f32 v73, v89, v129
    v_fmac_f32 v74, v90, v130
    v_fmac_f32 v75, v91, v131
    s_waitcnt lgkmcnt(9)
    v_fmac_f32 v76, v92, v132
    v_fmac_f32 v77, v93, v133
    v_fmac_f32 v78, v94, v134
    v_fmac_f32 v79, v95, v135
    s_waitcnt lgkmcnt(7)
    v_fmac_f32 v80, v96, v136
    v_fmac_f32 v81, v97, v137
    v_fmac_f32 v82, v98, v138
    v_fmac_f32 v83, v99, v139
    s_waitcnt lgkmcnt(5)
    v_fmac_f32 v84, v100, v140
    v_fmac_f32 v85, v101, v141
    v_fmac_f32 v86, v102, v142
    v_fmac_f32 v87, v103, v143
    s_waitcnt lgkmcnt(0)
    s_barrier
    ds_read_b128 v[128:131], v8 offset:0
    ds_read_b128 v[132:135], v8 offset:1024
    ds_read_b128 v[136:139], v8 offset:2048
    ds_read_b128 v[140:143], v8 offset:3072
    s_add_u32 m0, s12, 147456
    s_add_u32 s57, s7, 802816
    buffer_load_dwordx4 v11, s[20:23], s57 offen lds
    buffer_load_dwordx4 v20, s[20:23], s57 offen offset:1024 lds
    s_waitcnt lgkmcnt(3)
    v_fmac_f32 v72, v88, v128
    v_fmac_f32 v73, v89, v129
    v_fmac_f32 v74, v90, v130
    v_fmac_f32 v75, v91, v131
    s_waitcnt lgkmcnt(2)
    v_fmac_f32 v76, v92, v132
    v_fmac_f32 v77, v93, v133
    v_fmac_f32 v78, v94, v134
    v_fmac_f32 v79, v95, v135
    s_waitcnt lgkmcnt(1)
    v_fmac_f32 v80, v96, v136
    v_fmac_f32 v81, v97, v137
    v_fmac_f32 v82, v98, v138
    v_fmac_f32 v83, v99, v139
    s_waitcnt lgkmcnt(0)
    v_fmac_f32 v84, v100, v140
    v_fmac_f32 v85, v101, v141
    v_fmac_f32 v86, v102, v142
    v_fmac_f32 v87, v103, v143
    v_cvt_pk_bf16_f32 v32, v72, v73
    v_cvt_pk_bf16_f32 v33, v74, v75
    v_cvt_pk_bf16_f32 v34, v76, v77
    v_cvt_pk_bf16_f32 v35, v78, v79
    v_cvt_pk_bf16_f32 v36, v80, v81
    v_cvt_pk_bf16_f32 v37, v82, v83
    v_cvt_pk_bf16_f32 v38, v84, v85
    v_cvt_pk_bf16_f32 v39, v86, v87
    v_lshlrev_b32 v72, 16, v32
    v_and_b32 v73, s55, v32
    v_lshlrev_b32 v74, 16, v33
    v_and_b32 v75, s55, v33
    v_lshlrev_b32 v76, 16, v34
    v_and_b32 v77, s55, v34
    v_lshlrev_b32 v78, 16, v35
    v_and_b32 v79, s55, v35
    v_lshlrev_b32 v80, 16, v36
    v_and_b32 v81, s55, v36
    v_lshlrev_b32 v82, 16, v37
    v_and_b32 v83, s55, v37
    v_lshlrev_b32 v84, 16, v38
    v_and_b32 v85, s55, v38
    v_lshlrev_b32 v86, 16, v39
    v_and_b32 v87, s55, v39
    v_pk_mul_f32 v[72:73], v[72:73], v[104:105]
    v_pk_mul_f32 v[74:75], v[74:75], v[106:107]
    v_pk_mul_f32 v[76:77], v[76:77], v[108:109]
    v_pk_mul_f32 v[78:79], v[78:79], v[110:111]
    v_pk_mul_f32 v[80:81], v[80:81], v[112:113]
    v_pk_mul_f32 v[82:83], v[82:83], v[114:115]
    v_pk_mul_f32 v[84:85], v[84:85], v[116:117]
    v_pk_mul_f32 v[86:87], v[86:87], v[118:119]
    v_cvt_pk_bf16_f32 v40, v72, v73
    v_cvt_pk_bf16_f32 v41, v74, v75
    v_cvt_pk_bf16_f32 v42, v76, v77
    v_cvt_pk_bf16_f32 v43, v78, v79
    v_cvt_pk_bf16_f32 v44, v80, v81
    v_cvt_pk_bf16_f32 v45, v82, v83
    v_cvt_pk_bf16_f32 v46, v84, v85
    v_cvt_pk_bf16_f32 v47, v86, v87
    buffer_store_dwordx4 v[40:43], v7, s[48:51], s16 offen offset:0 sc1
    buffer_store_dwordx4 v[44:47], v7, s[48:51], s16 offen offset:1024 sc1
    v_dot2c_f32_bf16 v120, v32, v15
    v_dot2c_f32_bf16 v121, v32, v32
    v_dot2c_f32_bf16 v122, v33, v15
    v_dot2c_f32_bf16 v123, v33, v33
    v_dot2c_f32_bf16 v120, v34, v15
    v_dot2c_f32_bf16 v121, v34, v34
    v_dot2c_f32_bf16 v122, v35, v15
    v_dot2c_f32_bf16 v123, v35, v35
    v_dot2c_f32_bf16 v120, v36, v15
    v_dot2c_f32_bf16 v121, v36, v36
    v_dot2c_f32_bf16 v122, v37, v15
    v_dot2c_f32_bf16 v123, v37, v37
    v_dot2c_f32_bf16 v120, v38, v15
    v_dot2c_f32_bf16 v121, v38, v38
    v_dot2c_f32_bf16 v122, v39, v15
    v_dot2c_f32_bf16 v123, v39, v39
    s_nop 2
    v_pk_add_f32 v[120:121], v[120:121], v[122:123]
    s_nop 1
    v_permlane32_swap_b32 v120, v121
    v_add_f32 v120, v120, v121
    buffer_store_dword v120, v14, s[48:51], s17 offen sc1
    s_mov_b64 exec, 0xffff
    buffer_store_dwordx2 v[26:27], v29, s[48:51], s64 offen sc1
    s_mov_b64 exec, -1
    buffer_store_dwordx4 v[32:35], v7, s[48:51], s73 offen offset:0 sc1
    buffer_store_dwordx4 v[36:39], v7, s[48:51], s73 offen offset:1024 sc1
    ds_read_b128 v[68:71], v124 offset:9472
    ds_read_b128 v[72:75], v124 offset:9552
    ds_read_b128 v[76:79], v124 offset:9632
    ds_read_b128 v[80:83], v124 offset:9712
    ds_read_b128 v[84:87], v124 offset:9792
    s_waitcnt lgkmcnt(4)
    v_mfma_f32_16x16x32_bf16 v[156:159], v[68:71], a[0:3], 0
    s_add_u32 m0, s12, 155648
    s_nop 0
    buffer_load_dwordx4 v12, s[24:27], s57 offen lds
    v_mfma_f32_16x16x32_bf16 v[64:67], v[68:71], a[4:7], 0
    ds_read_b128 v[88:91], v124 offset:9872
    s_waitcnt lgkmcnt(4)
    v_mfma_f32_16x16x32_bf16 v[156:159], v[72:75], a[8:11], v[156:159]
    buffer_load_dwordx4 v21, s[24:27], s57 offen offset:1024 lds
    v_mfma_f32_16x16x32_bf16 v[64:67], v[72:75], a[12:15], v[64:67]
    ds_read_b128 v[68:71], v124 offset:9952
    s_waitcnt lgkmcnt(4)
    v_mfma_f32_16x16x32_bf16 v[156:159], v[76:79], a[16:19], v[156:159]
    v_mfma_f32_16x16x32_bf16 v[64:67], v[76:79], a[20:23], v[64:67]
    ds_read_b128 v[72:75], v124 offset:10032
    s_add_u32 m0, s12, 32768
    s_add_u32 s57, s7, 917504
    buffer_load_dwordx4 v11, s[20:23], s57 offen lds
    s_waitcnt lgkmcnt(4)
    v_mfma_f32_16x16x32_bf16 v[156:159], v[80:83], a[24:27], v[156:159]
    v_mfma_f32_16x16x32_bf16 v[64:67], v[80:83], a[28:31], v[64:67]
    ds_read_b128 v[76:79], v124 offset:10112
    buffer_load_dwordx4 v20, s[20:23], s57 offen offset:1024 lds
    s_waitcnt lgkmcnt(4)
    v_mfma_f32_16x16x32_bf16 v[156:159], v[84:87], a[32:35], v[156:159]
    v_mfma_f32_16x16x32_bf16 v[64:67], v[84:87], a[36:39], v[64:67]
    ds_read_b128 v[80:83], v124 offset:10192
    s_waitcnt lgkmcnt(4)
    v_mfma_f32_16x16x32_bf16 v[156:159], v[88:91], a[40:43], v[156:159]
    s_add_u32 m0, s12, 40960
    s_nop 0
    buffer_load_dwordx4 v12, s[24:27], s57 offen lds
    v_mfma_f32_16x16x32_bf16 v[64:67], v[88:91], a[44:47], v[64:67]
    ds_read_b128 v[84:87], v124 offset:10272
    s_waitcnt lgkmcnt(4)
    v_mfma_f32_16x16x32_bf16 v[156:159], v[68:71], a[48:51], v[156:159]
    v_mfma_f32_16x16x32_bf16 v[64:67], v[68:71], a[52:55], v[64:67]
    ds_read_b128 v[88:91], v124 offset:10352
    buffer_load_dwordx4 v21, s[24:27], s57 offen offset:1024 lds
    s_waitcnt lgkmcnt(4)
    v_mfma_f32_16x16x32_bf16 v[156:159], v[72:75], a[56:59], v[156:159]
    v_mfma_f32_16x16x32_bf16 v[64:67], v[72:75], a[60:63], v[64:67]
    ds_read_b128 v[68:71], v124 offset:10432
    s_waitcnt vmcnt(4)
    s_barrier
    s_add_u32 m0, s12, 49152
    s_add_u32 s57, s7, 1032192
    buffer_load_dwordx4 v11, s[20:23], s57 offen lds
    ds_read_b64_tr_b16 a[64:65], v18 offset:0
    ds_read_b64_tr_b16 a[66:67], v18 offset:2048
    buffer_load_dwordx4 v20, s[20:23], s57 offen offset:1024 lds
    ds_read_b64_tr_b16 a[68:69], v19 offset:0
    ds_read_b64_tr_b16 a[70:71], v19 offset:2048
    ds_read_b64_tr_b16 a[72:73], v18 offset:4096
    s_add_u32 m0, s12, 57344
    s_nop 0
    buffer_load_dwordx4 v12, s[24:27], s57 offen lds
    ds_read_b64_tr_b16 a[74:75], v18 offset:6144
    ds_read_b64_tr_b16 a[76:77], v19 offset:4096
    ds_read_b64_tr_b16 a[78:79], v19 offset:6144
    buffer_load_dwordx4 v21, s[24:27], s57 offen offset:1024 lds
    ds_read_b64_tr_b16 a[80:81], v18 offset:16384
    ds_read_b64_tr_b16 a[82:83], v18 offset:18432
    s_add_u32 m0, s12, 65536
    s_add_u32 s57, s7, 1146880
    buffer_load_dwordx4 v11, s[20:23], s57 offen lds
    ds_read_b64_tr_b16 a[84:85], v19 offset:16384
    ds_read_b64_tr_b16 a[86:87], v19 offset:18432
    ds_read_b64_tr_b16 a[88:89], v18 offset:20480
    buffer_load_dwordx4 v20, s[20:23], s57 offen offset:1024 lds
    ds_read_b64_tr_b16 a[90:91], v18 offset:22528
    ds_read_b64_tr_b16 a[92:93], v19 offset:20480
    ds_read_b64_tr_b16 a[94:95], v19 offset:22528
    s_add_u32 m0, s12, 73728
    s_nop 0
    buffer_load_dwordx4 v12, s[24:27], s57 offen lds
    ds_read_b64_tr_b16 a[96:97], v18 offset:32768
    ds_read_b64_tr_b16 a[98:99], v18 offset:34816
    buffer_load_dwordx4 v21, s[24:27], s57 offen offset:1024 lds
    ds_read_b64_tr_b16 a[100:101], v19 offset:32768
    ds_read_b64_tr_b16 a[102:103], v19 offset:34816
    ds_read_b64_tr_b16 a[104:105], v18 offset:36864
    s_add_u32 m0, s12, 81920
    s_add_u32 s57, s7, 1261568
    buffer_load_dwordx4 v11, s[20:23], s57 offen lds
    ds_read_b64_tr_b16 a[106:107], v18 offset:38912
    ds_read_b64_tr_b16 a[108:109], v19 offset:36864
    ds_read_b64_tr_b16 a[110:111], v19 offset:38912
    buffer_load_dwordx4 v20, s[20:23], s57 offen offset:1024 lds
    ds_read_b64_tr_b16 a[112:113], v18 offset:49152
    ds_read_b64_tr_b16 a[114:115], v18 offset:51200
    s_add_u32 m0, s12, 90112
    s_nop 0
    buffer_load_dwordx4 v12, s[24:27], s57 offen lds
    ds_read_b64_tr_b16 a[116:117], v19 offset:49152
    ds_read_b64_tr_b16 a[118:119], v19 offset:51200
    ds_read_b64_tr_b16 a[120:121], v18 offset:53248
    buffer_load_dwordx4 v21, s[24:27], s57 offen offset:1024 lds
    ds_read_b64_tr_b16 a[122:123], v18 offset:55296
    ds_read_b64_tr_b16 a[124:125], v19 offset:53248
    ds_read_b64_tr_b16 a[126:127], v19 offset:55296
    s_waitcnt lgkmcnt(0)
    s_barrier
    s_mov_b64 exec, 0xffff
    buffer_store_dwordx2 v[26:27], v29, s[48:51], s18 offen sc1
    s_mov_b64 exec, -1
    s_getpc_b64 s[74:75]
L_pc2:
    s_lshr_b32 s57, s2, 6
    s_lshr_b32 s56, s2, 3
    s_sub_u32 s57, s56, s57
    s_lshl_b32 s57, s57, 10
    v_lshl_add_u32 v8, v2, 7, s57
    v_min_u32 v8, L_end-L_pc2, v8
    v_mov_b32 v13, v23
    v_mov_b32 v23, v145
    v_mfma_f32_16x16x32_bf16 v[156:159], v[76:79], a[64:67], v[156:159]
    v_mfma_f32_16x16x32_bf16 v[64:67], v[76:79], a[68:71], v[64:67]
    ds_read_b128 v[72:75], v124 offset:10512
    v_mfma_f32_16x16x32_bf16 v[156:159], v[80:83], a[72:75], v[156:159]
    v_mfma_f32_16x16x32_bf16 v[64:67], v[80:83], a[76:79], v[64:67]
    ds_read_b128 v[76:79], v124 offset:10592
    v_mfma_f32_16x16x32_bf16 v[156:159], v[84:87], a[80:83], v[156:159]
    v_mfma_f32_16x16x32_bf16 v[64:67], v[84:87], a[84:87], v[64:67]
    ds_read_b128 v[80:83], v124 offset:10672
    v_mfma_f32_16x16x32_bf16 v[156:159], v[88:91], a[88:91], v[156:159]
    v_mfma_f32_16x16x32_bf16 v[64:67], v[88:91], a[92:95], v[64:67]
    ds_read_b128 v[84:87], v124 offset:10752
    v_mfma_f32_16x16x32_bf16 v[156:159], v[68:71], a[96:99], v[156:159]
    v_mfma_f32_16x16x32_bf16 v[64:67], v[68:71], a[100:103], v[64:67]
    ds_read_b128 v[88:91], v124 offset:10832
    s_waitcnt lgkmcnt(4)
    v_mfma_f32_16x16x32_bf16 v[156:159], v[72:75], a[104:107], v[156:159]
    v_mfma_f32_16x16x32_bf16 v[64:67], v[72:75], a[108:111], v[64:67]
    ds_read_b128 v[68:71], v124 offset:10912
    s_waitcnt lgkmcnt(4)
    v_mfma_f32_16x16x32_bf16 v[156:159], v[76:79], a[112:115], v[156:159]
    v_mfma_f32_16x16x32_bf16 v[64:67], v[76:79], a[116:119], v[64:67]
    ds_read_b128 v[72:75], v124 offset:10992
    s_waitcnt lgkmcnt(4)
    v_mfma_f32_16x16x32_bf16 v[156:159], v[80:83], a[120:123], v[156:159]
    v_mfma_f32_16x16x32_bf16 v[64:67], v[80:83], a[124:127], v[64:67]
    ds_read_b128 v[76:79], v124 offset:11072
    buffer_load_dwordx2 v[104:105], v147, s[48:51], s6 offen sc1
    s_add_u32 m0, s32, 131072
    s_add_u32 s56, s33, 0
    buffer_load_dwordx4 v7, s[48:51], s56 offen offset:0 sc1 lds
    buffer_load_dwordx4 v7, s[48:51], s56 offen offset:1024 sc1 lds
    buffer_load_dwordx4 v7, s[48:51], s56 offen offset:2048 sc1 lds
    s_waitcnt vmcnt(5)
    s_barrier
    buffer_load_dwordx4 v7, s[48:51], s56 offen offset:3072 sc1 lds
    ds_read_b64_tr_b16 a[128:129], v16 offset:0
    s_add_u32 m0, s32, 135168
    s_add_u32 s56, s33, 4096
    buffer_load_dwordx4 v7, s[48:51], s56 offen offset:0 sc1 lds
    ds_read_b64_tr_b16 a[130:131], v16 offset:2048
    buffer_load_dwordx4 v7, s[48:51], s56 offen offset:1024 sc1 lds
    ds_read_b64_tr_b16 a[132:133], v17 offset:0
    ds_read_b64_tr_b16 a[134:135], v17 offset:2048
    buffer_load_dwordx4 v7, s[48:51], s56 offen offset:2048 sc1 lds
    ds_read_b64_tr_b16 a[136:137], v16 offset:4096
    buffer_load_dwordx2 v[132:133], v125, s[48:51], s19 offen offset:0 sc1
    ds_read_b64_tr_b16 a[138:139], v16 offset:6144
    ds_read_b64_tr_b16 a[140:141], v17 offset:4096
    buffer_load_dwordx2 v[134:135], v125, s[48:51], s19 offen offset:256 sc1
    ds_read_b64_tr_b16 a[142:143], v17 offset:6144
    buffer_load_dwordx2 v[136:137], v125, s[48:51], s19 offen offset:512 sc1
    ds_read_b64_tr_b16 a[144:145], v16 offset:16384
    ds_read_b64_tr_b16 a[146:147], v16 offset:18432
    buffer_load_dwordx2 v[138:139], v125, s[48:51], s19 offen offset:768 sc1
    ds_read_b64_tr_b16 a[148:149], v17 offset:16384
    buffer_load_dwordx2 v[140:141], v125, s[48:51], s19 offen offset:1024 sc1
    ds_read_b64_tr_b16 a[150:151], v17 offset:18432
    ds_read_b64_tr_b16 a[152:153], v16 offset:20480
    buffer_load_dwordx2 v[142:143], v125, s[48:51], s19 offen offset:1280 sc1
    ds_read_b64_tr_b16 a[154:155], v16 offset:22528
    buffer_load_dwordx2 v[144:145], v125, s[48:51], s19 offen offset:1536 sc1
    ds_read_b64_tr_b16 a[156:157], v17 offset:20480
    ds_read_b64_tr_b16 a[158:159], v17 offset:22528
    s_waitcnt vmcnt(14)
    v_cmp_ne_u64 vcc, s[52:53], v[104:105]
    s_cbranch_vccnz L_xslow
L_xsok:
    global_load_dword v255, v8, s[74:75]
    s_waitcnt lgkmcnt(14)
    v_mfma_f32_16x16x32_bf16 v[156:159], v[84:87], a[128:131], v[156:159]
    s_waitcnt lgkmcnt(12)
    v_mfma_f32_16x16x32_bf16 v[64:67], v[84:87], a[132:135], v[64:67]
    ds_read_b128 v[80:83], v124 offset:11152
    s_waitcnt lgkmcnt(11)
    v_mfma_f32_16x16x32_bf16 v[156:159], v[88:91], a[136:139], v[156:159]
    s_waitcnt lgkmcnt(9)
    v_mfma_f32_16x16x32_bf16 v[64:67], v[88:91], a[140:143], v[64:67]
    ds_read_b128 v[84:87], v124 offset:11232
    s_waitcnt lgkmcnt(8)
    v_mfma_f32_16x16x32_bf16 v[156:159], v[68:71], a[144:147], v[156:159]
    s_waitcnt lgkmcnt(6)
    v_mfma_f32_16x16x32_bf16 v[64:67], v[68:71], a[148:151], v[64:67]
    ds_read_b128 v[88:91], v124 offset:11312
    s_waitcnt lgkmcnt(5)
    v_mfma_f32_16x16x32_bf16 v[156:159], v[72:75], a[152:155], v[156:159]
    s_waitcnt lgkmcnt(3)
    v_mfma_f32_16x16x32_bf16 v[64:67], v[72:75], a[156:159], v[64:67]
    ds_read_b128 v[68:71], v124 offset:11392
    v_mov_b32 v95, v124
    s_waitcnt vmcnt(8)
    s_waitcnt lgkmcnt(0)
    s_barrier
    ds_read_b128 v[116:119], v24 offset:28672
    ds_read_b128 v[120:123], v24 offset:29696
    ds_read_b128 v[124:127], v24 offset:30720
    s_waitcnt lgkmcnt(2)
    v_mfma_f32_32x32x16_bf16 v[32:47], a[0:3], v[116:119], 0
    ds_read_b128 v[128:131], v24 offset:31744
    s_add_u32 m0, s12, 32768
    s_add_u32 s57, s7, 1376256
    buffer_load_dwordx4 v11, s[20:23], s57 offen lds
    ds_read_b64_tr_b16 a[160:161], v16 offset:32768
    ds_read_b64_tr_b16 a[162:163], v16 offset:34816
    v_mfma_f32_32x32x16_bf16 v[48:63], a[4:7], v[116:119], 0
    buffer_load_dwordx4 v20, s[20:23], s57 offen offset:1024 lds
    ds_read_b64_tr_b16 a[164:165], v17 offset:32768
    ds_read_b64_tr_b16 a[166:167], v17 offset:34816
    s_waitcnt lgkmcnt(6)
    v_mfma_f32_32x32x16_bf16 v[32:47], a[8:11], v[120:123], v[32:47]
    ds_read_b128 v[116:119], v24 offset:32768
    ds_read_b64_tr_b16 a[168:169], v16 offset:36864
    ds_read_b64_tr_b16 a[170:171], v16 offset:38912
    v_mfma_f32_32x32x16_bf16 v[48:63], a[12:15], v[120:123], v[48:63]
    s_add_u32 m0, s12, 40960
    s_nop 0
    buffer_load_dwordx4 v12, s[24:27], s57 offen lds
    ds_read_b64_tr_b16 a[172:173], v17 offset:36864
    ds_read_b64_tr_b16 a[174:175], v17 offset:38912
    s_waitcnt lgkmcnt(10)
    v_mfma_f32_32x32x16_bf16 v[32:47], a[16:19], v[124:127], v[32:47]
    ds_read_b128 v[120:123], v24 offset:33792
    ds_read_b64_tr_b16 a[176:177], v16 offset:49152
    ds_read_b64_tr_b16 a[178:179], v16 offset:51200
    v_mfma_f32_32x32x16_bf16 v[48:63], a[20:23], v[124:127], v[48:63]
    buffer_load_dwordx4 v21, s[24:27], s57 offen offset:1024 lds
    ds_read_b64_tr_b16 a[180:181], v17 offset:49152
    ds_read_b64_tr_b16 a[182:183], v17 offset:51200
    s_waitcnt lgkmcnt(14)
    v_mfma_f32_32x32x16_bf16 v[32:47], a[24:27], v[128:131], v[32:47]
    ds_read_b128 v[124:127], v24 offset:34816
    ds_read_b64_tr_b16 a[184:185], v16 offset:53248
    ds_read_b64_tr_b16 a[186:187], v16 offset:55296
    v_mfma_f32_32x32x16_bf16 v[48:63], a[28:31], v[128:131], v[48:63]
    s_add_u32 m0, s12, 49152
    s_add_u32 s57, s7, 1490944
    buffer_load_dwordx4 v11, s[20:23], s57 offen lds
    ds_read_b64_tr_b16 a[188:189], v17 offset:53248
    ds_read_b64_tr_b16 a[190:191], v17 offset:55296
    s_waitcnt lgkmcnt(14)
    v_mfma_f32_32x32x16_bf16 v[32:47], a[32:35], v[116:119], v[32:47]
    ds_read_b128 v[128:131], v24 offset:35840
    v_mfma_f32_32x32x16_bf16 v[48:63], a[36:39], v[116:119], v[48:63]
    buffer_load_dwordx4 v20, s[20:23], s57 offen offset:1024 lds
    s_waitcnt lgkmcnt(10)
    v_mfma_f32_32x32x16_bf16 v[32:47], a[40:43], v[120:123], v[32:47]
    v_mfma_f32_16x16x32_bf16 v[64:67], v[76:79], a[164:167], v[64:67]
    ds_read_b128 v[72:75], v95 offset:11472
    v_mfma_f32_16x16x32_bf16 v[156:159], v[76:79], a[160:163], v[156:159]
    ds_read_b128 v[116:119], v24 offset:36864
    v_mfma_f32_32x32x16_bf16 v[48:63], a[44:47], v[120:123], v[48:63]
    v_mfma_f32_16x16x32_bf16 v[64:67], v[80:83], a[172:175], v[64:67]
    ds_read_b128 v[76:79], v95 offset:11552
    v_mfma_f32_16x16x32_bf16 v[156:159], v[80:83], a[168:171], v[156:159]
    buffer_load_dwordx2 v[30:31], v23, s[48:51], 0 offen sc1
    s_waitcnt lgkmcnt(8)
    v_mfma_f32_32x32x16_bf16 v[32:47], a[48:51], v[124:127], v[32:47]
    v_mfma_f32_16x16x32_bf16 v[64:67], v[84:87], a[180:183], v[64:67]
    ds_read_b128 v[80:83], v95 offset:11632
    v_mfma_f32_16x16x32_bf16 v[156:159], v[84:87], a[176:179], v[156:159]
    ds_read_b128 v[120:123], v24 offset:37888
    v_mfma_f32_32x32x16_bf16 v[48:63], a[52:55], v[124:127], v[48:63]
    s_waitcnt lgkmcnt(6)
    v_mfma_f32_16x16x32_bf16 v[64:67], v[88:91], a[188:191], v[64:67]
    v_mfma_f32_16x16x32_bf16 v[156:159], v[88:91], a[184:187], v[156:159]
    s_add_u32 m0, s12, 57344
    s_nop 0
    buffer_load_dwordx4 v12, s[24:27], s57 offen lds
    s_waitcnt lgkmcnt(5)
    v_mfma_f32_32x32x16_bf16 v[32:47], a[56:59], v[128:131], v[32:47]
    ds_read_b128 v[124:127], v24 offset:38912
    v_mfma_f32_32x32x16_bf16 v[48:63], a[60:63], v[128:131], v[48:63]
    buffer_load_dwordx4 v21, s[24:27], s57 offen offset:1024 lds
    s_waitcnt lgkmcnt(4)
    v_mfma_f32_32x32x16_bf16 v[32:47], a[64:67], v[116:119], v[32:47]
    ds_read_b128 v[128:131], v24 offset:39936
    v_mfma_f32_32x32x16_bf16 v[48:63], a[68:71], v[116:119], v[48:63]
    s_add_u32 m0, s32, 102400
    s_add_u32 s56, s34, 0
    buffer_load_dwordx4 v7, s[48:51], s56 offen offset:0 sc1 lds
    s_waitcnt vmcnt(16)
    v_add_f32 v132, v132, v134
    v_add_f32 v133, v133, v135
    s_waitcnt lgkmcnt(2)
    v_mfma_f32_32x32x16_bf16 v[32:47], a[72:75], v[120:123], v[32:47]
    ds_read_b128 v[116:119], v24 offset:40960
    s_waitcnt vmcnt(14)
    v_add_f32 v136, v136, v138
    v_add_f32 v137, v137, v139
    s_waitcnt vmcnt(12)
    v_add_f32 v140, v140, v142
    v_add_f32 v141, v141, v143
    v_add_f32 v132, v132, v136
    v_mfma_f32_32x32x16_bf16 v[48:63], a[76:79], v[120:123], v[48:63]
    buffer_load_dwordx4 v7, s[48:51], s56 offen offset:1024 sc1 lds
    v_add_f32 v133, v133, v137
    s_waitcnt vmcnt(12)
    v_add_f32 v140, v140, v144
    v_add_f32 v141, v141, v145
    v_add_f32 v132, v132, v140
    s_waitcnt lgkmcnt(2)
    v_mfma_f32_32x32x16_bf16 v[32:47], a[80:83], v[124:127], v[32:47]
    ds_read_b128 v[120:123], v24 offset:41984
    buffer_load_dwordx4 v7, s[48:51], s56 offen offset:2048 sc1 lds
    v_add_f32 v133, v133, v141
    v_mfma_f32_32x32x16_bf16 v[48:63], a[84:87], v[124:127], v[48:63]
    v_cmp_u_f32 vcc, v132, v133
    s_cbranch_vccnz L_sredo
L_sok:
    v_mov_b32 v134, v132
    v_mov_b32 v135, v133
    s_lshl_b32 s74, s3, 10
    s_waitcnt lgkmcnt(2)
    v_mfma_f32_32x32x16_bf16 v[32:47], a[88:91], v[128:131], v[32:47]
    ds_read_b128 v[124:127], v24 offset:43008
    buffer_load_dwordx4 v7, s[48:51], s56 offen offset:3072 sc1 lds
    s_lshl_b32 s75, s3, 9
    v_permlane32_swap_b32 v132, v134
    v_mfma_f32_32x32x16_bf16 v[48:63], a[92:95], v[128:131], v[48:63]
    v_permlane32_swap_b32 v133, v135
    v_add_f32 v132, v132, v134
    v_add_f32 v133, v133, v135
    v_mul_f32 v132, 0xbb124925, v132
    v_mul_f32 v133, 0x3b124925, v133
    s_waitcnt lgkmcnt(2)
    v_mfma_f32_32x32x16_bf16 v[32:47], a[96:99], v[116:119], v[32:47]
    ds_read_b128 v[128:131], v24 offset:44032
    s_add_u32 m0, s32, 106496
    s_add_u32 s56, s34, 4096
    buffer_load_dwordx4 v7, s[48:51], s56 offen offset:0 sc1 lds
    v_cvt_pk_bf16_f32 v140, v132, v132
    v_mfma_f32_32x32x16_bf16 v[48:63], a[100:103], v[116:119], v[48:63]
    v_fma_f32 v133, -v132, v132, v133
    v_and_b32 v141, s55, v140
    v_max_f32 v133, 0, v133
    v_sub_f32 v141, v132, v141
    v_add_f32 v138, 0x3727c5ac, v133
    v_cvt_pk_bf16_f32 v141, v141, v141
    s_waitcnt lgkmcnt(2)
    v_mfma_f32_32x32x16_bf16 v[32:47], a[104:107], v[120:123], v[32:47]
    ds_read_b128 v[116:119], v24 offset:45056
    buffer_load_dwordx4 v7, s[48:51], s56 offen offset:1024 sc1 lds
    v_rsq_f32 v134, v138
    v_cmp_gt_u32 vcc, 32, v0
    v_mfma_f32_32x32x16_bf16 v[48:63], a[108:111], v[120:123], v[48:63]
    v_mul_f32 v135, v138, v134
    v_mul_f32 v136, 0xc0135761, v134
    v_mul_f32 v137, v134, v134
    v_cvt_pk_bf16_f32 v142, v135, v135
    v_mul_f32 v137, v137, v136
    v_and_b32 v143, s55, v142
    s_waitcnt lgkmcnt(2)
    v_mfma_f32_32x32x16_bf16 v[32:47], a[112:115], v[124:127], v[32:47]
    ds_read_b128 v[120:123], v24 offset:46080
    buffer_load_dwordx4 v7, s[48:51], s56 offen offset:2048 sc1 lds
    v_mul_f32 v137, 0x3d372713, v137
    v_sub_f32 v143, v135, v143
    v_add_u32 v14, s74, v7
    v_mfma_f32_32x32x16_bf16 v[48:63], a[116:119], v[124:127], v[48:63]
    v_cvt_pk_bf16_f32 v143, v143, v143
    v_add_u32 v15, s75, v13
    v_cndmask_b32 v140, 0, v140, vcc
    v_cndmask_b32 v141, 0, v141, vcc
    v_cndmask_b32 v142, 0, v142, vcc
    v_cndmask_b32 v143, 0, v143, vcc
    s_waitcnt lgkmcnt(2)
    v_mfma_f32_32x32x16_bf16 v[32:47], a[120:123], v[128:131], v[32:47]
    ds_read_b128 v[124:127], v24 offset:47104
    s_waitcnt vmcnt(7)
    s_barrier
    v_mfma_f32_32x32x16_bf16 v[48:63], a[124:127], v[128:131], v[48:63]
    ds_read_b64_tr_b16 a[192:193], v16 offset:0
    ds_read_b64_tr_b16 a[194:195], v16 offset:2048
    ds_read_b64_tr_b16 a[196:197], v17 offset:0
    s_waitcnt lgkmcnt(5)
    v_mfma_f32_32x32x16_bf16 v[32:47], a[128:131], v[116:119], v[32:47]
    ds_read_b128 v[128:131], v24 offset:48128
    ds_read_b64_tr_b16 a[198:199], v17 offset:2048
    ds_read_b64_tr_b16 a[200:201], v16 offset:4096
    ds_read_b64_tr_b16 a[202:203], v16 offset:6144
    v_mfma_f32_32x32x16_bf16 v[48:63], a[132:135], v[116:119], v[48:63]
    ds_read_b64_tr_b16 a[204:205], v17 offset:4096
    ds_read_b64_tr_b16 a[206:207], v17 offset:6144
    ds_read_b64_tr_b16 a[208:209], v16 offset:16384
    v_cmp_ne_u64 vcc, s[52:53], v[30:31]
    s_cbranch_vccnz L_pfslow0
L_pfok0:
    s_waitcnt lgkmcnt(11)
    v_mfma_f32_32x32x16_bf16 v[32:47], a[136:139], v[120:123], v[32:47]
    ds_read_b128 v[116:119], v24 offset:49152
    s_add_u32 s57, s35, 0
    buffer_load_dwordx4 v[160:163], v7, s[48:51], s57 offen offset:0 sc1
    ds_read_b64_tr_b16 a[210:211], v16 offset:18432
    ds_read_b64_tr_b16 a[212:213], v17 offset:16384
    ds_read_b64_tr_b16 a[214:215], v17 offset:18432
    v_mfma_f32_32x32x16_bf16 v[48:63], a[140:143], v[120:123], v[48:63]
    buffer_load_dwordx4 v[164:167], v7, s[48:51], s57 offen offset:1024 sc1
    ds_read_b64_tr_b16 a[216:217], v16 offset:20480
    ds_read_b64_tr_b16 a[218:219], v16 offset:22528
    ds_read_b64_tr_b16 a[220:221], v17 offset:20480
    s_waitcnt lgkmcnt(14)
    v_mfma_f32_32x32x16_bf16 v[32:47], a[144:147], v[124:127], v[32:47]
    ds_read_b128 v[120:123], v24 offset:50176
    ds_read_b64_tr_b16 a[222:223], v17 offset:22528
    v_mfma_f32_32x32x16_bf16 v[48:63], a[148:151], v[124:127], v[48:63]
    buffer_load_dwordx4 v[168:171], v7, s[48:51], s57 offen offset:2048 sc1
    s_waitcnt lgkmcnt(14)
    v_mfma_f32_32x32x16_bf16 v[32:47], a[152:155], v[128:131], v[32:47]
    v_mfma_f32_16x16x32_bf16 v[64:67], v[68:71], a[196:199], v[64:67]
    v_mfma_f32_16x16x32_bf16 v[156:159], v[68:71], a[192:195], v[156:159]
    ds_read_b128 v[124:127], v24 offset:51200
    v_mfma_f32_32x32x16_bf16 v[48:63], a[156:159], v[128:131], v[48:63]
    s_waitcnt lgkmcnt(11)
    v_mfma_f32_16x16x32_bf16 v[64:67], v[72:75], a[204:207], v[64:67]
    v_mfma_f32_16x16x32_bf16 v[156:159], v[72:75], a[200:203], v[156:159]
    buffer_load_dwordx4 v[172:175], v7, s[48:51], s57 offen offset:3072 sc1
    s_waitcnt lgkmcnt(9)
    v_mfma_f32_32x32x16_bf16 v[32:47], a[160:163], v[116:119], v[32:47]
    s_waitcnt lgkmcnt(6)
    v_mfma_f32_16x16x32_bf16 v[64:67], v[76:79], a[212:215], v[64:67]
    v_mfma_f32_16x16x32_bf16 v[156:159], v[76:79], a[208:211], v[156:159]
    ds_read_b128 v[128:131], v24 offset:52224
    v_mfma_f32_32x32x16_bf16 v[48:63], a[164:167], v[116:119], v[48:63]
    s_waitcnt lgkmcnt(2)
    v_mfma_f32_16x16x32_bf16 v[64:67], v[80:83], a[220:223], v[64:67]
    v_mfma_f32_16x16x32_bf16 v[156:159], v[80:83], a[216:219], v[156:159]
    ds_write_b128 v14, v[140:143] offset:11776
    ds_write_b128 v15, v[136:139] offset:0
    s_add_u32 s57, s35, 16384
    buffer_load_dwordx4 v[176:179], v7, s[48:51], s57 offen offset:0 sc1
    v_mfma_f32_32x32x16_bf16 v[32:47], a[168:171], v[120:123], v[32:47]
    ds_read_b128 v[116:119], v24 offset:53248
    buffer_load_dwordx4 v[180:183], v7, s[48:51], s57 offen offset:1024 sc1
    v_mfma_f32_32x32x16_bf16 v[48:63], a[172:175], v[120:123], v[48:63]
    s_waitcnt lgkmcnt(4)
    v_mfma_f32_32x32x16_bf16 v[32:47], a[176:179], v[124:127], v[32:47]
    ds_read_b128 v[120:123], v24 offset:54272
    s_waitcnt lgkmcnt(2)
    s_barrier
    v_and_b32 v8, 1, v5
    v_cmp_eq_u32 vcc, 1, v8
    s_nop 1
    v_cndmask_b32 v148, v156, v157, vcc
    v_cndmask_b32 v150, v158, v159, vcc
    v_mfma_f32_32x32x16_bf16 v[48:63], a[180:183], v[124:127], v[48:63]
    s_add_u32 m0, s32, 16384
    s_add_u32 s56, s33, 65536
    buffer_load_dwordx4 v7, s[48:51], s56 offen offset:0 sc1 lds
    v_cndmask_b32 v152, v64, v65, vcc
    v_cndmask_b32 v154, v66, v67, vcc
    v_cvt_pk_bf16_f32 v149, v148, v148
    v_mfma_f32_32x32x16_bf16 v[32:47], a[184:187], v[128:131], v[32:47]
    ds_read_b128 v[124:127], v24 offset:55296
    buffer_load_dwordx4 v7, s[48:51], s56 offen offset:1024 sc1 lds
    v_cvt_pk_bf16_f32 v151, v150, v150
    v_cvt_pk_bf16_f32 v153, v152, v152
    v_cvt_pk_bf16_f32 v155, v154, v154
    v_and_b32 v149, s55, v149
    v_mfma_f32_32x32x16_bf16 v[48:63], a[188:191], v[128:131], v[48:63]
    v_and_b32 v151, s55, v151
    v_and_b32 v153, s55, v153
    v_and_b32 v155, s55, v155
    v_sub_f32 v148, v148, v149
    v_sub_f32 v150, v150, v151
    v_sub_f32 v152, v152, v153
    v_sub_f32 v154, v154, v155
    s_waitcnt lgkmcnt(2)
    v_mfma_f32_32x32x16_bf16 v[32:47], a[192:195], v[116:119], v[32:47]
    ds_read_b128 v[128:131], v24 offset:56320
    buffer_load_dwordx4 v7, s[48:51], s56 offen offset:2048 sc1 lds
    v_cvt_pk_bf16_f32 v96, v149, v148
    v_cvt_pk_bf16_f32 v98, v151, v150
    v_cvt_pk_bf16_f32 v100, v153, v152
    v_cvt_pk_bf16_f32 v102, v155, v154
    v_mfma_f32_32x32x16_bf16 v[48:63], a[196:199], v[116:119], v[48:63]
    v_mov_b32 v97, v96
    v_mov_b32 v99, v98
    v_mov_b32 v101, v100
    v_mov_b32 v103, v102
    v_add_u32 v16, s32, v7
    v_add_u32 v17, 73728, v16
    v_add_u32 v16, 16384, v16
    s_waitcnt lgkmcnt(2)
    v_mfma_f32_32x32x16_bf16 v[32:47], a[200:203], v[120:123], v[32:47]
    buffer_load_dwordx4 v7, s[48:51], s56 offen offset:3072 sc1 lds
    ds_read_b128 v[104:107], v7 offset:11776
    v_and_b32 v23, 1, v0
    v_lshlrev_b32 v23, 7, v23
    v_mfma_f32_32x32x16_bf16 v[48:63], a[204:207], v[120:123], v[48:63]
    ds_read_b128 v[108:111], v13 offset:0
    s_waitcnt lgkmcnt(3)
    v_mfma_f32_32x32x16_bf16 v[32:47], a[208:211], v[124:127], v[32:47]
    s_add_u32 m0, s32, 20480
    s_add_u32 s56, s33, 69632
    buffer_load_dwordx4 v7, s[48:51], s56 offen offset:0 sc1 lds
    v_mfma_f32_32x32x16_bf16 v[48:63], a[212:215], v[124:127], v[48:63]
    buffer_load_dwordx4 v7, s[48:51], s56 offen offset:1024 sc1 lds
    s_waitcnt lgkmcnt(2)
    v_mfma_f32_32x32x16_bf16 v[32:47], a[216:219], v[128:131], v[32:47]
    s_waitcnt vmcnt(12)
    s_barrier
    ds_read_b128 v[116:119], v24 offset:0
    ds_read_b128 v[120:123], v24 offset:1024
    v_mfma_f32_32x32x16_bf16 v[48:63], a[220:223], v[128:131], v[48:63]
    buffer_load_dwordx4 v7, s[48:51], s56 offen offset:2048 sc1 lds
    ds_read_b128 v[124:127], v24 offset:2048
    s_waitcnt lgkmcnt(4)
    v_mfma_f32_32x32x16_bf16 v[32:47], v[96:99], v[104:107], v[32:47]
    v_mfma_f32_32x32x16_bf16 v[48:63], v[100:103], v[104:107], v[48:63]
    s_add_u32 s76, s77, 1013760
    buffer_load_dwordx2 v[30:31], v23, s[48:51], s76 offen sc1
    s_waitcnt lgkmcnt(2)
    v_mfma_f32_32x32x16_bf16 v[64:79], a[0:3], v[116:119], 0
    ds_read_b128 v[128:131], v24 offset:3072
    v_mfma_f32_32x32x16_bf16 v[80:95], a[4:7], v[116:119], 0
    s_add_u32 s57, s35, 16384
    buffer_load_dwordx4 v[184:187], v7, s[48:51], s57 offen offset:2048 sc1
    s_waitcnt lgkmcnt(2)
    v_mfma_f32_32x32x16_bf16 v[64:79], a[8:11], v[120:123], v[64:79]
    ds_read_b128 v[116:119], v24 offset:4096
    v_cmp_u_f32 vcc, v32, v32
    s_cbranch_vccnz L_xredo0
L_xok0:
    v_mfma_f32_32x32x16_bf16 v[80:95], a[12:15], v[120:123], v[80:95]
    buffer_load_dwordx4 v[188:191], v7, s[48:51], s57 offen offset:3072 sc1
    v_mul_f32 v132, v32, v32
    v_mul_f32 v133, v33, v33
    v_fma_f32 v132, v132, v109, v108
    v_mul_f32 v134, v34, v34
    s_waitcnt lgkmcnt(2)
    v_mfma_f32_32x32x16_bf16 v[64:79], a[16:19], v[124:127], v[64:79]
    ds_read_b128 v[120:123], v24 offset:5120
    v_fma_f32 v133, v133, v109, v108
    v_mul_f32 v132, v32, v132
    v_mul_f32 v135, v35, v35
    v_fma_f32 v134, v134, v109, v108
    v_mfma_f32_32x32x16_bf16 v[80:95], a[20:23], v[124:127], v[80:95]
    s_add_u32 s57, s35, 32768
    buffer_load_dwordx4 v[192:195], v7, s[48:51], s57 offen offset:0 sc1
    v_exp_f32 v132, v132
    v_mul_f32 v133, v33, v133
    s_waitcnt lgkmcnt(2)
    v_mfma_f32_32x32x16_bf16 v[64:79], a[24:27], v[128:131], v[64:79]
    ds_read_b128 v[124:127], v24 offset:6144
    v_mul_f32 v136, v36, v36
    v_fma_f32 v135, v135, v109, v108
    v_exp_f32 v133, v133
    v_mul_f32 v134, v34, v134
    v_mfma_f32_32x32x16_bf16 v[80:95], a[28:31], v[128:131], v[80:95]
    buffer_load_dwordx4 v[196:199], v7, s[48:51], s57 offen offset:1024 sc1
    v_mul_f32 v140, v32, v40
    v_fma_f32 v132, v132, v110, v110
    v_mul_f32 v137, v37, v37
    v_fma_f32 v136, v136, v109, v108
    s_waitcnt lgkmcnt(2)
    v_mfma_f32_32x32x16_bf16 v[64:79], a[32:35], v[116:119], v[64:79]
    ds_read_b128 v[128:131], v24 offset:7168
    v_exp_f32 v134, v134
    v_mul_f32 v135, v35, v135
    v_mul_f32 v141, v33, v41
    v_fma_f32 v133, v133, v110, v110
    v_mfma_f32_32x32x16_bf16 v[80:95], a[36:39], v[116:119], v[80:95]
    buffer_load_dwordx4 v[200:203], v7, s[48:51], s57 offen offset:2048 sc1
    v_rcp_f32 v132, v132
    v_mul_f32 v138, v38, v38
    v_fma_f32 v137, v137, v109, v108
    s_waitcnt lgkmcnt(2)
    v_mfma_f32_32x32x16_bf16 v[64:79], a[40:43], v[120:123], v[64:79]
    ds_read_b128 v[116:119], v24 offset:8192
    v_exp_f32 v135, v135
    v_mul_f32 v136, v36, v136
    v_mul_f32 v142, v34, v42
    v_fma_f32 v134, v134, v110, v110
    v_mfma_f32_32x32x16_bf16 v[80:95], a[44:47], v[120:123], v[80:95]
    buffer_load_dwordx4 v[204:207], v7, s[48:51], s57 offen offset:3072 sc1
    v_rcp_f32 v133, v133
    v_mul_f32 v140, v140, v132
    v_mul_f32 v139, v39, v39
    s_waitcnt lgkmcnt(2)
    v_mfma_f32_32x32x16_bf16 v[64:79], a[48:51], v[124:127], v[64:79]
    ds_read_b128 v[120:123], v24 offset:9216
    v_fma_f32 v138, v138, v109, v108
    v_exp_f32 v136, v136
    v_mul_f32 v137, v37, v137
    v_mul_f32 v143, v35, v43
    v_mfma_f32_32x32x16_bf16 v[80:95], a[52:55], v[124:127], v[80:95]
    s_add_u32 s57, s35, 49152
    buffer_load_dwordx4 v[208:211], v7, s[48:51], s57 offen offset:0 sc1
    v_fma_f32 v135, v135, v110, v110
    v_rcp_f32 v134, v134
    s_waitcnt lgkmcnt(2)
    v_mfma_f32_32x32x16_bf16 v[64:79], a[56:59], v[128:131], v[64:79]
    ds_read_b128 v[124:127], v24 offset:10240
    v_mul_f32 v141, v141, v133
    v_mul_f32 v132, v48, v48
    v_fma_f32 v139, v139, v109, v108
    v_exp_f32 v137, v137
    v_mfma_f32_32x32x16_bf16 v[80:95], a[60:63], v[128:131], v[80:95]
    buffer_load_dwordx4 v[212:215], v7, s[48:51], s57 offen offset:1024 sc1
    v_mul_f32 v138, v38, v138
    v_mul_f32 v144, v36, v44
    v_fma_f32 v136, v136, v110, v110
    s_waitcnt lgkmcnt(2)
    v_mfma_f32_32x32x16_bf16 v[64:79], a[64:67], v[116:119], v[64:79]
    ds_read_b128 v[128:131], v24 offset:11264
    v_rcp_f32 v135, v135
    v_mul_f32 v142, v142, v134
    v_cvt_pk_bf16_f32 v148, v140, v141
    v_mul_f32 v133, v49, v49
    v_mfma_f32_32x32x16_bf16 v[80:95], a[68:71], v[116:119], v[80:95]
    s_add_u32 m0, s32, 45056
    s_add_u32 s56, s34, 65536
    buffer_load_dwordx4 v7, s[48:51], s56 offen offset:0 sc1 lds
    v_fma_f32 v132, v132, v109, v108
    s_waitcnt lgkmcnt(2)
    v_mfma_f32_32x32x16_bf16 v[64:79], a[72:75], v[120:123], v[64:79]
    ds_read_b128 v[116:119], v24 offset:12288
    v_exp_f32 v138, v138
    v_mul_f32 v139, v39, v139
    v_mul_f32 v145, v37, v45
    v_fma_f32 v137, v137, v110, v110
    v_mfma_f32_32x32x16_bf16 v[80:95], a[76:79], v[120:123], v[80:95]
    buffer_load_dwordx4 v7, s[48:51], s56 offen offset:1024 sc1 lds
    v_rcp_f32 v136, v136
    v_mul_f32 v143, v143, v135
    v_mul_f32 v134, v50, v50
    s_waitcnt lgkmcnt(2)
    v_mfma_f32_32x32x16_bf16 v[64:79], a[80:83], v[124:127], v[64:79]
    ds_read_b128 v[120:123], v24 offset:13312
    v_fma_f32 v133, v133, v109, v108
    v_exp_f32 v139, v139
    v_mul_f32 v132, v48, v132
    v_mul_f32 v146, v38, v46
    v_mfma_f32_32x32x16_bf16 v[80:95], a[84:87], v[124:127], v[80:95]
    v_fma_f32 v138, v138, v110, v110
    v_rcp_f32 v137, v137
    v_mul_f32 v144, v144, v136
    v_cvt_pk_bf16_f32 v149, v142, v143
    v_mul_f32 v135, v51, v51
    s_waitcnt lgkmcnt(2)
    v_mfma_f32_32x32x16_bf16 v[64:79], a[88:91], v[128:131], v[64:79]
    ds_read_b128 v[124:127], v24 offset:14336
    buffer_load_dwordx4 v7, s[48:51], s56 offen offset:2048 sc1 lds
    s_waitcnt vmcnt(11)
    v_cmp_ne_u64 vcc, s[52:53], v[30:31]
    s_cbranch_vccnz L_pfslow1
L_pfok1:
    v_mfma_f32_32x32x16_bf16 v[80:95], a[92:95], v[128:131], v[80:95]
    v_fma_f32 v134, v134, v109, v108
    v_exp_f32 v132, v132
    v_mul_f32 v133, v49, v133
    v_mul_f32 v147, v39, v47
    v_fma_f32 v139, v139, v110, v110
    s_waitcnt lgkmcnt(2)
    v_mfma_f32_32x32x16_bf16 v[64:79], a[96:99], v[116:119], v[64:79]
    ds_read_b128 v[128:131], v24 offset:15360
    buffer_load_dwordx4 v7, s[48:51], s56 offen offset:3072 sc1 lds
    v_rcp_f32 v138, v138
    v_mul_f32 v145, v145, v137
    v_mfma_f32_32x32x16_bf16 v[80:95], a[100:103], v[116:119], v[80:95]
    v_mul_f32 v136, v52, v52
    v_fma_f32 v135, v135, v109, v108
    v_exp_f32 v133, v133
    v_mul_f32 v134, v50, v134
    v_mul_f32 v140, v48, v56
    s_waitcnt lgkmcnt(2)
    v_mfma_f32_32x32x16_bf16 v[64:79], a[104:107], v[120:123], v[64:79]
    ds_read_b128 v[116:119], v24 offset:16384
    s_add_u32 m0, s32, 49152
    s_add_u32 s56, s34, 69632
    buffer_load_dwordx4 v7, s[48:51], s56 offen offset:0 sc1 lds
    v_fma_f32 v132, v132, v110, v110
    v_mfma_f32_32x32x16_bf16 v[80:95], a[108:111], v[120:123], v[80:95]
    v_rcp_f32 v139, v139
    v_mul_f32 v146, v146, v138
    v_cvt_pk_bf16_f32 v150, v144, v145
    v_mul_f32 v137, v53, v53
    v_fma_f32 v136, v136, v109, v108
    s_waitcnt lgkmcnt(2)
    v_mfma_f32_32x32x16_bf16 v[64:79], a[112:115], v[124:127], v[64:79]
    ds_read_b128 v[120:123], v24 offset:17408
    buffer_load_dwordx4 v7, s[48:51], s56 offen offset:1024 sc1 lds
    v_exp_f32 v134, v134
    v_mul_f32 v135, v51, v135
    v_mfma_f32_32x32x16_bf16 v[80:95], a[116:119], v[124:127], v[80:95]
    v_mul_f32 v141, v49, v57
    v_fma_f32 v133, v133, v110, v110
    v_rcp_f32 v132, v132
    v_mul_f32 v147, v147, v139
    v_mul_f32 v138, v54, v54
    s_waitcnt lgkmcnt(2)
    v_mfma_f32_32x32x16_bf16 v[64:79], a[120:123], v[128:131], v[64:79]
    ds_read_b128 v[124:127], v24 offset:18432
    buffer_load_dwordx4 v7, s[48:51], s56 offen offset:2048 sc1 lds
    v_fma_f32 v137, v137, v109, v108
    v_exp_f32 v135, v135
    v_mfma_f32_32x32x16_bf16 v[80:95], a[124:127], v[128:131], v[80:95]
    v_mul_f32 v136, v52, v136
    v_mul_f32 v142, v50, v58
    v_fma_f32 v134, v134, v110, v110
    v_rcp_f32 v133, v133
    v_mul_f32 v140, v140, v132
    s_waitcnt lgkmcnt(2)
    v_mfma_f32_32x32x16_bf16 v[64:79], a[128:131], v[116:119], v[64:79]
    ds_read_b128 v[128:131], v24 offset:19456
    s_add_u32 s57, s35, 49152
    buffer_load_dwordx4 v[216:219], v7, s[48:51], s57 offen offset:2048 sc1
    v_cvt_pk_bf16_f32 v151, v146, v147
    v_mfma_f32_32x32x16_bf16 v[80:95], a[132:135], v[116:119], v[80:95]
    buffer_store_dwordx4 v[148:151], v7, s[48:51], s37 offen offset:0 sc1
    v_mul_f32 v139, v55, v55
    v_fma_f32 v138, v138, v109, v108
    v_exp_f32 v136, v136
    s_waitcnt lgkmcnt(2)
    v_mfma_f32_32x32x16_bf16 v[64:79], a[136:139], v[120:123], v[64:79]
    ds_read_b128 v[116:119], v24 offset:20480
    buffer_load_dwordx4 v[220:223], v7, s[48:51], s57 offen offset:3072 sc1
    v_mul_f32 v137, v53, v137
    v_mul_f32 v143, v51, v59
    v_fma_f32 v135, v135, v110, v110
    v_mfma_f32_32x32x16_bf16 v[80:95], a[140:143], v[120:123], v[80:95]
    v_rcp_f32 v134, v134
    v_mul_f32 v141, v141, v133
    v_fma_f32 v139, v139, v109, v108
    v_exp_f32 v137, v137
    s_waitcnt lgkmcnt(2)
    v_mfma_f32_32x32x16_bf16 v[64:79], a[144:147], v[124:127], v[64:79]
    ds_read_b128 v[120:123], v24 offset:21504
    s_add_u32 s57, s35, 65536
    buffer_load_dwordx4 v[224:227], v7, s[48:51], s57 offen offset:0 sc1
    v_mul_f32 v138, v54, v138
    v_mul_f32 v144, v52, v60
    v_mfma_f32_32x32x16_bf16 v[80:95], a[148:151], v[124:127], v[80:95]
    v_fma_f32 v136, v136, v110, v110
    v_rcp_f32 v135, v135
    v_mul_f32 v142, v142, v134
    v_cvt_pk_bf16_f32 v152, v140, v141
    s_waitcnt lgkmcnt(2)
    v_mfma_f32_32x32x16_bf16 v[64:79], a[152:155], v[128:131], v[64:79]
    ds_read_b128 v[124:127], v24 offset:22528
    buffer_load_dwordx4 v[228:231], v7, s[48:51], s57 offen offset:1024 sc1
    v_exp_f32 v138, v138
    v_mul_f32 v139, v55, v139
    v_mfma_f32_32x32x16_bf16 v[80:95], a[156:159], v[128:131], v[80:95]
    v_mul_f32 v145, v53, v61
    v_fma_f32 v137, v137, v110, v110
    v_rcp_f32 v136, v136
    v_mul_f32 v143, v143, v135
    s_waitcnt lgkmcnt(2)
    v_mfma_f32_32x32x16_bf16 v[64:79], a[160:163], v[116:119], v[64:79]
    ds_read_b128 v[128:131], v24 offset:23552
    buffer_load_dwordx4 v[232:235], v7, s[48:51], s57 offen offset:2048 sc1
    v_exp_f32 v139, v139
    v_mul_f32 v146, v54, v62
    v_mfma_f32_32x32x16_bf16 v[80:95], a[164:167], v[116:119], v[80:95]
    v_fma_f32 v138, v138, v110, v110
    v_rcp_f32 v137, v137
    v_mul_f32 v144, v144, v136
    v_cvt_pk_bf16_f32 v153, v142, v143
    v_mul_f32 v147, v55, v63
    s_waitcnt lgkmcnt(2)
    v_mfma_f32_32x32x16_bf16 v[64:79], a[168:171], v[120:123], v[64:79]
    ds_read_b128 v[116:119], v24 offset:24576
    v_fma_f32 v139, v139, v110, v110
    v_rcp_f32 v138, v138
    v_mul_f32 v145, v145, v137
    v_mfma_f32_32x32x16_bf16 v[80:95], a[172:175], v[120:123], v[80:95]
    buffer_load_dwordx4 v[236:239], v7, s[48:51], s57 offen offset:3072 sc1
    v_rcp_f32 v139, v139
    v_mul_f32 v146, v146, v138
    v_cvt_pk_bf16_f32 v154, v144, v145
    s_waitcnt lgkmcnt(2)
    v_mfma_f32_32x32x16_bf16 v[64:79], a[176:179], v[124:127], v[64:79]
    ds_read_b128 v[120:123], v24 offset:25600
    v_mul_f32 v147, v147, v139
    v_cvt_pk_bf16_f32 v155, v146, v147
    v_mfma_f32_32x32x16_bf16 v[80:95], a[180:183], v[124:127], v[80:95]
    buffer_store_dwordx4 v[152:155], v7, s[48:51], s37 offen offset:1024 sc1
    s_mov_b64 exec, 0xffff
    buffer_store_dwordx2 v[26:27], v29, s[48:51], s39 offen sc1
    s_mov_b64 exec, -1
    s_add_u32 s39, s39, 16384
    s_add_u32 s57, s35, 81920
    buffer_load_dwordx4 v[240:243], v7, s[48:51], s57 offen offset:0 sc1
    s_waitcnt lgkmcnt(2)
    v_mfma_f32_32x32x16_bf16 v[64:79], a[184:187], v[128:131], v[64:79]
    ds_read_b128 v[124:127], v24 offset:26624
    s_add_u32 s37, s37, 229376
    v_mfma_f32_32x32x16_bf16 v[80:95], a[188:191], v[128:131], v[80:95]
    buffer_load_dwordx4 v[244:247], v7, s[48:51], s57 offen offset:1024 sc1
    s_waitcnt lgkmcnt(2)
    v_mfma_f32_32x32x16_bf16 v[64:79], a[192:195], v[116:119], v[64:79]
    ds_read_b128 v[128:131], v24 offset:27648
    v_mfma_f32_32x32x16_bf16 v[80:95], a[196:199], v[116:119], v[80:95]
    buffer_load_dwordx4 v[248:251], v7, s[48:51], s57 offen offset:2048 sc1
    s_waitcnt lgkmcnt(2)
    v_mfma_f32_32x32x16_bf16 v[64:79], a[200:203], v[120:123], v[64:79]
    ds_read_b128 v[104:107], v7 offset:12800
    v_mfma_f32_32x32x16_bf16 v[80:95], a[204:207], v[120:123], v[80:95]
    ds_read_b128 v[112:115], v13 offset:512
    buffer_load_dwordx4 v[252:255], v7, s[48:51], s57 offen offset:3072 sc1
    s_waitcnt lgkmcnt(3)
    v_mfma_f32_32x32x16_bf16 v[64:79], a[208:211], v[124:127], v[64:79]
    v_mfma_f32_32x32x16_bf16 v[80:95], a[212:215], v[124:127], v[80:95]
    s_add_u32 s57, s35, 98304
    buffer_load_dwordx4 a[224:227], v7, s[48:51], s57 offen offset:0 sc1
    s_waitcnt lgkmcnt(2)
    v_mfma_f32_32x32x16_bf16 v[64:79], a[216:219], v[128:131], v[64:79]
    s_barrier
    ds_read_b128 v[116:119], v25 offset:0
    ds_read_b128 v[120:123], v25 offset:1024
    v_mfma_f32_32x32x16_bf16 v[80:95], a[220:223], v[128:131], v[80:95]
    ds_read_b128 v[124:127], v25 offset:2048
    buffer_load_dwordx4 a[228:231], v7, s[48:51], s57 offen offset:1024 sc1
    s_waitcnt lgkmcnt(4)
    v_mfma_f32_32x32x16_bf16 v[64:79], v[96:99], v[104:107], v[64:79]
    v_mfma_f32_32x32x16_bf16 v[80:95], v[100:103], v[104:107], v[80:95]
    s_waitcnt lgkmcnt(2)
    v_mfma_f32_32x32x16_bf16 v[32:47], a[0:3], v[116:119], 0
    ds_read_b128 v[128:131], v25 offset:3072
    v_mfma_f32_32x32x16_bf16 v[48:63], a[4:7], v[116:119], 0
    s_add_u32 s57, s36, 16384
    s_add_u32 m0, s32, 73728
    s_nop 0
    buffer_load_dwordx4 v7, s[48:51], s57 offen offset:0 sc1 lds
    s_waitcnt lgkmcnt(2)
    v_mfma_f32_32x32x16_bf16 v[32:47], a[8:11], v[120:123], v[32:47]
    ds_read_b128 v[116:119], v25 offset:4096
    v_cmp_u_f32 vcc, v64, v64
    s_cbranch_vccnz L_xredo1
L_xok1:
    v_mfma_f32_32x32x16_bf16 v[48:63], a[12:15], v[120:123], v[48:63]
    buffer_load_dwordx4 v7, s[48:51], s57 offen offset:1024 sc1 lds
    v_mul_f32 v132, v64, v64
    v_mul_f32 v133, v65, v65
    v_fma_f32 v132, v132, v113, v112
    v_mul_f32 v134, v66, v66
    s_waitcnt lgkmcnt(2)
    v_mfma_f32_32x32x16_bf16 v[32:47], a[16:19], v[124:127], v[32:47]
    ds_read_b128 v[120:123], v25 offset:5120
    v_fma_f32 v133, v133, v113, v112
    v_mul_f32 v132, v64, v132
    v_mul_f32 v135, v67, v67
    v_fma_f32 v134, v134, v113, v112
    v_mfma_f32_32x32x16_bf16 v[48:63], a[20:23], v[124:127], v[48:63]
    buffer_load_dwordx4 v7, s[48:51], s57 offen offset:2048 sc1 lds
    v_exp_f32 v132, v132
    v_mul_f32 v133, v65, v133
    v_mul_f32 v136, v68, v68
    s_waitcnt lgkmcnt(2)
    v_mfma_f32_32x32x16_bf16 v[32:47], a[24:27], v[128:131], v[32:47]
    ds_read_b128 v[124:127], v25 offset:6144
    v_fma_f32 v135, v135, v113, v112
    v_exp_f32 v133, v133
    v_mul_f32 v134, v66, v134
    v_mul_f32 v140, v64, v72
    v_mfma_f32_32x32x16_bf16 v[48:63], a[28:31], v[128:131], v[48:63]
    buffer_load_dwordx4 v7, s[48:51], s57 offen offset:3072 sc1 lds
    v_fma_f32 v132, v132, v114, v114
    v_mul_f32 v137, v69, v69
    v_fma_f32 v136, v136, v113, v112
    s_waitcnt lgkmcnt(2)
    v_mfma_f32_32x32x16_bf16 v[32:47], a[32:35], v[116:119], v[32:47]
    ds_read_b128 v[128:131], v25 offset:7168
    v_exp_f32 v134, v134
    v_mul_f32 v135, v67, v135
    v_mul_f32 v141, v65, v73
    v_fma_f32 v133, v133, v114, v114
    v_mfma_f32_32x32x16_bf16 v[48:63], a[36:39], v[116:119], v[48:63]
    v_rcp_f32 v132, v132
    v_mul_f32 v138, v70, v70
    v_fma_f32 v137, v137, v113, v112
    v_exp_f32 v135, v135
    s_waitcnt lgkmcnt(2)
    v_mfma_f32_32x32x16_bf16 v[32:47], a[40:43], v[120:123], v[32:47]
    ds_read_b128 v[116:119], v25 offset:8192
    s_add_u32 s57, s36, 32768
    s_add_u32 m0, s32, 77824
    s_nop 0
    buffer_load_dwordx4 v7, s[48:51], s57 offen offset:0 sc1 lds
    v_mul_f32 v136, v68, v136
    v_mfma_f32_32x32x16_bf16 v[48:63], a[44:47], v[120:123], v[48:63]
    v_mul_f32 v142, v66, v74
    v_fma_f32 v134, v134, v114, v114
    v_rcp_f32 v133, v133
    v_mul_f32 v140, v140, v132
    v_mul_f32 v139, v71, v71
    s_waitcnt lgkmcnt(2)
    v_mfma_f32_32x32x16_bf16 v[32:47], a[48:51], v[124:127], v[32:47]
    ds_read_b128 v[120:123], v25 offset:9216
    buffer_load_dwordx4 v7, s[48:51], s57 offen offset:1024 sc1 lds
    v_fma_f32 v138, v138, v113, v112
    v_exp_f32 v136, v136
    v_mfma_f32_32x32x16_bf16 v[48:63], a[52:55], v[124:127], v[48:63]
    v_mul_f32 v137, v69, v137
    v_mul_f32 v143, v67, v75
    v_fma_f32 v135, v135, v114, v114
    v_rcp_f32 v134, v134
    v_mul_f32 v141, v141, v133
    s_waitcnt lgkmcnt(2)
    v_mfma_f32_32x32x16_bf16 v[32:47], a[56:59], v[128:131], v[32:47]
    ds_read_b128 v[124:127], v25 offset:10240
    s_add_u32 m0, s32, 129024
    s_nop 0
    buffer_load_dwordx4 v7, s[48:51], s57 offen offset:2048 sc1 lds
    v_mul_f32 v132, v80, v80
    v_fma_f32 v139, v139, v113, v112
    v_mfma_f32_32x32x16_bf16 v[48:63], a[60:63], v[128:131], v[48:63]
    v_exp_f32 v137, v137
    v_mul_f32 v138, v70, v138
    v_mul_f32 v144, v68, v76
    v_fma_f32 v136, v136, v114, v114
    s_waitcnt lgkmcnt(2)
    v_mfma_f32_32x32x16_bf16 v[32:47], a[64:67], v[116:119], v[32:47]
    ds_read_b128 v[128:131], v25 offset:11264
    v_rcp_f32 v135, v135
    v_mul_f32 v142, v142, v134
    v_cvt_pk_bf16_f32 v148, v140, v141
    v_mul_f32 v133, v81, v81
    v_mfma_f32_32x32x16_bf16 v[48:63], a[68:71], v[116:119], v[48:63]
    buffer_load_dwordx4 v7, s[48:51], s57 offen offset:3072 sc1 lds
    v_fma_f32 v132, v132, v113, v112
    v_exp_f32 v138, v138
    v_mul_f32 v139, v71, v139
    s_waitcnt lgkmcnt(2)
    v_mfma_f32_32x32x16_bf16 v[32:47], a[72:75], v[120:123], v[32:47]
    ds_read_b128 v[116:119], v25 offset:12288
    v_mul_f32 v145, v69, v77
    v_fma_f32 v137, v137, v114, v114
    v_rcp_f32 v136, v136
    v_mul_f32 v143, v143, v135
    v_mfma_f32_32x32x16_bf16 v[48:63], a[76:79], v[120:123], v[48:63]
    s_add_u32 s57, s36, 49152
    s_add_u32 m0, s32, 133120
    s_nop 0
    buffer_load_dwordx4 v7, s[48:51], s57 offen offset:0 sc1 lds
    v_mul_f32 v134, v82, v82
    v_fma_f32 v133, v133, v113, v112
    s_waitcnt lgkmcnt(2)
    v_mfma_f32_32x32x16_bf16 v[32:47], a[80:83], v[124:127], v[32:47]
    ds_read_b128 v[120:123], v25 offset:13312
    v_exp_f32 v139, v139
    v_mul_f32 v132, v80, v132
    v_mul_f32 v146, v70, v78
    v_fma_f32 v138, v138, v114, v114
    v_mfma_f32_32x32x16_bf16 v[48:63], a[84:87], v[124:127], v[48:63]
    buffer_load_dwordx4 v7, s[48:51], s57 offen offset:1024 sc1 lds
    v_rcp_f32 v137, v137
    v_mul_f32 v144, v144, v136
    v_cvt_pk_bf16_f32 v149, v142, v143
    s_waitcnt lgkmcnt(2)
    v_mfma_f32_32x32x16_bf16 v[32:47], a[88:91], v[128:131], v[32:47]
    ds_read_b128 v[124:127], v25 offset:14336
    v_mul_f32 v135, v83, v83
    v_fma_f32 v134, v134, v113, v112
    v_exp_f32 v132, v132
    v_mul_f32 v133, v81, v133
    v_mfma_f32_32x32x16_bf16 v[48:63], a[92:95], v[128:131], v[48:63]
    v_mul_f32 v147, v71, v79
    v_fma_f32 v139, v139, v114, v114
    v_rcp_f32 v138, v138
    v_mul_f32 v145, v145, v137
    v_mul_f32 v136, v84, v84
    s_waitcnt lgkmcnt(2)
    v_mfma_f32_32x32x16_bf16 v[32:47], a[96:99], v[116:119], v[32:47]
    ds_read_b128 v[128:131], v25 offset:15360
    buffer_load_dwordx4 v7, s[48:51], s57 offen offset:2048 sc1 lds
    v_fma_f32 v135, v135, v113, v112
    v_exp_f32 v133, v133
    v_mfma_f32_32x32x16_bf16 v[48:63], a[100:103], v[116:119], v[48:63]
    v_mul_f32 v134, v82, v134
    v_mul_f32 v140, v80, v88
    v_fma_f32 v132, v132, v114, v114
    v_rcp_f32 v139, v139
    v_mul_f32 v146, v146, v138
    s_waitcnt lgkmcnt(2)
    v_mfma_f32_32x32x16_bf16 v[32:47], a[104:107], v[120:123], v[32:47]
    ds_read_b128 v[116:119], v25 offset:16384
    buffer_load_dwordx4 v7, s[48:51], s57 offen offset:3072 sc1 lds
    v_cvt_pk_bf16_f32 v150, v144, v145
    v_mul_f32 v137, v85, v85
    v_fma_f32 v136, v136, v113, v112
    v_mfma_f32_32x32x16_bf16 v[48:63], a[108:111], v[120:123], v[48:63]
    v_exp_f32 v134, v134
    v_mul_f32 v135, v83, v135
    v_mul_f32 v141, v81, v89
    v_fma_f32 v133, v133, v114, v114
    s_waitcnt lgkmcnt(2)
    v_mfma_f32_32x32x16_bf16 v[32:47], a[112:115], v[124:127], v[32:47]
    ds_read_b128 v[120:123], v25 offset:17408
    s_add_u32 s57, s36, 65536
    s_add_u32 m0, s32, 102400
    s_nop 0
    buffer_load_dwordx4 v7, s[48:51], s57 offen offset:0 sc1 lds
    v_mfma_f32_32x32x16_bf16 v[48:63], a[116:119], v[124:127], v[48:63]
    v_rcp_f32 v132, v132
    v_mul_f32 v147, v147, v139
    v_mul_f32 v138, v86, v86
    v_fma_f32 v137, v137, v113, v112
    s_waitcnt lgkmcnt(2)
    v_mfma_f32_32x32x16_bf16 v[32:47], a[120:123], v[128:131], v[32:47]
    ds_read_b128 v[124:127], v25 offset:18432
    buffer_load_dwordx4 v7, s[48:51], s57 offen offset:1024 sc1 lds
    v_exp_f32 v135, v135
    v_mul_f32 v136, v84, v136
    v_mfma_f32_32x32x16_bf16 v[48:63], a[124:127], v[128:131], v[48:63]
    v_mul_f32 v142, v82, v90
    v_fma_f32 v134, v134, v114, v114
    v_rcp_f32 v133, v133
    v_mul_f32 v140, v140, v132
    v_cvt_pk_bf16_f32 v151, v146, v147
    s_waitcnt lgkmcnt(2)
    v_mfma_f32_32x32x16_bf16 v[32:47], a[128:131], v[116:119], v[32:47]
    ds_read_b128 v[128:131], v25 offset:19456
    buffer_store_dwordx4 v[148:151], v7, s[48:51], s38 offen offset:0 sc1
    v_mul_f32 v139, v87, v87
    v_fma_f32 v138, v138, v113, v112
    v_mfma_f32_32x32x16_bf16 v[48:63], a[132:135], v[116:119], v[48:63]
    buffer_load_dwordx4 v7, s[48:51], s57 offen offset:2048 sc1 lds
    v_exp_f32 v136, v136
    v_mul_f32 v137, v85, v137
    v_mul_f32 v143, v83, v91
    s_waitcnt lgkmcnt(2)
    v_mfma_f32_32x32x16_bf16 v[32:47], a[136:139], v[120:123], v[32:47]
    ds_read_b128 v[116:119], v25 offset:20480
    v_fma_f32 v135, v135, v114, v114
    v_rcp_f32 v134, v134
    v_mul_f32 v141, v141, v133
    v_fma_f32 v139, v139, v113, v112
    v_mfma_f32_32x32x16_bf16 v[48:63], a[140:143], v[120:123], v[48:63]
    buffer_load_dwordx4 v7, s[48:51], s57 offen offset:3072 sc1 lds
    v_exp_f32 v137, v137
    v_mul_f32 v138, v86, v138
    v_mul_f32 v144, v84, v92
    s_waitcnt lgkmcnt(2)
    v_mfma_f32_32x32x16_bf16 v[32:47], a[144:147], v[124:127], v[32:47]
    ds_read_b128 v[120:123], v25 offset:21504
    v_fma_f32 v136, v136, v114, v114
    v_rcp_f32 v135, v135
    v_mul_f32 v142, v142, v134
    v_cvt_pk_bf16_f32 v152, v140, v141
    v_mfma_f32_32x32x16_bf16 v[48:63], a[148:151], v[124:127], v[48:63]
    s_add_u32 s57, s36, 81920
    s_add_u32 m0, s32, 106496
    s_nop 0
    buffer_load_dwordx4 v7, s[48:51], s57 offen offset:0 sc1 lds
    v_exp_f32 v138, v138
    s_waitcnt lgkmcnt(2)
    v_mfma_f32_32x32x16_bf16 v[32:47], a[152:155], v[128:131], v[32:47]
    ds_read_b128 v[124:127], v25 offset:22528
    v_mul_f32 v139, v87, v139
    v_mul_f32 v145, v85, v93
    v_fma_f32 v137, v137, v114, v114
    v_rcp_f32 v136, v136
    v_mfma_f32_32x32x16_bf16 v[48:63], a[156:159], v[128:131], v[48:63]
    v_mul_f32 v143, v143, v135
    v_exp_f32 v139, v139
    v_mul_f32 v146, v86, v94
    v_fma_f32 v138, v138, v114, v114
    s_waitcnt lgkmcnt(2)
    v_mfma_f32_32x32x16_bf16 v[32:47], a[160:163], v[116:119], v[32:47]
    ds_read_b128 v[128:131], v25 offset:23552
    buffer_load_dwordx4 v7, s[48:51], s57 offen offset:1024 sc1 lds
    s_add_u32 s76, s77, 1014016
    buffer_load_dwordx2 v[30:31], v23, s[48:51], s76 offen sc1
    v_mfma_f32_32x32x16_bf16 v[48:63], a[164:167], v[116:119], v[48:63]
    v_rcp_f32 v137, v137
    v_mul_f32 v144, v144, v136
    v_cvt_pk_bf16_f32 v153, v142, v143
    v_mul_f32 v147, v87, v95
    v_fma_f32 v139, v139, v114, v114
    s_waitcnt lgkmcnt(2)
    v_mfma_f32_32x32x16_bf16 v[32:47], a[168:171], v[120:123], v[32:47]
    ds_read_b128 v[116:119], v25 offset:24576
    s_add_u32 s57, s35, 98304
    buffer_load_dwordx4 a[232:235], v7, s[48:51], s57 offen offset:2048 sc1
    v_rcp_f32 v138, v138
    v_mfma_f32_32x32x16_bf16 v[48:63], a[172:175], v[120:123], v[48:63]
    v_mul_f32 v145, v145, v137
    v_rcp_f32 v139, v139
    v_mul_f32 v146, v146, v138
    v_cvt_pk_bf16_f32 v154, v144, v145
    v_mul_f32 v147, v147, v139
    s_waitcnt lgkmcnt(2)
    v_mfma_f32_32x32x16_bf16 v[32:47], a[176:179], v[124:127], v[32:47]
    ds_read_b128 v[120:123], v25 offset:25600
    buffer_load_dwordx4 a[236:239], v7, s[48:51], s57 offen offset:3072 sc1
    v_cvt_pk_bf16_f32 v155, v146, v147
    v_mfma_f32_32x32x16_bf16 v[48:63], a[180:183], v[124:127], v[48:63]
    buffer_store_dwordx4 v[152:155], v7, s[48:51], s38 offen offset:1024 sc1
    s_mov_b64 exec, 0xffff
    buffer_store_dwordx2 v[26:27], v29, s[48:51], s61 offen sc1
    s_mov_b64 exec, -1
    s_add_u32 s61, s61, 16384
    s_add_u32 s38, s38, 229376
    s_waitcnt lgkmcnt(2)
    v_mfma_f32_32x32x16_bf16 v[32:47], a[184:187], v[128:131], v[32:47]
    ds_read_b128 v[124:127], v25 offset:26624
    s_add_u32 s57, s36, 0
    buffer_load_dwordx4 a[240:243], v7, s[48:51], s57 offen offset:0 sc1
    v_mfma_f32_32x32x16_bf16 v[48:63], a[188:191], v[128:131], v[48:63]
    s_waitcnt lgkmcnt(2)
    v_mfma_f32_32x32x16_bf16 v[32:47], a[192:195], v[116:119], v[32:47]
    ds_read_b128 v[128:131], v25 offset:27648
    v_mfma_f32_32x32x16_bf16 v[48:63], a[196:199], v[116:119], v[48:63]
    buffer_load_dwordx4 a[244:247], v7, s[48:51], s57 offen offset:1024 sc1
    s_waitcnt lgkmcnt(2)
    v_mfma_f32_32x32x16_bf16 v[32:47], a[200:203], v[120:123], v[32:47]
    ds_read_b128 v[104:107], v7 offset:13824
    v_mfma_f32_32x32x16_bf16 v[48:63], a[204:207], v[120:123], v[48:63]
    ds_read_b128 v[108:111], v13 offset:1024
    buffer_load_dwordx4 a[248:251], v7, s[48:51], s57 offen offset:2048 sc1
    s_waitcnt lgkmcnt(3)
    v_mfma_f32_32x32x16_bf16 v[32:47], a[208:211], v[124:127], v[32:47]
    v_mfma_f32_32x32x16_bf16 v[48:63], a[212:215], v[124:127], v[48:63]
    buffer_load_dwordx4 a[252:255], v7, s[48:51], s57 offen offset:3072 sc1
    s_waitcnt lgkmcnt(2)
    v_mfma_f32_32x32x16_bf16 v[32:47], a[216:219], v[128:131], v[32:47]
    s_waitcnt vmcnt(43)
    s_barrier
    ds_read_b128 v[116:119], v25 offset:28672
    ds_read_b128 v[120:123], v25 offset:29696
    v_mfma_f32_32x32x16_bf16 v[48:63], a[220:223], v[128:131], v[48:63]
    ds_read_b128 v[124:127], v25 offset:30720
    s_waitcnt lgkmcnt(4)
    v_mfma_f32_32x32x16_bf16 v[32:47], v[96:99], v[104:107], v[32:47]
    v_mfma_f32_32x32x16_bf16 v[48:63], v[100:103], v[104:107], v[48:63]
    s_waitcnt lgkmcnt(2)
    v_mfma_f32_32x32x16_bf16 v[64:79], a[0:3], v[116:119], 0
    ds_read_b128 v[128:131], v25 offset:31744
    v_mfma_f32_32x32x16_bf16 v[80:95], a[4:7], v[116:119], 0
    s_add_u32 s57, s36, 81920
    s_add_u32 m0, s32, 14336
    s_nop 0
    buffer_load_dwordx4 v7, s[48:51], s57 offen offset:2048 sc1 lds
    s_waitcnt lgkmcnt(2)
    v_mfma_f32_32x32x16_bf16 v[64:79], a[8:11], v[120:123], v[64:79]
    ds_read_b128 v[116:119], v25 offset:32768
    v_mfma_f32_32x32x16_bf16 v[80:95], a[12:15], v[120:123], v[80:95]
    buffer_load_dwordx4 v7, s[48:51], s57 offen offset:3072 sc1 lds
    v_mul_f32 v132, v32, v32
    v_mul_f32 v133, v33, v33
    v_fma_f32 v132, v132, v109, v108
    v_mul_f32 v134, v34, v34
    s_waitcnt lgkmcnt(2)
    v_mfma_f32_32x32x16_bf16 v[64:79], a[16:19], v[124:127], v[64:79]
    ds_read_b128 v[120:123], v25 offset:33792
    v_fma_f32 v133, v133, v109, v108
    v_mul_f32 v132, v32, v132
    v_mul_f32 v135, v35, v35
    v_fma_f32 v134, v134, v109, v108
    v_mfma_f32_32x32x16_bf16 v[80:95], a[20:23], v[124:127], v[80:95]
    s_add_u32 s57, s36, 98304
    s_add_u32 m0, s32, 18432
    s_nop 0
    buffer_load_dwordx4 v7, s[48:51], s57 offen offset:0 sc1 lds
    v_exp_f32 v132, v132
    s_waitcnt lgkmcnt(2)
    v_mfma_f32_32x32x16_bf16 v[64:79], a[24:27], v[128:131], v[64:79]
    ds_read_b128 v[124:127], v25 offset:34816
    v_mul_f32 v133, v33, v133
    v_mul_f32 v136, v36, v36
    v_fma_f32 v135, v135, v109, v108
    v_exp_f32 v133, v133
    v_mfma_f32_32x32x16_bf16 v[80:95], a[28:31], v[128:131], v[80:95]
    buffer_load_dwordx4 v7, s[48:51], s57 offen offset:1024 sc1 lds
    v_mul_f32 v134, v34, v134
    v_mul_f32 v140, v32, v40
    v_fma_f32 v132, v132, v110, v110
    v_mul_f32 v137, v37, v37
    s_waitcnt lgkmcnt(2)
    v_mfma_f32_32x32x16_bf16 v[64:79], a[32:35], v[116:119], v[64:79]
    ds_read_b128 v[128:131], v25 offset:35840
    v_fma_f32 v136, v136, v109, v108
    v_exp_f32 v134, v134
    v_mul_f32 v135, v35, v135
    v_mul_f32 v141, v33, v41
    v_mfma_f32_32x32x16_bf16 v[80:95], a[36:39], v[116:119], v[80:95]
    buffer_load_dwordx4 v7, s[48:51], s57 offen offset:2048 sc1 lds
    v_fma_f32 v133, v133, v110, v110
    v_rcp_f32 v132, v132
    v_mul_f32 v138, v38, v38
    s_waitcnt lgkmcnt(2)
    v_mfma_f32_32x32x16_bf16 v[64:79], a[40:43], v[120:123], v[64:79]
    ds_read_b128 v[116:119], v25 offset:36864
    s_waitcnt vmcnt(13)
    v_cmp_ne_u64 vcc, s[52:53], v[30:31]
    s_cbranch_vccnz L_pfslow3
L_pfok3:
    v_fma_f32 v137, v137, v109, v108
    v_mfma_f32_32x32x16_bf16 v[80:95], a[44:47], v[120:123], v[80:95]
    buffer_load_dwordx4 v7, s[48:51], s57 offen offset:3072 sc1 lds
    v_exp_f32 v135, v135
    v_mul_f32 v136, v36, v136
    v_mul_f32 v142, v34, v42
    s_waitcnt lgkmcnt(2)
    v_mfma_f32_32x32x16_bf16 v[64:79], a[48:51], v[124:127], v[64:79]
    ds_read_b128 v[120:123], v25 offset:37888
    v_fma_f32 v134, v134, v110, v110
    v_rcp_f32 v133, v133
    v_mul_f32 v140, v140, v132
    v_mul_f32 v139, v39, v39
    v_mfma_f32_32x32x16_bf16 v[80:95], a[52:55], v[124:127], v[80:95]
    s_add_u32 s57, s68, 0
    buffer_load_dwordx2 v[30:31], v28, s[48:51], s57 offen sc1
    v_fma_f32 v138, v138, v109, v108
    v_exp_f32 v136, v136
    s_waitcnt lgkmcnt(2)
    v_mfma_f32_32x32x16_bf16 v[64:79], a[56:59], v[128:131], v[64:79]
    ds_read_b128 v[124:127], v25 offset:38912
    v_mul_f32 v137, v37, v137
    v_mul_f32 v143, v35, v43
    v_fma_f32 v135, v135, v110, v110
    v_rcp_f32 v134, v134
    v_mfma_f32_32x32x16_bf16 v[80:95], a[60:63], v[128:131], v[80:95]
    s_add_u32 s76, s70, 0
    buffer_load_dwordx4 a[0:3], v7, s[48:51], s76 offen offset:0 sc1
    v_mul_f32 v141, v141, v133
    v_mul_f32 v132, v48, v48
    v_fma_f32 v139, v139, v109, v108
    s_waitcnt lgkmcnt(2)
    v_mfma_f32_32x32x16_bf16 v[64:79], a[64:67], v[116:119], v[64:79]
    ds_read_b128 v[128:131], v25 offset:39936
    v_exp_f32 v137, v137
    v_mul_f32 v138, v38, v138
    v_mul_f32 v144, v36, v44
    v_fma_f32 v136, v136, v110, v110
    v_mfma_f32_32x32x16_bf16 v[80:95], a[68:71], v[116:119], v[80:95]
    buffer_load_dwordx4 a[4:7], v7, s[48:51], s76 offen offset:1024 sc1
    v_rcp_f32 v135, v135
    v_mul_f32 v142, v142, v134
    v_cvt_pk_bf16_f32 v148, v140, v141
    s_waitcnt lgkmcnt(2)
    v_mfma_f32_32x32x16_bf16 v[64:79], a[72:75], v[120:123], v[64:79]
    ds_read_b128 v[116:119], v25 offset:40960
    v_mul_f32 v133, v49, v49
    v_fma_f32 v132, v132, v109, v108
    v_exp_f32 v138, v138
    v_mul_f32 v139, v39, v139
    v_mfma_f32_32x32x16_bf16 v[80:95], a[76:79], v[120:123], v[80:95]
    s_add_u32 s76, s70, 8192
    buffer_load_dwordx4 a[8:11], v7, s[48:51], s76 offen offset:0 sc1
    v_mul_f32 v145, v37, v45
    v_fma_f32 v137, v137, v110, v110
    s_waitcnt lgkmcnt(2)
    v_mfma_f32_32x32x16_bf16 v[64:79], a[80:83], v[124:127], v[64:79]
    ds_read_b128 v[120:123], v25 offset:41984
    v_rcp_f32 v136, v136
    v_mul_f32 v143, v143, v135
    v_mul_f32 v134, v50, v50
    v_fma_f32 v133, v133, v109, v108
    v_mfma_f32_32x32x16_bf16 v[80:95], a[84:87], v[124:127], v[80:95]
    buffer_load_dwordx4 a[12:15], v7, s[48:51], s76 offen offset:1024 sc1
    v_exp_f32 v139, v139
    v_mul_f32 v132, v48, v132
    v_mul_f32 v146, v38, v46
    s_waitcnt lgkmcnt(2)
    v_mfma_f32_32x32x16_bf16 v[64:79], a[88:91], v[128:131], v[64:79]
    ds_read_b128 v[124:127], v25 offset:43008
    v_fma_f32 v138, v138, v110, v110
    v_rcp_f32 v137, v137
    v_mul_f32 v144, v144, v136
    v_cvt_pk_bf16_f32 v149, v142, v143
    v_mfma_f32_32x32x16_bf16 v[80:95], a[92:95], v[128:131], v[80:95]
    s_add_u32 s76, s70, 16384
    buffer_load_dwordx4 a[16:19], v7, s[48:51], s76 offen offset:0 sc1
    v_mul_f32 v135, v51, v51
    v_fma_f32 v134, v134, v109, v108
    s_waitcnt lgkmcnt(2)
    v_mfma_f32_32x32x16_bf16 v[64:79], a[96:99], v[116:119], v[64:79]
    ds_read_b128 v[128:131], v25 offset:44032
    v_exp_f32 v132, v132
    v_mul_f32 v133, v49, v133
    v_mul_f32 v147, v39, v47
    v_fma_f32 v139, v139, v110, v110
    v_mfma_f32_32x32x16_bf16 v[80:95], a[100:103], v[116:119], v[80:95]
    buffer_load_dwordx4 a[20:23], v7, s[48:51], s76 offen offset:1024 sc1
    v_rcp_f32 v138, v138
    v_mul_f32 v145, v145, v137
    v_mul_f32 v136, v52, v52
    s_waitcnt lgkmcnt(2)
    v_mfma_f32_32x32x16_bf16 v[64:79], a[104:107], v[120:123], v[64:79]
    ds_read_b128 v[116:119], v25 offset:45056
    v_fma_f32 v135, v135, v109, v108
    v_exp_f32 v133, v133
    v_mul_f32 v134, v50, v134
    v_mul_f32 v140, v48, v56
    v_mfma_f32_32x32x16_bf16 v[80:95], a[108:111], v[120:123], v[80:95]
    s_add_u32 s76, s70, 24576
    buffer_load_dwordx4 a[24:27], v7, s[48:51], s76 offen offset:0 sc1
    v_fma_f32 v132, v132, v110, v110
    v_rcp_f32 v139, v139
    s_waitcnt lgkmcnt(2)
    v_mfma_f32_32x32x16_bf16 v[64:79], a[112:115], v[124:127], v[64:79]
    ds_read_b128 v[120:123], v25 offset:46080
    v_mul_f32 v146, v146, v138
    v_cvt_pk_bf16_f32 v150, v144, v145
    v_mul_f32 v137, v53, v53
    v_fma_f32 v136, v136, v109, v108
    v_mfma_f32_32x32x16_bf16 v[80:95], a[116:119], v[124:127], v[80:95]
    buffer_load_dwordx4 a[28:31], v7, s[48:51], s76 offen offset:1024 sc1
    v_exp_f32 v134, v134
    v_mul_f32 v135, v51, v135
    v_mul_f32 v141, v49, v57
    s_waitcnt lgkmcnt(2)
    v_mfma_f32_32x32x16_bf16 v[64:79], a[120:123], v[128:131], v[64:79]
    ds_read_b128 v[124:127], v25 offset:47104
    v_fma_f32 v133, v133, v110, v110
    v_rcp_f32 v132, v132
    v_mul_f32 v147, v147, v139
    v_mul_f32 v138, v54, v54
    v_mfma_f32_32x32x16_bf16 v[80:95], a[124:127], v[128:131], v[80:95]
    s_add_u32 s76, s70, 32768
    buffer_load_dwordx4 a[32:35], v7, s[48:51], s76 offen offset:0 sc1
    v_fma_f32 v137, v137, v109, v108
    v_exp_f32 v135, v135
    s_waitcnt lgkmcnt(2)
    v_mfma_f32_32x32x16_bf16 v[64:79], a[128:131], v[116:119], v[64:79]
    ds_read_b128 v[128:131], v25 offset:48128
    v_mul_f32 v136, v52, v136
    v_mul_f32 v142, v50, v58
    v_fma_f32 v134, v134, v110, v110
    v_rcp_f32 v133, v133
    v_mfma_f32_32x32x16_bf16 v[80:95], a[132:135], v[116:119], v[80:95]
    buffer_load_dwordx4 a[36:39], v7, s[48:51], s76 offen offset:1024 sc1
    v_mul_f32 v140, v140, v132
    v_cvt_pk_bf16_f32 v151, v146, v147
    s_waitcnt lgkmcnt(2)
    v_mfma_f32_32x32x16_bf16 v[64:79], a[136:139], v[120:123], v[64:79]
    ds_read_b128 v[116:119], v25 offset:49152
    buffer_store_dwordx4 v[148:151], v7, s[48:51], s37 offen offset:0 sc1
    v_mul_f32 v139, v55, v55
    v_fma_f32 v138, v138, v109, v108
    v_mfma_f32_32x32x16_bf16 v[80:95], a[140:143], v[120:123], v[80:95]
    s_add_u32 s76, s70, 40960
    buffer_load_dwordx4 a[40:43], v7, s[48:51], s76 offen offset:0 sc1
    v_exp_f32 v136, v136
    v_mul_f32 v137, v53, v137
    s_waitcnt lgkmcnt(2)
    v_mfma_f32_32x32x16_bf16 v[64:79], a[144:147], v[124:127], v[64:79]
    ds_read_b128 v[120:123], v25 offset:50176
    v_mul_f32 v143, v51, v59
    v_fma_f32 v135, v135, v110, v110
    v_rcp_f32 v134, v134
    v_mul_f32 v141, v141, v133
    v_mfma_f32_32x32x16_bf16 v[80:95], a[148:151], v[124:127], v[80:95]
    buffer_load_dwordx4 a[44:47], v7, s[48:51], s76 offen offset:1024 sc1
    v_fma_f32 v139, v139, v109, v108
    v_exp_f32 v137, v137
    v_mul_f32 v138, v54, v138
    s_waitcnt lgkmcnt(2)
    v_mfma_f32_32x32x16_bf16 v[64:79], a[152:155], v[128:131], v[64:79]
    ds_read_b128 v[124:127], v25 offset:51200
    v_mul_f32 v144, v52, v60
    v_fma_f32 v136, v136, v110, v110
    v_rcp_f32 v135, v135
    v_mul_f32 v142, v142, v134
    v_mfma_f32_32x32x16_bf16 v[80:95], a[156:159], v[128:131], v[80:95]
    s_add_u32 s76, s70, 49152
    buffer_load_dwordx4 a[48:51], v7, s[48:51], s76 offen offset:0 sc1
    v_cvt_pk_bf16_f32 v152, v140, v141
    v_exp_f32 v138, v138
    s_waitcnt lgkmcnt(2)
    v_mfma_f32_32x32x16_bf16 v[64:79], a[160:163], v[116:119], v[64:79]
    ds_read_b128 v[128:131], v25 offset:52224
    v_mul_f32 v139, v55, v139
    v_mul_f32 v145, v53, v61
    v_fma_f32 v137, v137, v110, v110
    v_rcp_f32 v136, v136
    v_mfma_f32_32x32x16_bf16 v[80:95], a[164:167], v[116:119], v[80:95]
    buffer_load_dwordx4 a[52:55], v7, s[48:51], s76 offen offset:1024 sc1
    v_mul_f32 v143, v143, v135
    v_exp_f32 v139, v139
    v_mul_f32 v146, v54, v62
    s_waitcnt lgkmcnt(2)
    v_mfma_f32_32x32x16_bf16 v[64:79], a[168:171], v[120:123], v[64:79]
    ds_read_b128 v[116:119], v25 offset:53248
    v_fma_f32 v138, v138, v110, v110
    v_rcp_f32 v137, v137
    v_mul_f32 v144, v144, v136
    v_cvt_pk_bf16_f32 v153, v142, v143
    v_mfma_f32_32x32x16_bf16 v[80:95], a[172:175], v[120:123], v[80:95]
    s_add_u32 s76, s71, 0
    buffer_load_dwordx4 a[56:59], v7, s[48:51], s76 offen offset:0 sc1
    v_mul_f32 v147, v55, v63
    v_fma_f32 v139, v139, v110, v110
    s_waitcnt lgkmcnt(2)
    v_mfma_f32_32x32x16_bf16 v[64:79], a[176:179], v[124:127], v[64:79]
    ds_read_b128 v[120:123], v25 offset:54272
    v_rcp_f32 v138, v138
    v_mfma_f32_32x32x16_bf16 v[80:95], a[180:183], v[124:127], v[80:95]
    buffer_load_dwordx4 a[60:63], v7, s[48:51], s76 offen offset:1024 sc1
    ds_read_b128 a[128:131], v17 offset:0
    v_mul_f32 v145, v145, v137
    v_rcp_f32 v139, v139
    s_waitcnt lgkmcnt(3)
    v_mfma_f32_32x32x16_bf16 v[64:79], a[184:187], v[128:131], v[64:79]
    ds_read_b128 v[124:127], v25 offset:55296
    ds_read_b128 a[132:135], v17 offset:1024
    v_mul_f32 v146, v146, v138
    v_cvt_pk_bf16_f32 v154, v144, v145
    v_mul_f32 v147, v147, v139
    v_mfma_f32_32x32x16_bf16 v[80:95], a[188:191], v[128:131], v[80:95]
    s_add_u32 s76, s71, 8192
    buffer_load_dwordx4 a[64:67], v7, s[48:51], s76 offen offset:0 sc1
    ds_read_b128 a[136:139], v17 offset:2048
    v_cvt_pk_bf16_f32 v155, v146, v147
    s_waitcnt lgkmcnt(5)
    v_mfma_f32_32x32x16_bf16 v[64:79], a[192:195], v[116:119], v[64:79]
    ds_read_b128 v[128:131], v25 offset:56320
    buffer_store_dwordx4 v[152:155], v7, s[48:51], s37 offen offset:1024 sc1
    s_mov_b64 exec, 0xffff
    buffer_store_dwordx2 v[26:27], v29, s[48:51], s39 offen sc1
    s_mov_b64 exec, -1
    ds_read_b128 a[140:143], v17 offset:3072
    v_mfma_f32_32x32x16_bf16 v[80:95], a[196:199], v[116:119], v[80:95]
    buffer_load_dwordx4 a[68:71], v7, s[48:51], s76 offen offset:1024 sc1
    ds_read_b128 a[144:147], v17 offset:4096
    s_waitcnt lgkmcnt(7)
    v_mfma_f32_32x32x16_bf16 v[64:79], a[200:203], v[120:123], v[64:79]
    ds_read_b128 v[104:107], v7 offset:14848
    ds_read_b128 a[148:151], v17 offset:5120
    s_waitcnt vmcnt(21)
    v_cmp_ne_u64 vcc, s[52:53], v[30:31]
    s_nop 0
    s_cmp_eq_u64 vcc, 0
    s_cselect_b32 s66, s70, 0x40000000
    v_mfma_f32_32x32x16_bf16 v[80:95], a[204:207], v[120:123], v[80:95]
    ds_read_b128 v[112:115], v13 offset:1536
    s_add_u32 s76, s71, 16384
    buffer_load_dwordx4 a[72:75], v7, s[48:51], s76 offen offset:0 sc1
    s_add_u32 s57, s69, 0
    buffer_load_dwordx2 v[30:31], v28, s[48:51], s57 offen sc1
    ds_read_b128 a[152:155], v17 offset:57344
    s_waitcnt lgkmcnt(9)
    v_mfma_f32_32x32x16_bf16 v[64:79], a[208:211], v[124:127], v[64:79]
    ds_read_b128 a[156:159], v17 offset:58368
    v_mfma_f32_32x32x16_bf16 v[80:95], a[212:215], v[124:127], v[80:95]
    buffer_load_dwordx4 a[76:79], v7, s[48:51], s76 offen offset:1024 sc1
    ds_read_b128 a[160:163], v17 offset:59392
    s_waitcnt lgkmcnt(8)
    v_mfma_f32_32x32x16_bf16 v[64:79], a[216:219], v[128:131], v[64:79]
    ds_read_b128 a[164:167], v17 offset:60416
    v_mfma_f32_32x32x16_bf16 v[80:95], a[220:223], v[128:131], v[80:95]
    ds_read_b128 a[168:171], v17 offset:61440
    s_waitcnt lgkmcnt(7)
    v_mfma_f32_32x32x16_bf16 v[64:79], v[96:99], v[104:107], v[64:79]
    ds_read_b128 a[172:175], v17 offset:62464
    v_mfma_f32_32x32x16_bf16 v[80:95], v[100:103], v[104:107], v[80:95]
    s_nop 9
    v_pk_mul_f32 v[132:133], v[64:65], v[64:65]
    v_pk_mul_f32 v[134:135], v[66:67], v[66:67]
    v_pk_mul_f32 v[136:137], v[68:69], v[68:69]
    v_pk_mul_f32 v[138:139], v[70:71], v[70:71]
    s_waitcnt lgkmcnt(6)
    v_pk_fma_f32 v[132:133], v[132:133], v[112:113], v[112:113] op_sel:[0,1,0] op_sel_hi:[1,1,0]
    v_pk_fma_f32 v[134:135], v[134:135], v[112:113], v[112:113] op_sel:[0,1,0] op_sel_hi:[1,1,0]
    v_pk_fma_f32 v[136:137], v[136:137], v[112:113], v[112:113] op_sel:[0,1,0] op_sel_hi:[1,1,0]
    v_pk_fma_f32 v[138:139], v[138:139], v[112:113], v[112:113] op_sel:[0,1,0] op_sel_hi:[1,1,0]
    v_pk_mul_f32 v[132:133], v[64:65], v[132:133]
    v_pk_mul_f32 v[134:135], v[66:67], v[134:135]
    v_pk_mul_f32 v[136:137], v[68:69], v[136:137]
    v_pk_mul_f32 v[138:139], v[70:71], v[138:139]
    v_exp_f32 v132, v132
    v_exp_f32 v133, v133
    v_exp_f32 v134, v134
    v_exp_f32 v135, v135
    v_exp_f32 v136, v136
    v_exp_f32 v137, v137
    v_exp_f32 v138, v138
    v_exp_f32 v139, v139
    v_pk_mul_f32 v[140:141], v[64:65], v[72:73]
    v_pk_mul_f32 v[142:143], v[66:67], v[74:75]
    v_pk_mul_f32 v[144:145], v[68:69], v[76:77]
    v_pk_mul_f32 v[146:147], v[70:71], v[78:79]
    v_pk_fma_f32 v[132:133], v[132:133], v[114:115], v[114:115] op_sel_hi:[1,0,0]
    v_pk_fma_f32 v[134:135], v[134:135], v[114:115], v[114:115] op_sel_hi:[1,0,0]
    v_pk_fma_f32 v[136:137], v[136:137], v[114:115], v[114:115] op_sel_hi:[1,0,0]
    v_pk_fma_f32 v[138:139], v[138:139], v[114:115], v[114:115] op_sel_hi:[1,0,0]
    v_rcp_f32 v132, v132
    v_rcp_f32 v133, v133
    v_rcp_f32 v134, v134
    v_rcp_f32 v135, v135
    v_rcp_f32 v136, v136
    v_rcp_f32 v137, v137
    v_rcp_f32 v138, v138
    v_rcp_f32 v139, v139
    v_pk_mul_f32 v[140:141], v[140:141], v[132:133]
    v_pk_mul_f32 v[142:143], v[142:143], v[134:135]
    v_pk_mul_f32 v[144:145], v[144:145], v[136:137]
    v_pk_mul_f32 v[146:147], v[146:147], v[138:139]
    v_cvt_pk_bf16_f32 v148, v140, v141
    v_cvt_pk_bf16_f32 v149, v142, v143
    v_cvt_pk_bf16_f32 v150, v144, v145
    v_cvt_pk_bf16_f32 v151, v146, v147
    buffer_store_dwordx4 v[148:151], v7, s[48:51], s38 offen offset:0 sc1
    v_pk_mul_f32 v[132:133], v[80:81], v[80:81]
    v_pk_mul_f32 v[134:135], v[82:83], v[82:83]
    v_pk_mul_f32 v[136:137], v[84:85], v[84:85]
    v_pk_mul_f32 v[138:139], v[86:87], v[86:87]
    v_pk_fma_f32 v[132:133], v[132:133], v[112:113], v[112:113] op_sel:[0,1,0] op_sel_hi:[1,1,0]
    v_pk_fma_f32 v[134:135], v[134:135], v[112:113], v[112:113] op_sel:[0,1,0] op_sel_hi:[1,1,0]
    v_pk_fma_f32 v[136:137], v[136:137], v[112:113], v[112:113] op_sel:[0,1,0] op_sel_hi:[1,1,0]
    v_pk_fma_f32 v[138:139], v[138:139], v[112:113], v[112:113] op_sel:[0,1,0] op_sel_hi:[1,1,0]
    v_pk_mul_f32 v[132:133], v[80:81], v[132:133]
    v_pk_mul_f32 v[134:135], v[82:83], v[134:135]
    v_pk_mul_f32 v[136:137], v[84:85], v[136:137]
    v_pk_mul_f32 v[138:139], v[86:87], v[138:139]
    v_exp_f32 v132, v132
    v_exp_f32 v133, v133
    v_exp_f32 v134, v134
    v_exp_f32 v135, v135
    v_exp_f32 v136, v136
    v_exp_f32 v137, v137
    v_exp_f32 v138, v138
    v_exp_f32 v139, v139
    v_pk_mul_f32 v[140:141], v[80:81], v[88:89]
    v_pk_mul_f32 v[142:143], v[82:83], v[90:91]
    v_pk_mul_f32 v[144:145], v[84:85], v[92:93]
    v_pk_mul_f32 v[146:147], v[86:87], v[94:95]
    v_pk_fma_f32 v[132:133], v[132:133], v[114:115], v[114:115] op_sel_hi:[1,0,0]
    v_pk_fma_f32 v[134:135], v[134:135], v[114:115], v[114:115] op_sel_hi:[1,0,0]
    v_pk_fma_f32 v[136:137], v[136:137], v[114:115], v[114:115] op_sel_hi:[1,0,0]
    v_pk_fma_f32 v[138:139], v[138:139], v[114:115], v[114:115] op_sel_hi:[1,0,0]
    v_rcp_f32 v132, v132
    v_rcp_f32 v133, v133
    v_rcp_f32 v134, v134
    v_rcp_f32 v135, v135
    v_rcp_f32 v136, v136
    v_rcp_f32 v137, v137
    v_rcp_f32 v138, v138
    v_rcp_f32 v139, v139
    v_pk_mul_f32 v[140:141], v[140:141], v[132:133]
    v_pk_mul_f32 v[142:143], v[142:143], v[134:135]
    v_pk_mul_f32 v[144:145], v[144:145], v[136:137]
    v_pk_mul_f32 v[146:147], v[146:147], v[138:139]
    v_cvt_pk_bf16_f32 v152, v140, v141
    v_cvt_pk_bf16_f32 v153, v142, v143
    v_cvt_pk_bf16_f32 v154, v144, v145
    v_cvt_pk_bf16_f32 v155, v146, v147
    buffer_store_dwordx4 v[152:155], v7, s[48:51], s38 offen offset:1024 sc1
    s_mov_b64 exec, 0xffff
    buffer_store_dwordx2 v[26:27], v29, s[48:51], s61 offen sc1
    s_mov_b64 exec, -1
    s_cmp_eq_u32 s66, 0x40000000
    s_cbranch_scc1 L_slow_17
L_back_16:
    s_waitcnt vmcnt(26)
    v_mfma_f32_32x32x16_bf16 v[32:47], v[160:163], a[0:3], 0
    s_add_u32 s76, s71, 24576
    buffer_load_dwordx4 a[80:83], v7, s[48:51], s76 offen offset:0 sc1
    s_lshl_b32 s56, s63, 12
    s_lshl_b32 s72, s62, 15
    v_mfma_f32_32x32x16_bf16 v[48:63], v[164:167], a[0:3], 0
    ds_read_b128 a[176:179], v17 offset:28672
    s_add_u32 s56, s56, s77
    s_lshl_b32 s65, s3, 7
    s_add_u32 s72, s72, s56
    v_lshrrev_b32 v13, 1, v2
    s_add_u32 s72, s72, s65
    v_and_b32 v12, 1, v0
    s_waitcnt vmcnt(26)
    v_mfma_f32_32x32x16_bf16 v[32:47], v[168:171], a[4:7], v[32:47]
    ds_read_b128 a[180:183], v17 offset:29696
    buffer_load_dwordx4 a[84:87], v7, s[48:51], s76 offen offset:1024 sc1
    s_add_u32 s72, s72, 393216
    v_lshlrev_b32 v13, 10, v13
    s_add_u32 s73, s72, 0x10000
    v_lshl_add_u32 v13, v12, 3, v13
    s_waitcnt vmcnt(6)
    v_cmp_ne_u64 vcc, s[52:53], v[30:31]
    s_nop 0
    s_cmp_eq_u64 vcc, 0
    s_cselect_b32 s67, s71, 0x40000000
    v_mfma_f32_32x32x16_bf16 v[48:63], v[172:175], a[4:7], v[48:63]
    ds_read_b128 a[184:187], v17 offset:30720
    v_and_b32 v12, 3, v0
    v_lshl_add_u32 v13, v3, 4, v13
    v_mul_u32_u24 v12, 1088, v12
    v_lshrrev_b32 v14, 2, v2
    v_lshl_add_u32 v12, v3, 4, v12
    v_mul_u32_u24 v14, 28672, v14
    v_mfma_f32_32x32x16_bf16 v[32:47], v[176:179], a[8:11], v[32:47]
    ds_read_b128 a[188:191], v17 offset:31744
    s_add_u32 s76, s71, 32768
    buffer_load_dwordx4 a[88:91], v7, s[48:51], s76 offen offset:0 sc1
    v_add_u32 v10, s32, v7
    v_add3_u32 v12, v12, v14, s65
    v_add_u32 v11, 16384, v10
    v_mfma_f32_32x32x16_bf16 v[48:63], v[180:183], a[8:11], v[48:63]
    ds_read_b128 a[192:195], v17 offset:32768
    v_add_u32 v14, 16384, v12
    v_add_u32 v10, 73728, v10
    v_add_u32 v12, 73728, v12
    v_mul_u32_u24 v15, 896, v3
    v_lshlrev_b32 v20, 5, v2
    v_lshl_add_u32 v15, v2, 4, v15
    v_mfma_f32_32x32x16_bf16 v[32:47], v[184:187], a[12:15], v[32:47]
    ds_read_b128 a[196:199], v17 offset:33792
    buffer_load_dwordx4 a[92:95], v7, s[48:51], s76 offen offset:1024 sc1
    s_lshl_b32 s56, s4, 2
    s_add_u32 s56, s56, s62
    s_mul_i32 s74, s56, 28672
    s_lshl_b32 s56, s63, 7
    v_mfma_f32_32x32x16_bf16 v[48:63], v[188:191], a[12:15], v[48:63]
    ds_read_b128 a[200:203], v16 offset:0
    s_add_u32 s74, s74, s32
    s_add_u32 s74, s74, s56
    s_add_u32 s75, s74, 57344
    v_mfma_f32_32x32x16_bf16 v[32:47], v[192:195], a[16:19], v[32:47]
    ds_read_b128 a[204:207], v16 offset:1024
    s_add_u32 s76, s71, 40960
    buffer_load_dwordx4 a[96:99], v7, s[48:51], s76 offen offset:0 sc1
    v_mfma_f32_32x32x16_bf16 v[48:63], v[196:199], a[16:19], v[48:63]
    ds_read_b128 a[208:211], v16 offset:2048
    v_mfma_f32_32x32x16_bf16 v[32:47], v[200:203], a[20:23], v[32:47]
    ds_read_b128 a[212:215], v16 offset:3072
    buffer_load_dwordx4 a[100:103], v7, s[48:51], s76 offen offset:1024 sc1
    v_mfma_f32_32x32x16_bf16 v[48:63], v[204:207], a[20:23], v[48:63]
    ds_read_b128 a[216:219], v16 offset:4096
    v_mfma_f32_32x32x16_bf16 v[32:47], v[208:211], a[24:27], v[32:47]
    ds_read_b128 a[220:223], v16 offset:5120
    s_add_u32 s76, s71, 49152
    buffer_load_dwordx4 a[104:107], v7, s[48:51], s76 offen offset:0 sc1
    v_mfma_f32_32x32x16_bf16 v[48:63], v[212:215], a[24:27], v[48:63]
    v_mfma_f32_32x32x16_bf16 v[32:47], v[216:219], a[28:31], v[32:47]
    buffer_load_dwordx4 a[108:111], v7, s[48:51], s76 offen offset:1024 sc1
    v_mfma_f32_32x32x16_bf16 v[48:63], v[220:223], a[28:31], v[48:63]
    v_mfma_f32_32x32x16_bf16 v[32:47], v[224:227], a[32:35], v[32:47]
    buffer_load_dwordx2 v[16:17], v13, s[48:51], s72 offen offset:0 sc1
    v_mfma_f32_32x32x16_bf16 v[48:63], v[228:231], a[32:35], v[48:63]
    v_mfma_f32_32x32x16_bf16 v[32:47], v[232:235], a[36:39], v[32:47]
    buffer_load_dwordx2 v[18:19], v13, s[48:51], s72 offen offset:512 sc1
    v_mfma_f32_32x32x16_bf16 v[48:63], v[236:239], a[36:39], v[48:63]
    v_mfma_f32_32x32x16_bf16 v[32:47], v[240:243], a[40:43], v[32:47]
    buffer_load_dwordx2 v[156:157], v13, s[48:51], s73 offen offset:0 sc1
    v_mfma_f32_32x32x16_bf16 v[48:63], v[244:247], a[40:43], v[48:63]
    v_mfma_f32_32x32x16_bf16 v[32:47], v[248:251], a[44:47], v[32:47]
    buffer_load_dwordx2 v[158:159], v13, s[48:51], s73 offen offset:512 sc1
    v_mfma_f32_32x32x16_bf16 v[48:63], v[252:255], a[44:47], v[48:63]
    s_waitcnt lgkmcnt(0)
    s_add_u32 s57, s68, 16384
        s_buffer_load_dwordx2 s[8:9], s[48:51], s57 offset:0 glc
        s_buffer_load_dwordx2 s[10:11], s[48:51], s57 offset:512 glc
        s_buffer_load_dwordx2 s[20:21], s[48:51], s57 offset:1024 glc
        s_buffer_load_dwordx2 s[22:23], s[48:51], s57 offset:1536 glc
        s_buffer_load_dwordx2 s[24:25], s[48:51], s57 offset:2048 glc
        s_buffer_load_dwordx2 s[26:27], s[48:51], s57 offset:2560 glc
        s_buffer_load_dwordx2 s[12:13], s[48:51], s57 offset:3072 glc
    v_mfma_f32_32x32x16_bf16 v[32:47], a[224:227], a[48:51], v[32:47]
    s_add_u32 s76, s70, 229376
    buffer_load_dwordx4 a[0:3], v7, s[48:51], s76 offen offset:0 sc1
    v_mfma_f32_32x32x16_bf16 v[48:63], a[228:231], a[48:51], v[48:63]
    v_mfma_f32_32x32x16_bf16 v[32:47], a[232:235], a[52:55], v[32:47]
    buffer_load_dwordx4 a[4:7], v7, s[48:51], s76 offen offset:1024 sc1
    v_mfma_f32_32x32x16_bf16 v[48:63], a[236:239], a[52:55], v[48:63]
    s_cmp_eq_u32 s67, 0x40000000
    s_cbranch_scc1 L_slow_19
L_back_18:
    v_mfma_f32_32x32x16_bf16 v[32:47], a[240:243], a[56:59], v[32:47]
    s_add_u32 s76, s70, 237568
    buffer_load_dwordx4 a[8:11], v7, s[48:51], s76 offen offset:0 sc1
    v_mfma_f32_32x32x16_bf16 v[48:63], a[244:247], a[56:59], v[48:63]
    v_mfma_f32_32x32x16_bf16 v[32:47], a[248:251], a[60:63], v[32:47]
    buffer_load_dwordx4 a[12:15], v7, s[48:51], s76 offen offset:1024 sc1
    v_mfma_f32_32x32x16_bf16 v[48:63], a[252:255], a[60:63], v[48:63]
    v_mfma_f32_32x32x16_bf16 v[32:47], a[128:131], a[64:67], v[32:47]
    s_add_u32 s76, s70, 245760
    buffer_load_dwordx4 a[16:19], v7, s[48:51], s76 offen offset:0 sc1
    v_mfma_f32_32x32x16_bf16 v[48:63], a[132:135], a[64:67], v[48:63]
    v_mfma_f32_32x32x16_bf16 v[32:47], a[136:139], a[68:71], v[32:47]
    buffer_load_dwordx4 a[20:23], v7, s[48:51], s76 offen offset:1024 sc1
    v_mfma_f32_32x32x16_bf16 v[48:63], a[140:143], a[68:71], v[48:63]
    v_mfma_f32_32x32x16_bf16 v[32:47], a[144:147], a[72:75], v[32:47]
    s_add_u32 s76, s70, 253952
    buffer_load_dwordx4 a[24:27], v7, s[48:51], s76 offen offset:0 sc1
    v_mfma_f32_32x32x16_bf16 v[48:63], a[148:151], a[72:75], v[48:63]
    s_waitcnt vmcnt(22)
    v_mfma_f32_32x32x16_bf16 v[32:47], a[152:155], a[76:79], v[32:47]
    buffer_load_dwordx4 a[28:31], v7, s[48:51], s76 offen offset:1024 sc1
    v_mfma_f32_32x32x16_bf16 v[48:63], a[156:159], a[76:79], v[48:63]
    s_waitcnt vmcnt(19)
    v_mfma_f32_32x32x16_bf16 v[32:47], a[160:163], a[80:83], v[32:47]
    s_add_u32 s76, s70, 262144
    buffer_load_dwordx4 a[32:35], v7, s[48:51], s76 offen offset:0 sc1
    v_mfma_f32_32x32x16_bf16 v[48:63], a[164:167], a[80:83], v[48:63]
    s_waitcnt vmcnt(19)
    v_mfma_f32_32x32x16_bf16 v[32:47], a[168:171], a[84:87], v[32:47]
    buffer_load_dwordx4 a[36:39], v7, s[48:51], s76 offen offset:1024 sc1
    v_mfma_f32_32x32x16_bf16 v[48:63], a[172:175], a[84:87], v[48:63]
    s_waitcnt vmcnt(19)
    v_mfma_f32_32x32x16_bf16 v[32:47], a[176:179], a[88:91], v[32:47]
    s_add_u32 s76, s70, 270336
    buffer_load_dwordx4 a[40:43], v7, s[48:51], s76 offen offset:0 sc1
    v_mfma_f32_32x32x16_bf16 v[48:63], a[180:183], a[88:91], v[48:63]
    s_waitcnt vmcnt(19)
    v_mfma_f32_32x32x16_bf16 v[32:47], a[184:187], a[92:95], v[32:47]
    buffer_load_dwordx4 a[44:47], v7, s[48:51], s76 offen offset:1024 sc1
    v_mfma_f32_32x32x16_bf16 v[48:63], a[188:191], a[92:95], v[48:63]
    s_waitcnt vmcnt(19)
    v_mfma_f32_32x32x16_bf16 v[32:47], a[192:195], a[96:99], v[32:47]
    s_add_u32 s76, s70, 278528
    buffer_load_dwordx4 a[48:51], v7, s[48:51], s76 offen offset:0 sc1
    v_mfma_f32_32x32x16_bf16 v[48:63], a[196:199], a[96:99], v[48:63]
    s_waitcnt vmcnt(19)
    v_mfma_f32_32x32x16_bf16 v[32:47], a[200:203], a[100:103], v[32:47]
    buffer_load_dwordx4 a[52:55], v7, s[48:51], s76 offen offset:1024 sc1
    s_waitcnt lgkmcnt(0)
    s_xor_b64 s[8:9], s[8:9], s[52:53]
    s_xor_b64 s[10:11], s[10:11], s[52:53]
    s_xor_b64 s[20:21], s[20:21], s[52:53]
    s_xor_b64 s[22:23], s[22:23], s[52:53]
    s_xor_b64 s[24:25], s[24:25], s[52:53]
    s_xor_b64 s[26:27], s[26:27], s[52:53]
    s_xor_b64 s[12:13], s[12:13], s[52:53]
    s_or_b64 s[8:9], s[8:9], s[10:11]
    s_or_b64 s[20:21], s[20:21], s[22:23]
    s_or_b64 s[24:25], s[24:25], s[26:27]
    s_or_b64 s[8:9], s[8:9], s[12:13]
    s_or_b64 s[20:21], s[20:21], s[24:25]
    s_or_b64 s[8:9], s[8:9], s[20:21]
    s_cselect_b32 s59, 0x40000000, s70
    v_mfma_f32_32x32x16_bf16 v[48:63], a[204:207], a[100:103], v[48:63]
    s_waitcnt vmcnt(19)
    v_mfma_f32_32x32x16_bf16 v[32:47], a[208:211], a[104:107], v[32:47]
    v_mfma_f32_32x32x16_bf16 v[48:63], a[212:215], a[104:107], v[48:63]
    s_waitcnt vmcnt(18)
    v_mfma_f32_32x32x16_bf16 v[32:47], a[216:219], a[108:111], v[32:47]
    v_mfma_f32_32x32x16_bf16 v[48:63], a[220:223], a[108:111], v[48:63]
    s_cmp_eq_u32 s59, 0x40000000
    s_cbranch_scc1 L_slow_21
L_back_20:
    s_waitcnt vmcnt(13)
    v_mfma_f32_32x32x16_bf16 v[64:79], v[160:163], a[0:3], 0
    s_add_u32 s57, s69, 16384
        s_buffer_load_dwordx2 s[8:9], s[48:51], s57 offset:0 glc
        s_buffer_load_dwordx2 s[10:11], s[48:51], s57 offset:512 glc
        s_buffer_load_dwordx2 s[20:21], s[48:51], s57 offset:1024 glc
        s_buffer_load_dwordx2 s[22:23], s[48:51], s57 offset:1536 glc
        s_buffer_load_dwordx2 s[24:25], s[48:51], s57 offset:2048 glc
        s_buffer_load_dwordx2 s[26:27], s[48:51], s57 offset:2560 glc
        s_buffer_load_dwordx2 s[12:13], s[48:51], s57 offset:3072 glc
    v_mfma_f32_32x32x16_bf16 v[80:95], v[164:167], a[0:3], 0
    s_add_u32 s76, s71, 229376
    buffer_load_dwordx4 v[96:99], v7, s[48:51], s76 offen offset:0 sc1
    s_waitcnt vmcnt(13)
    v_mfma_f32_32x32x16_bf16 v[64:79], v[168:171], a[4:7], v[64:79]
    v_mfma_f32_32x32x16_bf16 v[80:95], v[172:175], a[4:7], v[80:95]
    buffer_load_dwordx4 v[100:103], v7, s[48:51], s76 offen offset:1024 sc1
    v_cmp_u_f32 vcc, v32, v32
    s_cbranch_vccnz L_p4redo0
L_p4ok0:
    s_waitcnt vmcnt(13)
    v_mfma_f32_32x32x16_bf16 v[64:79], v[176:179], a[8:11], v[64:79]
    ds_write_b128 v10, v[32:35] offset:0
    v_mfma_f32_32x32x16_bf16 v[80:95], v[180:183], a[8:11], v[80:95]
    s_add_u32 s76, s71, 237568
    buffer_load_dwordx4 v[104:107], v7, s[48:51], s76 offen offset:0 sc1
    s_waitcnt vmcnt(13)
    v_mfma_f32_32x32x16_bf16 v[64:79], v[184:187], a[12:15], v[64:79]
    ds_write_b128 v10, v[36:39] offset:1088
    v_mfma_f32_32x32x16_bf16 v[80:95], v[188:191], a[12:15], v[80:95]
    buffer_load_dwordx4 v[108:111], v7, s[48:51], s76 offen offset:1024 sc1
    s_waitcnt vmcnt(13)
    v_mfma_f32_32x32x16_bf16 v[64:79], v[192:195], a[16:19], v[64:79]
    ds_write_b128 v10, v[40:43] offset:2176
    v_mfma_f32_32x32x16_bf16 v[80:95], v[196:199], a[16:19], v[80:95]
    s_add_u32 s76, s71, 245760
    buffer_load_dwordx4 v[112:115], v7, s[48:51], s76 offen offset:0 sc1
    s_waitcnt vmcnt(13)
    v_mfma_f32_32x32x16_bf16 v[64:79], v[200:203], a[20:23], v[64:79]
    ds_write_b128 v10, v[44:47] offset:3264
    v_mfma_f32_32x32x16_bf16 v[80:95], v[204:207], a[20:23], v[80:95]
    buffer_load_dwordx4 v[116:119], v7, s[48:51], s76 offen offset:1024 sc1
    s_waitcnt vmcnt(13)
    v_mfma_f32_32x32x16_bf16 v[64:79], v[208:211], a[24:27], v[64:79]
    ds_write_b128 v10, v[48:51] offset:28672
    v_mfma_f32_32x32x16_bf16 v[80:95], v[212:215], a[24:27], v[80:95]
    s_add_u32 s76, s71, 253952
    buffer_load_dwordx4 v[120:123], v7, s[48:51], s76 offen offset:0 sc1
    s_waitcnt vmcnt(13)
    v_mfma_f32_32x32x16_bf16 v[64:79], v[216:219], a[28:31], v[64:79]
    ds_write_b128 v10, v[52:55] offset:29760
    v_mfma_f32_32x32x16_bf16 v[80:95], v[220:223], a[28:31], v[80:95]
    buffer_load_dwordx4 v[124:127], v7, s[48:51], s76 offen offset:1024 sc1
    s_waitcnt vmcnt(13)
    v_mfma_f32_32x32x16_bf16 v[64:79], v[224:227], a[32:35], v[64:79]
    ds_write_b128 v10, v[56:59] offset:30848
    v_mfma_f32_32x32x16_bf16 v[80:95], v[228:231], a[32:35], v[80:95]
    s_add_u32 s76, s71, 262144
    buffer_load_dwordx4 v[128:131], v7, s[48:51], s76 offen offset:0 sc1
    s_waitcnt vmcnt(13)
    v_mfma_f32_32x32x16_bf16 v[64:79], v[232:235], a[36:39], v[64:79]
    ds_write_b128 v10, v[60:63] offset:31936
    v_mfma_f32_32x32x16_bf16 v[80:95], v[236:239], a[36:39], v[80:95]
    buffer_load_dwordx4 v[132:135], v7, s[48:51], s76 offen offset:1024 sc1
    s_waitcnt vmcnt(13)
    v_mfma_f32_32x32x16_bf16 v[64:79], v[240:243], a[40:43], v[64:79]
    v_mfma_f32_32x32x16_bf16 v[80:95], v[244:247], a[40:43], v[80:95]
    s_add_u32 s76, s71, 270336
    buffer_load_dwordx4 v[136:139], v7, s[48:51], s76 offen offset:0 sc1
    s_waitcnt vmcnt(13)
    v_mfma_f32_32x32x16_bf16 v[64:79], v[248:251], a[44:47], v[64:79]
    v_mfma_f32_32x32x16_bf16 v[80:95], v[252:255], a[44:47], v[80:95]
    buffer_load_dwordx4 v[140:143], v7, s[48:51], s76 offen offset:1024 sc1
    s_waitcnt vmcnt(13)
    v_mfma_f32_32x32x16_bf16 v[64:79], a[224:227], a[48:51], v[64:79]
    v_mfma_f32_32x32x16_bf16 v[80:95], a[228:231], a[48:51], v[80:95]
    s_add_u32 s76, s71, 278528
    buffer_load_dwordx4 v[144:147], v7, s[48:51], s76 offen offset:0 sc1
    s_waitcnt vmcnt(13)
    v_mfma_f32_32x32x16_bf16 v[64:79], a[232:235], a[52:55], v[64:79]
    v_mfma_f32_32x32x16_bf16 v[80:95], a[236:239], a[52:55], v[80:95]
    buffer_load_dwordx4 v[148:151], v7, s[48:51], s76 offen offset:1024 sc1
    s_waitcnt lgkmcnt(0)
    s_xor_b64 s[8:9], s[8:9], s[52:53]
    s_xor_b64 s[10:11], s[10:11], s[52:53]
    s_xor_b64 s[20:21], s[20:21], s[52:53]
    s_xor_b64 s[22:23], s[22:23], s[52:53]
    s_xor_b64 s[24:25], s[24:25], s[52:53]
    s_xor_b64 s[26:27], s[26:27], s[52:53]
    s_xor_b64 s[12:13], s[12:13], s[52:53]
    s_or_b64 s[8:9], s[8:9], s[10:11]
    s_or_b64 s[20:21], s[20:21], s[22:23]
    s_or_b64 s[24:25], s[24:25], s[26:27]
    s_or_b64 s[8:9], s[8:9], s[12:13]
    s_or_b64 s[20:21], s[20:21], s[24:25]
    s_or_b64 s[8:9], s[8:9], s[20:21]
    s_cselect_b32 s60, 0x40000000, s71
    s_cmp_eq_u32 s60, 0x40000000
    s_cbranch_scc1 L_slow_23
L_back_22:
    s_barrier
    s_waitcnt vmcnt(13)
    v_mfma_f32_32x32x16_bf16 v[64:79], a[240:243], v[96:99], v[64:79]
    ds_read_b128 v[22:25], v20 offset:4352
    ds_read_b128 v[26:29], v20 offset:4368
    v_mfma_f32_32x32x16_bf16 v[80:95], a[244:247], v[96:99], v[80:95]
    ds_read_b128 v[32:35], v12 offset:0
    ds_read_b128 v[36:39], v12 offset:512
    s_waitcnt vmcnt(12)
    v_mfma_f32_32x32x16_bf16 v[64:79], a[248:251], v[100:103], v[64:79]
    ds_read_b128 v[40:43], v12 offset:7168
    ds_read_b128 v[44:47], v12 offset:7680
    v_mfma_f32_32x32x16_bf16 v[80:95], a[252:255], v[100:103], v[80:95]
    ds_read_b128 v[48:51], v12 offset:14336
    ds_read_b128 v[52:55], v12 offset:14848
    s_waitcnt vmcnt(11)
    v_mfma_f32_32x32x16_bf16 v[64:79], a[128:131], v[104:107], v[64:79]
    ds_read_b128 v[56:59], v12 offset:21504
    ds_read_b128 v[60:63], v12 offset:22016
    v_mfma_f32_32x32x16_bf16 v[80:95], a[132:135], v[104:107], v[80:95]
    s_waitcnt vmcnt(10)
    v_mfma_f32_32x32x16_bf16 v[64:79], a[136:139], v[108:111], v[64:79]
    s_waitcnt lgkmcnt(5)
    v_add_f32 v32, v32, v40
    v_add_f32 v33, v33, v41
    v_add_f32 v34, v34, v42
    v_add_f32 v35, v35, v43
    s_waitcnt lgkmcnt(4)
    v_add_f32 v36, v36, v44
    v_add_f32 v37, v37, v45
    v_mfma_f32_32x32x16_bf16 v[80:95], a[140:143], v[108:111], v[80:95]
    v_add_f32 v38, v38, v46
    v_add_f32 v39, v39, v47
    v_lshlrev_b32 v40, 16, v16
    v_and_b32 v41, s55, v16
    v_lshlrev_b32 v42, 16, v17
    v_and_b32 v43, s55, v17
    s_waitcnt vmcnt(9)
    v_mfma_f32_32x32x16_bf16 v[64:79], a[144:147], v[112:115], v[64:79]
    v_lshlrev_b32 v44, 16, v18
    v_and_b32 v45, s55, v18
    v_lshlrev_b32 v46, 16, v19
    v_and_b32 v47, s55, v19
    s_waitcnt lgkmcnt(1)
    v_add_f32 v48, v48, v56
    v_add_f32 v49, v49, v57
    v_mfma_f32_32x32x16_bf16 v[80:95], a[148:151], v[112:115], v[80:95]
    v_add_f32 v50, v50, v58
    v_add_f32 v51, v51, v59
    s_waitcnt lgkmcnt(0)
    v_add_f32 v52, v52, v60
    v_add_f32 v53, v53, v61
    v_add_f32 v54, v54, v62
    v_add_f32 v55, v55, v63
    s_waitcnt vmcnt(8)
    v_mfma_f32_32x32x16_bf16 v[64:79], a[152:155], v[116:119], v[64:79]
    v_add_f32 v32, v32, v48
    v_add_f32 v33, v33, v49
    v_add_f32 v34, v34, v50
    v_add_f32 v35, v35, v51
    v_add_f32 v36, v36, v52
    v_add_f32 v37, v37, v53
    v_mfma_f32_32x32x16_bf16 v[80:95], a[156:159], v[116:119], v[80:95]
    v_add_f32 v38, v38, v54
    v_add_f32 v39, v39, v55
    v_fmac_f32 v40, v32, v22
    v_fmac_f32 v41, v33, v23
    v_fmac_f32 v42, v34, v24
    v_fmac_f32 v43, v35, v25
    s_waitcnt vmcnt(7)
    v_mfma_f32_32x32x16_bf16 v[64:79], a[160:163], v[120:123], v[64:79]
    v_fmac_f32 v44, v36, v26
    v_fmac_f32 v45, v37, v27
    v_fmac_f32 v46, v38, v28
    v_fmac_f32 v47, v39, v29
    v_cvt_pk_bf16_f32 v16, v40, v41
    v_cvt_pk_bf16_f32 v17, v42, v43
    v_mfma_f32_32x32x16_bf16 v[80:95], a[164:167], v[120:123], v[80:95]
    v_cvt_pk_bf16_f32 v18, v44, v45
    v_cvt_pk_bf16_f32 v19, v46, v47
    s_waitcnt vmcnt(6)
    v_mfma_f32_32x32x16_bf16 v[64:79], a[168:171], v[124:127], v[64:79]
    buffer_store_dwordx4 v[16:19], v15, s[40:43], s74 offen sc1
    v_mfma_f32_32x32x16_bf16 v[80:95], a[172:175], v[124:127], v[80:95]
    s_waitcnt vmcnt(6)
    v_mfma_f32_32x32x16_bf16 v[64:79], a[176:179], v[128:131], v[64:79]
    s_waitcnt vmcnt(5)
    v_mfma_f32_32x32x16_bf16 v[64:79], a[184:187], v[132:135], v[64:79]
    s_waitcnt vmcnt(4)
    v_mfma_f32_32x32x16_bf16 v[64:79], a[192:195], v[136:139], v[64:79]
    s_waitcnt vmcnt(3)
    v_mfma_f32_32x32x16_bf16 v[64:79], a[200:203], v[140:143], v[64:79]
    s_waitcnt vmcnt(2)
    v_mfma_f32_32x32x16_bf16 v[64:79], a[208:211], v[144:147], v[64:79]
    s_waitcnt vmcnt(1)
    v_mfma_f32_32x32x16_bf16 v[64:79], a[216:219], v[148:151], v[64:79]
    v_mfma_f32_32x32x16_bf16 v[80:95], a[180:183], v[128:131], v[80:95]
    v_mfma_f32_32x32x16_bf16 v[80:95], a[188:191], v[132:135], v[80:95]
    v_mfma_f32_32x32x16_bf16 v[80:95], a[196:199], v[136:139], v[80:95]
    s_nop 8
    ds_write_b128 v11, v[64:67] offset:0
    v_mfma_f32_32x32x16_bf16 v[80:95], a[204:207], v[140:143], v[80:95]
    ds_write_b128 v11, v[68:71] offset:1088
    v_mfma_f32_32x32x16_bf16 v[80:95], a[212:215], v[144:147], v[80:95]
    ds_write_b128 v11, v[72:75] offset:2176
    v_mfma_f32_32x32x16_bf16 v[80:95], a[220:223], v[148:151], v[80:95]
    ds_write_b128 v11, v[76:79] offset:3264
    v_cmp_u_f32 vcc, v64, v64
    s_cbranch_vccnz L_p4redo
L_p4ok:
    s_nop 8
    ds_write_b128 v11, v[80:83] offset:28672
    ds_write_b128 v11, v[84:87] offset:29760
    ds_write_b128 v11, v[88:91] offset:30848
    ds_write_b128 v11, v[92:95] offset:31936
    v_lshlrev_b32 v96, 16, v156
    v_and_b32 v97, s55, v156
    v_lshlrev_b32 v98, 16, v157
    v_and_b32 v99, s55, v157
    v_lshlrev_b32 v100, 16, v158
    v_and_b32 v101, s55, v158
    v_lshlrev_b32 v102, 16, v159
    v_and_b32 v103, s55, v159
    s_waitcnt lgkmcnt(0)
    s_barrier
    ds_read_b128 v[32:35], v14 offset:0
    ds_read_b128 v[36:39], v14 offset:512
    ds_read_b128 v[40:43], v14 offset:7168
    ds_read_b128 v[44:47], v14 offset:7680
    ds_read_b128 v[48:51], v14 offset:14336
    ds_read_b128 v[52:55], v14 offset:14848
    ds_read_b128 v[56:59], v14 offset:21504
    ds_read_b128 v[60:63], v14 offset:22016
    s_waitcnt lgkmcnt(5)
    v_pk_add_f32 v[32:33], v[32:33], v[40:41]
    v_pk_add_f32 v[34:35], v[34:35], v[42:43]
    s_waitcnt lgkmcnt(4)
    v_pk_add_f32 v[36:37], v[36:37], v[44:45]
    v_pk_add_f32 v[38:39], v[38:39], v[46:47]
    s_waitcnt lgkmcnt(1)
    v_pk_add_f32 v[48:49], v[48:49], v[56:57]
    v_pk_add_f32 v[50:51], v[50:51], v[58:59]
    s_waitcnt lgkmcnt(0)
    v_pk_add_f32 v[52:53], v[52:53], v[60:61]
    v_pk_add_f32 v[54:55], v[54:55], v[62:63]
    v_pk_add_f32 v[32:33], v[32:33], v[48:49]
    v_pk_add_f32 v[34:35], v[34:35], v[50:51]
    v_pk_add_f32 v[36:37], v[36:37], v[52:53]
    v_pk_add_f32 v[38:39], v[38:39], v[54:55]
    v_pk_fma_f32 v[96:97], v[32:33], v[22:23], v[96:97]
    v_pk_fma_f32 v[98:99], v[34:35], v[24:25], v[98:99]
    v_pk_fma_f32 v[100:101], v[36:37], v[26:27], v[100:101]
    v_pk_fma_f32 v[102:103], v[38:39], v[28:29], v[102:103]
    v_cvt_pk_bf16_f32 v156, v96, v97
    v_cvt_pk_bf16_f32 v157, v98, v99
    v_cvt_pk_bf16_f32 v158, v100, v101
    v_cvt_pk_bf16_f32 v159, v102, v103
    buffer_store_dwordx4 v[156:159], v15, s[40:43], s75 offen sc1
    s_branch L_fin
L_slow_17:
    v_min_u32 v21, 6, v0
    v_lshlrev_b32 v21, 9, v21
    s_mov_b32 s54, 0
L_slow_17l:
    s_add_u32 s57, s68, 0
    buffer_load_dwordx2 v[8:9], v21, s[48:51], s57 offen sc1
    s_add_u32 s57, s70, 0
    buffer_load_dwordx4 a[0:3], v7, s[48:51], s57 offen offset:0 sc1
    buffer_load_dwordx4 a[4:7], v7, s[48:51], s57 offen offset:1024 sc1
    s_add_u32 s57, s70, 8192
    buffer_load_dwordx4 a[8:11], v7, s[48:51], s57 offen offset:0 sc1
    buffer_load_dwordx4 a[12:15], v7, s[48:51], s57 offen offset:1024 sc1
    s_add_u32 s57, s70, 16384
    buffer_load_dwordx4 a[16:19], v7, s[48:51], s57 offen offset:0 sc1
    buffer_load_dwordx4 a[20:23], v7, s[48:51], s57 offen offset:1024 sc1
    s_add_u32 s57, s70, 24576
    buffer_load_dwordx4 a[24:27], v7, s[48:51], s57 offen offset:0 sc1
    buffer_load_dwordx4 a[28:31], v7, s[48:51], s57 offen offset:1024 sc1
    s_add_u32 s57, s70, 32768
    buffer_load_dwordx4 a[32:35], v7, s[48:51], s57 offen offset:0 sc1
    buffer_load_dwordx4 a[36:39], v7, s[48:51], s57 offen offset:1024 sc1
    s_add_u32 s57, s70, 40960
    buffer_load_dwordx4 a[40:43], v7, s[48:51], s57 offen offset:0 sc1
    buffer_load_dwordx4 a[44:47], v7, s[48:51], s57 offen offset:1024 sc1
    s_add_u32 s57, s70, 49152
    buffer_load_dwordx4 a[48:51], v7, s[48:51], s57 offen offset:0 sc1
    buffer_load_dwordx4 a[52:55], v7, s[48:51], s57 offen offset:1024 sc1
    s_waitcnt vmcnt(0)
    v_cmp_ne_u64 vcc, s[52:53], v[8:9]
    s_cbranch_vccz L_back_16
    s_add_u32 s54, s54, 1
    s_cmp_lt_u32 s54, 16384
    s_cbranch_scc1 L_slow_17l
    s_branch L_back_16
L_slow_19:
    v_min_u32 v21, 6, v0
    v_lshlrev_b32 v21, 9, v21
    s_mov_b32 s54, 0
L_slow_19l:
    s_add_u32 s57, s69, 0
    buffer_load_dwordx2 v[8:9], v21, s[48:51], s57 offen sc1
    s_add_u32 s57, s71, 0
    buffer_load_dwordx4 a[56:59], v7, s[48:51], s57 offen offset:0 sc1
    buffer_load_dwordx4 a[60:63], v7, s[48:51], s57 offen offset:1024 sc1
    s_add_u32 s57, s71, 8192
    buffer_load_dwordx4 a[64:67], v7, s[48:51], s57 offen offset:0 sc1
    buffer_load_dwordx4 a[68:71], v7, s[48:51], s57 offen offset:1024 sc1
    s_add_u32 s57, s71, 16384
    buffer_load_dwordx4 a[72:75], v7, s[48:51], s57 offen offset:0 sc1
    buffer_load_dwordx4 a[76:79], v7, s[48:51], s57 offen offset:1024 sc1
    s_add_u32 s57, s71, 24576
    buffer_load_dwordx4 a[80:83], v7, s[48:51], s57 offen offset:0 sc1
    buffer_load_dwordx4 a[84:87], v7, s[48:51], s57 offen offset:1024 sc1
    s_add_u32 s57, s71, 32768
    buffer_load_dwordx4 a[88:91], v7, s[48:51], s57 offen offset:0 sc1
    buffer_load_dwordx4 a[92:95], v7, s[48:51], s57 offen offset:1024 sc1
    s_add_u32 s57, s71, 40960
    buffer_load_dwordx4 a[96:99], v7, s[48:51], s57 offen offset:0 sc1
    buffer_load_dwordx4 a[100:103], v7, s[48:51], s57 offen offset:1024 sc1
    s_add_u32 s57, s71, 49152
    buffer_load_dwordx4 a[104:107], v7, s[48:51], s57 offen offset:0 sc1
    buffer_load_dwordx4 a[108:111], v7, s[48:51], s57 offen offset:1024 sc1
    s_waitcnt vmcnt(0)
    v_cmp_ne_u64 vcc, s[52:53], v[8:9]
    s_cbranch_vccz L_back_18
    s_add_u32 s54, s54, 1
    s_cmp_lt_u32 s54, 16384
    s_cbranch_scc1 L_slow_19l
    s_branch L_back_18
L_slow_21:
    v_min_u32 v21, 6, v0
    v_lshlrev_b32 v21, 9, v21
    s_mov_b32 s54, 0
L_slow_21l:
    s_add_u32 s57, s68, 16384
    buffer_load_dwordx2 v[8:9], v21, s[48:51], s57 offen sc1
    s_add_u32 s57, s70, 229376
    buffer_load_dwordx4 a[0:3], v7, s[48:51], s57 offen offset:0 sc1
    buffer_load_dwordx4 a[4:7], v7, s[48:51], s57 offen offset:1024 sc1
    s_add_u32 s57, s70, 237568
    buffer_load_dwordx4 a[8:11], v7, s[48:51], s57 offen offset:0 sc1
    buffer_load_dwordx4 a[12:15], v7, s[48:51], s57 offen offset:1024 sc1
    s_add_u32 s57, s70, 245760
    buffer_load_dwordx4 a[16:19], v7, s[48:51], s57 offen offset:0 sc1
    buffer_load_dwordx4 a[20:23], v7, s[48:51], s57 offen offset:1024 sc1
    s_add_u32 s57, s70, 253952
    buffer_load_dwordx4 a[24:27], v7, s[48:51], s57 offen offset:0 sc1
    buffer_load_dwordx4 a[28:31], v7, s[48:51], s57 offen offset:1024 sc1
    s_add_u32 s57, s70, 262144
    buffer_load_dwordx4 a[32:35], v7, s[48:51], s57 offen offset:0 sc1
    buffer_load_dwordx4 a[36:39], v7, s[48:51], s57 offen offset:1024 sc1
    s_add_u32 s57, s70, 270336
    buffer_load_dwordx4 a[40:43], v7, s[48:51], s57 offen offset:0 sc1
    buffer_load_dwordx4 a[44:47], v7, s[48:51], s57 offen offset:1024 sc1
    s_add_u32 s57, s70, 278528
    buffer_load_dwordx4 a[48:51], v7, s[48:51], s57 offen offset:0 sc1
    buffer_load_dwordx4 a[52:55], v7, s[48:51], s57 offen offset:1024 sc1
    s_waitcnt vmcnt(0)
    v_cmp_ne_u64 vcc, s[52:53], v[8:9]
    s_cbranch_vccz L_back_20
    s_add_u32 s54, s54, 1
    s_cmp_lt_u32 s54, 16384
    s_cbranch_scc1 L_slow_21l
    s_branch L_back_20
L_slow_23:
    v_min_u32 v21, 6, v0
    v_lshlrev_b32 v21, 9, v21
    s_mov_b32 s54, 0
L_slow_23l:
    s_add_u32 s57, s69, 16384
    buffer_load_dwordx2 v[8:9], v21, s[48:51], s57 offen sc1
    s_add_u32 s57, s71, 229376
    buffer_load_dwordx4 v[96:99], v7, s[48:51], s57 offen offset:0 sc1
    buffer_load_dwordx4 v[100:103], v7, s[48:51], s57 offen offset:1024 sc1
    s_add_u32 s57, s71, 237568
    buffer_load_dwordx4 v[104:107], v7, s[48:51], s57 offen offset:0 sc1
    buffer_load_dwordx4 v[108:111], v7, s[48:51], s57 offen offset:1024 sc1
    s_add_u32 s57, s71, 245760
    buffer_load_dwordx4 v[112:115], v7, s[48:51], s57 offen offset:0 sc1
    buffer_load_dwordx4 v[116:119], v7, s[48:51], s57 offen offset:1024 sc1
    s_add_u32 s57, s71, 253952
    buffer_load_dwordx4 v[120:123], v7, s[48:51], s57 offen offset:0 sc1
    buffer_load_dwordx4 v[124:127], v7, s[48:51], s57 offen offset:1024 sc1
    s_add_u32 s57, s71, 262144
    buffer_load_dwordx4 v[128:131], v7, s[48:51], s57 offen offset:0 sc1
    buffer_load_dwordx4 v[132:135], v7, s[48:51], s57 offen offset:1024 sc1
    s_add_u32 s57, s71, 270336
    buffer_load_dwordx4 v[136:139], v7, s[48:51], s57 offen offset:0 sc1
    buffer_load_dwordx4 v[140:143], v7, s[48:51], s57 offen offset:1024 sc1
    s_add_u32 s57, s71, 278528
    buffer_load_dwordx4 v[144:147], v7, s[48:51], s57 offen offset:0 sc1
    buffer_load_dwordx4 v[148:151], v7, s[48:51], s57 offen offset:1024 sc1
    s_waitcnt vmcnt(0)
    v_cmp_ne_u64 vcc, s[52:53], v[8:9]
    s_cbranch_vccz L_back_22
    s_add_u32 s54, s54, 1
    s_cmp_lt_u32 s54, 16384
    s_cbranch_scc1 L_slow_23l
    s_branch L_back_22
L_p2redo:
    s_mov_b32 s54, 0
L_p2r1:
    s_add_u32 s76, s15, 0
    buffer_load_dwordx4 v[192:195], v7, s[48:51], s76 offen offset:0 sc1
    buffer_load_dwordx4 v[196:199], v7, s[48:51], s76 offen offset:1024 sc1
    buffer_load_dwordx4 v[200:203], v7, s[48:51], s76 offen offset:2048 sc1
    buffer_load_dwordx4 v[204:207], v7, s[48:51], s76 offen offset:3072 sc1
    s_add_u32 s76, s15, 4096
    buffer_load_dwordx4 v[208:211], v7, s[48:51], s76 offen offset:0 sc1
    buffer_load_dwordx4 v[212:215], v7, s[48:51], s76 offen offset:1024 sc1
    buffer_load_dwordx4 v[216:219], v7, s[48:51], s76 offen offset:2048 sc1
    buffer_load_dwordx4 v[220:223], v7, s[48:51], s76 offen offset:3072 sc1
    s_add_u32 s76, s15, 8192
    buffer_load_dwordx4 v[224:227], v7, s[48:51], s76 offen offset:0 sc1
    buffer_load_dwordx4 v[228:231], v7, s[48:51], s76 offen offset:1024 sc1
    buffer_load_dwordx4 v[232:235], v7, s[48:51], s76 offen offset:2048 sc1
    buffer_load_dwordx4 v[236:239], v7, s[48:51], s76 offen offset:3072 sc1
    s_add_u32 s76, s15, 12288
    buffer_load_dwordx4 v[240:243], v7, s[48:51], s76 offen offset:0 sc1
    buffer_load_dwordx4 v[244:247], v7, s[48:51], s76 offen offset:1024 sc1
    buffer_load_dwordx4 v[248:251], v7, s[48:51], s76 offen offset:2048 sc1
    buffer_load_dwordx4 v[252:255], v7, s[48:51], s76 offen offset:3072 sc1
    s_waitcnt vmcnt(15)
    v_mfma_f32_32x32x16_bf16 v[160:175], a[132:135], v[192:195], 0
    v_mfma_f32_32x32x16_bf16 v[128:143], a[128:131], v[192:195], 0
    s_waitcnt vmcnt(14)
    v_mfma_f32_32x32x16_bf16 v[160:175], a[140:143], v[196:199], v[160:175]
    v_mfma_f32_32x32x16_bf16 v[128:143], a[136:139], v[196:199], v[128:143]
    s_waitcnt vmcnt(13)
    v_mfma_f32_32x32x16_bf16 v[160:175], a[148:151], v[200:203], v[160:175]
    v_mfma_f32_32x32x16_bf16 v[128:143], a[144:147], v[200:203], v[128:143]
    s_waitcnt vmcnt(12)
    v_mfma_f32_32x32x16_bf16 v[160:175], a[156:159], v[204:207], v[160:175]
    v_mfma_f32_32x32x16_bf16 v[128:143], a[152:155], v[204:207], v[128:143]
    s_waitcnt vmcnt(11)
    v_mfma_f32_32x32x16_bf16 v[160:175], a[164:167], v[208:211], v[160:175]
    v_mfma_f32_32x32x16_bf16 v[128:143], a[160:163], v[208:211], v[128:143]
    s_waitcnt vmcnt(10)
    v_mfma_f32_32x32x16_bf16 v[160:175], a[172:175], v[212:215], v[160:175]
    v_mfma_f32_32x32x16_bf16 v[128:143], a[168:171], v[212:215], v[128:143]
    s_waitcnt vmcnt(9)
    v_mfma_f32_32x32x16_bf16 v[160:175], a[180:183], v[216:219], v[160:175]
    v_mfma_f32_32x32x16_bf16 v[128:143], a[176:179], v[216:219], v[128:143]
    s_waitcnt vmcnt(8)
    v_mfma_f32_32x32x16_bf16 v[160:175], a[188:191], v[220:223], v[160:175]
    v_mfma_f32_32x32x16_bf16 v[128:143], a[184:187], v[220:223], v[128:143]
    s_waitcnt vmcnt(7)
    v_mfma_f32_32x32x16_bf16 v[160:175], a[196:199], v[224:227], v[160:175]
    v_mfma_f32_32x32x16_bf16 v[128:143], a[192:195], v[224:227], v[128:143]
    s_waitcnt vmcnt(6)
    v_mfma_f32_32x32x16_bf16 v[160:175], a[204:207], v[228:231], v[160:175]
    v_mfma_f32_32x32x16_bf16 v[128:143], a[200:203], v[228:231], v[128:143]
    s_waitcnt vmcnt(5)
    v_mfma_f32_32x32x16_bf16 v[160:175], a[212:215], v[232:235], v[160:175]
    v_mfma_f32_32x32x16_bf16 v[128:143], a[208:211], v[232:235], v[128:143]
    s_waitcnt vmcnt(4)
    v_mfma_f32_32x32x16_bf16 v[160:175], a[220:223], v[236:239], v[160:175]
    v_mfma_f32_32x32x16_bf16 v[128:143], a[216:219], v[236:239], v[128:143]
    s_waitcnt vmcnt(3)
    v_mfma_f32_32x32x16_bf16 v[160:175], a[228:231], v[240:243], v[160:175]
    v_mfma_f32_32x32x16_bf16 v[128:143], a[224:227], v[240:243], v[128:143]
    s_waitcnt vmcnt(2)
    v_mfma_f32_32x32x16_bf16 v[160:175], a[236:239], v[244:247], v[160:175]
    v_mfma_f32_32x32x16_bf16 v[128:143], a[232:235], v[244:247], v[128:143]
    s_waitcnt vmcnt(1)
    v_mfma_f32_32x32x16_bf16 v[160:175], a[244:247], v[248:251], v[160:175]
    v_mfma_f32_32x32x16_bf16 v[128:143], a[240:243], v[248:251], v[128:143]
    s_waitcnt vmcnt(0)
    v_mfma_f32_32x32x16_bf16 v[160:175], a[252:255], v[252:255], v[160:175]
    v_mfma_f32_32x32x16_bf16 v[128:143], a[248:251], v[252:255], v[128:143]
    s_nop 10
    v_cmp_u_f32 vcc, v160, v160
    s_cbranch_vccz L_p2ok
    s_add_u32 s54, s54, 1
    s_cmp_lt_u32 s54, 0x400
    s_cbranch_scc1 L_p2r1
    s_branch L_p2ok
L_p4redo:
    s_mov_b32 s54, 0
L_p4r1:
    s_add_u32 s57, s70, 229376
    buffer_load_dwordx4 a[0:3], v7, s[48:51], s57 offen offset:0 sc1
    buffer_load_dwordx4 a[4:7], v7, s[48:51], s57 offen offset:1024 sc1
    s_add_u32 s57, s70, 237568
    buffer_load_dwordx4 a[8:11], v7, s[48:51], s57 offen offset:0 sc1
    buffer_load_dwordx4 a[12:15], v7, s[48:51], s57 offen offset:1024 sc1
    s_add_u32 s57, s70, 245760
    buffer_load_dwordx4 a[16:19], v7, s[48:51], s57 offen offset:0 sc1
    buffer_load_dwordx4 a[20:23], v7, s[48:51], s57 offen offset:1024 sc1
    s_add_u32 s57, s70, 253952
    buffer_load_dwordx4 a[24:27], v7, s[48:51], s57 offen offset:0 sc1
    buffer_load_dwordx4 a[28:31], v7, s[48:51], s57 offen offset:1024 sc1
    s_add_u32 s57, s70, 262144
    buffer_load_dwordx4 a[32:35], v7, s[48:51], s57 offen offset:0 sc1
    buffer_load_dwordx4 a[36:39], v7, s[48:51], s57 offen offset:1024 sc1
    s_add_u32 s57, s70, 270336
    buffer_load_dwordx4 a[40:43], v7, s[48:51], s57 offen offset:0 sc1
    buffer_load_dwordx4 a[44:47], v7, s[48:51], s57 offen offset:1024 sc1
    s_add_u32 s57, s70, 278528
    buffer_load_dwordx4 a[48:51], v7, s[48:51], s57 offen offset:0 sc1
    buffer_load_dwordx4 a[52:55], v7, s[48:51], s57 offen offset:1024 sc1
    s_add_u32 s57, s71, 229376
    buffer_load_dwordx4 a[56:59], v7, s[48:51], s57 offen offset:0 sc1
    buffer_load_dwordx4 a[60:63], v7, s[48:51], s57 offen offset:1024 sc1
    s_add_u32 s57, s71, 237568
    buffer_load_dwordx4 a[64:67], v7, s[48:51], s57 offen offset:0 sc1
    buffer_load_dwordx4 a[68:71], v7, s[48:51], s57 offen offset:1024 sc1
    s_add_u32 s57, s71, 245760
    buffer_load_dwordx4 a[72:75], v7, s[48:51], s57 offen offset:0 sc1
    buffer_load_dwordx4 a[76:79], v7, s[48:51], s57 offen offset:1024 sc1
    s_add_u32 s57, s71, 253952
    buffer_load_dwordx4 a[80:83], v7, s[48:51], s57 offen offset:0 sc1
    buffer_load_dwordx4 a[84:87], v7, s[48:51], s57 offen offset:1024 sc1
    s_add_u32 s57, s71, 262144
    buffer_load_dwordx4 a[88:91], v7, s[48:51], s57 offen offset:0 sc1
    buffer_load_dwordx4 a[92:95], v7, s[48:51], s57 offen offset:1024 sc1
    s_add_u32 s57, s71, 270336
    buffer_load_dwordx4 a[96:99], v7, s[48:51], s57 offen offset:0 sc1
    buffer_load_dwordx4 a[100:103], v7, s[48:51], s57 offen offset:1024 sc1
    s_add_u32 s57, s71, 278528
    buffer_load_dwordx4 a[104:107], v7, s[48:51], s57 offen offset:0 sc1
    buffer_load_dwordx4 a[108:111], v7, s[48:51], s57 offen offset:1024 sc1
    s_waitcnt vmcnt(27)
    v_mfma_f32_32x32x16_bf16 v[64:79], v[160:163], a[0:3], 0
    v_mfma_f32_32x32x16_bf16 v[80:95], v[164:167], a[0:3], 0
    s_waitcnt vmcnt(26)
    v_mfma_f32_32x32x16_bf16 v[64:79], v[168:171], a[4:7], v[64:79]
    v_mfma_f32_32x32x16_bf16 v[80:95], v[172:175], a[4:7], v[80:95]
    s_waitcnt vmcnt(25)
    v_mfma_f32_32x32x16_bf16 v[64:79], v[176:179], a[8:11], v[64:79]
    v_mfma_f32_32x32x16_bf16 v[80:95], v[180:183], a[8:11], v[80:95]
    s_waitcnt vmcnt(24)
    v_mfma_f32_32x32x16_bf16 v[64:79], v[184:187], a[12:15], v[64:79]
    v_mfma_f32_32x32x16_bf16 v[80:95], v[188:191], a[12:15], v[80:95]
    s_waitcnt vmcnt(23)
    v_mfma_f32_32x32x16_bf16 v[64:79], v[192:195], a[16:19], v[64:79]
    v_mfma_f32_32x32x16_bf16 v[80:95], v[196:199], a[16:19], v[80:95]
    s_waitcnt vmcnt(22)
    v_mfma_f32_32x32x16_bf16 v[64:79], v[200:203], a[20:23], v[64:79]
    v_mfma_f32_32x32x16_bf16 v[80:95], v[204:207], a[20:23], v[80:95]
    s_waitcnt vmcnt(21)
    v_mfma_f32_32x32x16_bf16 v[64:79], v[208:211], a[24:27], v[64:79]
    v_mfma_f32_32x32x16_bf16 v[80:95], v[212:215], a[24:27], v[80:95]
    s_waitcnt vmcnt(20)
    v_mfma_f32_32x32x16_bf16 v[64:79], v[216:219], a[28:31], v[64:79]
    v_mfma_f32_32x32x16_bf16 v[80:95], v[220:223], a[28:31], v[80:95]
    s_waitcnt vmcnt(19)
    v_mfma_f32_32x32x16_bf16 v[64:79], v[224:227], a[32:35], v[64:79]
    v_mfma_f32_32x32x16_bf16 v[80:95], v[228:231], a[32:35], v[80:95]
    s_waitcnt vmcnt(18)
    v_mfma_f32_32x32x16_bf16 v[64:79], v[232:235], a[36:39], v[64:79]
    v_mfma_f32_32x32x16_bf16 v[80:95], v[236:239], a[36:39], v[80:95]
    s_waitcnt vmcnt(17)
    v_mfma_f32_32x32x16_bf16 v[64:79], v[240:243], a[40:43], v[64:79]
    v_mfma_f32_32x32x16_bf16 v[80:95], v[244:247], a[40:43], v[80:95]
    s_waitcnt vmcnt(16)
    v_mfma_f32_32x32x16_bf16 v[64:79], v[248:251], a[44:47], v[64:79]
    v_mfma_f32_32x32x16_bf16 v[80:95], v[252:255], a[44:47], v[80:95]
    s_waitcnt vmcnt(15)
    v_mfma_f32_32x32x16_bf16 v[64:79], a[224:227], a[48:51], v[64:79]
    v_mfma_f32_32x32x16_bf16 v[80:95], a[228:231], a[48:51], v[80:95]
    s_waitcnt vmcnt(14)
    v_mfma_f32_32x32x16_bf16 v[64:79], a[232:235], a[52:55], v[64:79]
    v_mfma_f32_32x32x16_bf16 v[80:95], a[236:239], a[52:55], v[80:95]
    s_waitcnt vmcnt(13)
    v_mfma_f32_32x32x16_bf16 v[64:79], a[240:243], a[56:59], v[64:79]
    v_mfma_f32_32x32x16_bf16 v[80:95], a[244:247], a[56:59], v[80:95]
    s_waitcnt vmcnt(12)
    v_mfma_f32_32x32x16_bf16 v[64:79], a[248:251], a[60:63], v[64:79]
    v_mfma_f32_32x32x16_bf16 v[80:95], a[252:255], a[60:63], v[80:95]
    s_waitcnt vmcnt(11)
    v_mfma_f32_32x32x16_bf16 v[64:79], a[128:131], a[64:67], v[64:79]
    v_mfma_f32_32x32x16_bf16 v[80:95], a[132:135], a[64:67], v[80:95]
    s_waitcnt vmcnt(10)
    v_mfma_f32_32x32x16_bf16 v[64:79], a[136:139], a[68:71], v[64:79]
    v_mfma_f32_32x32x16_bf16 v[80:95], a[140:143], a[68:71], v[80:95]
    s_waitcnt vmcnt(9)
    v_mfma_f32_32x32x16_bf16 v[64:79], a[144:147], a[72:75], v[64:79]
    v_mfma_f32_32x32x16_bf16 v[80:95], a[148:151], a[72:75], v[80:95]
    s_waitcnt vmcnt(8)
    v_mfma_f32_32x32x16_bf16 v[64:79], a[152:155], a[76:79], v[64:79]
    v_mfma_f32_32x32x16_bf16 v[80:95], a[156:159], a[76:79], v[80:95]
    s_waitcnt vmcnt(7)
    v_mfma_f32_32x32x16_bf16 v[64:79], a[160:163], a[80:83], v[64:79]
    v_mfma_f32_32x32x16_bf16 v[80:95], a[164:167], a[80:83], v[80:95]
    s_waitcnt vmcnt(6)
    v_mfma_f32_32x32x16_bf16 v[64:79], a[168:171], a[84:87], v[64:79]
    v_mfma_f32_32x32x16_bf16 v[80:95], a[172:175], a[84:87], v[80:95]
    s_waitcnt vmcnt(5)
    v_mfma_f32_32x32x16_bf16 v[64:79], a[176:179], a[88:91], v[64:79]
    v_mfma_f32_32x32x16_bf16 v[80:95], a[180:183], a[88:91], v[80:95]
    s_waitcnt vmcnt(4)
    v_mfma_f32_32x32x16_bf16 v[64:79], a[184:187], a[92:95], v[64:79]
    v_mfma_f32_32x32x16_bf16 v[80:95], a[188:191], a[92:95], v[80:95]
    s_waitcnt vmcnt(3)
    v_mfma_f32_32x32x16_bf16 v[64:79], a[192:195], a[96:99], v[64:79]
    v_mfma_f32_32x32x16_bf16 v[80:95], a[196:199], a[96:99], v[80:95]
    s_waitcnt vmcnt(2)
    v_mfma_f32_32x32x16_bf16 v[64:79], a[200:203], a[100:103], v[64:79]
    v_mfma_f32_32x32x16_bf16 v[80:95], a[204:207], a[100:103], v[80:95]
    s_waitcnt vmcnt(1)
    v_mfma_f32_32x32x16_bf16 v[64:79], a[208:211], a[104:107], v[64:79]
    v_mfma_f32_32x32x16_bf16 v[80:95], a[212:215], a[104:107], v[80:95]
    s_waitcnt vmcnt(0)
    v_mfma_f32_32x32x16_bf16 v[64:79], a[216:219], a[108:111], v[64:79]
    v_mfma_f32_32x32x16_bf16 v[80:95], a[220:223], a[108:111], v[80:95]
    s_nop 10
    v_cmp_u_f32 vcc, v64, v64
    s_cbranch_vccz L_p4rd
    s_add_u32 s54, s54, 1
    s_cmp_lt_u32 s54, 0x400
    s_cbranch_scc1 L_p4r1
L_p4rd:
    ds_write_b128 v11, v[64:67] offset:0
    ds_write_b128 v11, v[68:71] offset:1088
    ds_write_b128 v11, v[72:75] offset:2176
    ds_write_b128 v11, v[76:79] offset:3264
    s_branch L_p4ok
L_p4redo0:
    s_mov_b32 s54, 0
L_p4r10:
    s_add_u32 s57, s70, 0
    buffer_load_dwordx4 a[0:3], v7, s[48:51], s57 offen offset:0 sc1
    buffer_load_dwordx4 a[4:7], v7, s[48:51], s57 offen offset:1024 sc1
    s_add_u32 s57, s70, 8192
    buffer_load_dwordx4 a[8:11], v7, s[48:51], s57 offen offset:0 sc1
    buffer_load_dwordx4 a[12:15], v7, s[48:51], s57 offen offset:1024 sc1
    s_add_u32 s57, s70, 16384
    buffer_load_dwordx4 a[16:19], v7, s[48:51], s57 offen offset:0 sc1
    buffer_load_dwordx4 a[20:23], v7, s[48:51], s57 offen offset:1024 sc1
    s_add_u32 s57, s70, 24576
    buffer_load_dwordx4 a[24:27], v7, s[48:51], s57 offen offset:0 sc1
    buffer_load_dwordx4 a[28:31], v7, s[48:51], s57 offen offset:1024 sc1
    s_add_u32 s57, s70, 32768
    buffer_load_dwordx4 a[32:35], v7, s[48:51], s57 offen offset:0 sc1
    buffer_load_dwordx4 a[36:39], v7, s[48:51], s57 offen offset:1024 sc1
    s_add_u32 s57, s70, 40960
    buffer_load_dwordx4 a[40:43], v7, s[48:51], s57 offen offset:0 sc1
    buffer_load_dwordx4 a[44:47], v7, s[48:51], s57 offen offset:1024 sc1
    s_add_u32 s57, s70, 49152
    buffer_load_dwordx4 a[48:51], v7, s[48:51], s57 offen offset:0 sc1
    buffer_load_dwordx4 a[52:55], v7, s[48:51], s57 offen offset:1024 sc1
    s_add_u32 s57, s71, 0
    buffer_load_dwordx4 a[56:59], v7, s[48:51], s57 offen offset:0 sc1
    buffer_load_dwordx4 a[60:63], v7, s[48:51], s57 offen offset:1024 sc1
    s_add_u32 s57, s71, 8192
    buffer_load_dwordx4 a[64:67], v7, s[48:51], s57 offen offset:0 sc1
    buffer_load_dwordx4 a[68:71], v7, s[48:51], s57 offen offset:1024 sc1
    s_add_u32 s57, s71, 16384
    buffer_load_dwordx4 a[72:75], v7, s[48:51], s57 offen offset:0 sc1
    buffer_load_dwordx4 a[76:79], v7, s[48:51], s57 offen offset:1024 sc1
    s_add_u32 s57, s71, 24576
    buffer_load_dwordx4 a[80:83], v7, s[48:51], s57 offen offset:0 sc1
    buffer_load_dwordx4 a[84:87], v7, s[48:51], s57 offen offset:1024 sc1
    s_add_u32 s57, s71, 32768
    buffer_load_dwordx4 a[88:91], v7, s[48:51], s57 offen offset:0 sc1
    buffer_load_dwordx4 a[92:95], v7, s[48:51], s57 offen offset:1024 sc1
    s_add_u32 s57, s71, 40960
    buffer_load_dwordx4 a[96:99], v7, s[48:51], s57 offen offset:0 sc1
    buffer_load_dwordx4 a[100:103], v7, s[48:51], s57 offen offset:1024 sc1
    s_add_u32 s57, s71, 49152
    buffer_load_dwordx4 a[104:107], v7, s[48:51], s57 offen offset:0 sc1
    buffer_load_dwordx4 a[108:111], v7, s[48:51], s57 offen offset:1024 sc1
    s_waitcnt vmcnt(27)
    v_mfma_f32_32x32x16_bf16 v[32:47], v[160:163], a[0:3], 0
    v_mfma_f32_32x32x16_bf16 v[48:63], v[164:167], a[0:3], 0
    s_waitcnt vmcnt(26)
    v_mfma_f32_32x32x16_bf16 v[32:47], v[168:171], a[4:7], v[32:47]
    v_mfma_f32_32x32x16_bf16 v[48:63], v[172:175], a[4:7], v[48:63]
    s_waitcnt vmcnt(25)
    v_mfma_f32_32x32x16_bf16 v[32:47], v[176:179], a[8:11], v[32:47]
    v_mfma_f32_32x32x16_bf16 v[48:63], v[180:183], a[8:11], v[48:63]
    s_waitcnt vmcnt(24)
    v_mfma_f32_32x32x16_bf16 v[32:47], v[184:187], a[12:15], v[32:47]
    v_mfma_f32_32x32x16_bf16 v[48:63], v[188:191], a[12:15], v[48:63]
    s_waitcnt vmcnt(23)
    v_mfma_f32_32x32x16_bf16 v[32:47], v[192:195], a[16:19], v[32:47]
    v_mfma_f32_32x32x16_bf16 v[48:63], v[196:199], a[16:19], v[48:63]
    s_waitcnt vmcnt(22)
    v_mfma_f32_32x32x16_bf16 v[32:47], v[200:203], a[20:23], v[32:47]
    v_mfma_f32_32x32x16_bf16 v[48:63], v[204:207], a[20:23], v[48:63]
    s_waitcnt vmcnt(21)
    v_mfma_f32_32x32x16_bf16 v[32:47], v[208:211], a[24:27], v[32:47]
    v_mfma_f32_32x32x16_bf16 v[48:63], v[212:215], a[24:27], v[48:63]
    s_waitcnt vmcnt(20)
    v_mfma_f32_32x32x16_bf16 v[32:47], v[216:219], a[28:31], v[32:47]
    v_mfma_f32_32x32x16_bf16 v[48:63], v[220:223], a[28:31], v[48:63]
    s_waitcnt vmcnt(19)
    v_mfma_f32_32x32x16_bf16 v[32:47], v[224:227], a[32:35], v[32:47]
    v_mfma_f32_32x32x16_bf16 v[48:63], v[228:231], a[32:35], v[48:63]
    s_waitcnt vmcnt(18)
    v_mfma_f32_32x32x16_bf16 v[32:47], v[232:235], a[36:39], v[32:47]
    v_mfma_f32_32x32x16_bf16 v[48:63], v[236:239], a[36:39], v[48:63]
    s_waitcnt vmcnt(17)
    v_mfma_f32_32x32x16_bf16 v[32:47], v[240:243], a[40:43], v[32:47]
    v_mfma_f32_32x32x16_bf16 v[48:63], v[244:247], a[40:43], v[48:63]
    s_waitcnt vmcnt(16)
    v_mfma_f32_32x32x16_bf16 v[32:47], v[248:251], a[44:47], v[32:47]
    v_mfma_f32_32x32x16_bf16 v[48:63], v[252:255], a[44:47], v[48:63]
    s_waitcnt vmcnt(15)
    v_mfma_f32_32x32x16_bf16 v[32:47], a[224:227], a[48:51], v[32:47]
    v_mfma_f32_32x32x16_bf16 v[48:63], a[228:231], a[48:51], v[48:63]
    s_waitcnt vmcnt(14)
    v_mfma_f32_32x32x16_bf16 v[32:47], a[232:235], a[52:55], v[32:47]
    v_mfma_f32_32x32x16_bf16 v[48:63], a[236:239], a[52:55], v[48:63]
    s_waitcnt vmcnt(13)
    v_mfma_f32_32x32x16_bf16 v[32:47], a[240:243], a[56:59], v[32:47]
    v_mfma_f32_32x32x16_bf16 v[48:63], a[244:247], a[56:59], v[48:63]
    s_waitcnt vmcnt(12)
    v_mfma_f32_32x32x16_bf16 v[32:47], a[248:251], a[60:63], v[32:47]
    v_mfma_f32_32x32x16_bf16 v[48:63], a[252:255], a[60:63], v[48:63]
    s_waitcnt vmcnt(11)
    v_mfma_f32_32x32x16_bf16 v[32:47], a[128:131], a[64:67], v[32:47]
    v_mfma_f32_32x32x16_bf16 v[48:63], a[132:135], a[64:67], v[48:63]
    s_waitcnt vmcnt(10)
    v_mfma_f32_32x32x16_bf16 v[32:47], a[136:139], a[68:71], v[32:47]
    v_mfma_f32_32x32x16_bf16 v[48:63], a[140:143], a[68:71], v[48:63]
    s_waitcnt vmcnt(9)
    v_mfma_f32_32x32x16_bf16 v[32:47], a[144:147], a[72:75], v[32:47]
    v_mfma_f32_32x32x16_bf16 v[48:63], a[148:151], a[72:75], v[48:63]
    s_waitcnt vmcnt(8)
    v_mfma_f32_32x32x16_bf16 v[32:47], a[152:155], a[76:79], v[32:47]
    v_mfma_f32_32x32x16_bf16 v[48:63], a[156:159], a[76:79], v[48:63]
    s_waitcnt vmcnt(7)
    v_mfma_f32_32x32x16_bf16 v[32:47], a[160:163], a[80:83], v[32:47]
    v_mfma_f32_32x32x16_bf16 v[48:63], a[164:167], a[80:83], v[48:63]
    s_waitcnt vmcnt(6)
    v_mfma_f32_32x32x16_bf16 v[32:47], a[168:171], a[84:87], v[32:47]
    v_mfma_f32_32x32x16_bf16 v[48:63], a[172:175], a[84:87], v[48:63]
    s_waitcnt vmcnt(5)
    v_mfma_f32_32x32x16_bf16 v[32:47], a[176:179], a[88:91], v[32:47]
    v_mfma_f32_32x32x16_bf16 v[48:63], a[180:183], a[88:91], v[48:63]
    s_waitcnt vmcnt(4)
    v_mfma_f32_32x32x16_bf16 v[32:47], a[184:187], a[92:95], v[32:47]
    v_mfma_f32_32x32x16_bf16 v[48:63], a[188:191], a[92:95], v[48:63]
    s_waitcnt vmcnt(3)
    v_mfma_f32_32x32x16_bf16 v[32:47], a[192:195], a[96:99], v[32:47]
    v_mfma_f32_32x32x16_bf16 v[48:63], a[196:199], a[96:99], v[48:63]
    s_waitcnt vmcnt(2)
    v_mfma_f32_32x32x16_bf16 v[32:47], a[200:203], a[100:103], v[32:47]
    v_mfma_f32_32x32x16_bf16 v[48:63], a[204:207], a[100:103], v[48:63]
    s_waitcnt vmcnt(1)
    v_mfma_f32_32x32x16_bf16 v[32:47], a[208:211], a[104:107], v[32:47]
    v_mfma_f32_32x32x16_bf16 v[48:63], a[212:215], a[104:107], v[48:63]
    s_waitcnt vmcnt(0)
    v_mfma_f32_32x32x16_bf16 v[32:47], a[216:219], a[108:111], v[32:47]
    v_mfma_f32_32x32x16_bf16 v[48:63], a[220:223], a[108:111], v[48:63]
    s_nop 10
    v_cmp_u_f32 vcc, v32, v32
    s_cbranch_vccz L_p4rd0
    s_add_u32 s54, s54, 1
    s_cmp_lt_u32 s54, 0x400
    s_cbranch_scc1 L_p4r10
L_p4rd0:
    s_add_u32 s57, s70, 229376
    buffer_load_dwordx4 a[0:3], v7, s[48:51], s57 offen offset:0 sc1
    buffer_load_dwordx4 a[4:7], v7, s[48:51], s57 offen offset:1024 sc1
    s_add_u32 s57, s70, 237568
    buffer_load_dwordx4 a[8:11], v7, s[48:51], s57 offen offset:0 sc1
    buffer_load_dwordx4 a[12:15], v7, s[48:51], s57 offen offset:1024 sc1
    s_add_u32 s57, s70, 245760
    buffer_load_dwordx4 a[16:19], v7, s[48:51], s57 offen offset:0 sc1
    buffer_load_dwordx4 a[20:23], v7, s[48:51], s57 offen offset:1024 sc1
    s_add_u32 s57, s70, 253952
    buffer_load_dwordx4 a[24:27], v7, s[48:51], s57 offen offset:0 sc1
    buffer_load_dwordx4 a[28:31], v7, s[48:51], s57 offen offset:1024 sc1
    s_add_u32 s57, s70, 262144
    buffer_load_dwordx4 a[32:35], v7, s[48:51], s57 offen offset:0 sc1
    buffer_load_dwordx4 a[36:39], v7, s[48:51], s57 offen offset:1024 sc1
    s_add_u32 s57, s70, 270336
    buffer_load_dwordx4 a[40:43], v7, s[48:51], s57 offen offset:0 sc1
    buffer_load_dwordx4 a[44:47], v7, s[48:51], s57 offen offset:1024 sc1
    s_add_u32 s57, s70, 278528
    buffer_load_dwordx4 a[48:51], v7, s[48:51], s57 offen offset:0 sc1
    buffer_load_dwordx4 a[52:55], v7, s[48:51], s57 offen offset:1024 sc1
    s_waitcnt vmcnt(0)
    s_branch L_p4ok0
L_pfslow0:
    s_mov_b32 s54, 0
L_poll_24:
    buffer_load_dwordx2 v[30:31], v23, s[48:51], 0 offen sc1
    s_waitcnt vmcnt(0)
    v_cmp_ne_u64 vcc, s[52:53], v[30:31]
    s_cbranch_vccz L_pdone_25
    s_add_u32 s54, s54, 1
    s_cmp_lt_u32 s54, 16384
    s_cbranch_scc1 L_poll_24
    s_waitcnt vmcnt(0)
    v_mov_b32 v30, 8
    buffer_store_dword v30, off, s[44:47], 0 offset:16
    s_waitcnt vmcnt(0)
L_pdone_25:
    s_branch L_pfok0
L_pfslow1:
    s_mov_b32 s54, 0
L_poll_26:
    buffer_load_dwordx2 v[30:31], v23, s[48:51], s76 offen sc1
    s_waitcnt vmcnt(0)
    v_cmp_ne_u64 vcc, s[52:53], v[30:31]
    s_cbranch_vccz L_pdone_27
    s_add_u32 s54, s54, 1
    s_cmp_lt_u32 s54, 16384
    s_cbranch_scc1 L_poll_26
    s_waitcnt vmcnt(0)
    v_mov_b32 v30, 8
    buffer_store_dword v30, off, s[44:47], 0 offset:16
    s_waitcnt vmcnt(0)
L_pdone_27:
    s_branch L_pfok1
L_pfslow3:
    s_mov_b32 s54, 0
L_poll_28:
    buffer_load_dwordx2 v[30:31], v23, s[48:51], s76 offen sc1
    s_waitcnt vmcnt(0)
    v_cmp_ne_u64 vcc, s[52:53], v[30:31]
    s_cbranch_vccz L_pdone_29
    s_add_u32 s54, s54, 1
    s_cmp_lt_u32 s54, 16384
    s_cbranch_scc1 L_poll_28
    s_waitcnt vmcnt(0)
    v_mov_b32 v30, 8
    buffer_store_dword v30, off, s[44:47], 0 offset:16
    s_waitcnt vmcnt(0)
L_pdone_29:
    s_branch L_pfok3
L_sredo:
    s_mov_b32 s54, 0
    v_mul_u32_u24 v15, 1792, v6
    v_lshl_add_u32 v15, v1, 3, v15
L_sr1:
    buffer_load_dwordx2 v[132:133], v15, s[48:51], s19 offen offset:0 sc1
    buffer_load_dwordx2 v[134:135], v15, s[48:51], s19 offen offset:256 sc1
    buffer_load_dwordx2 v[136:137], v15, s[48:51], s19 offen offset:512 sc1
    buffer_load_dwordx2 v[138:139], v15, s[48:51], s19 offen offset:768 sc1
    buffer_load_dwordx2 v[140:141], v15, s[48:51], s19 offen offset:1024 sc1
    buffer_load_dwordx2 v[142:143], v15, s[48:51], s19 offen offset:1280 sc1
    buffer_load_dwordx2 v[144:145], v15, s[48:51], s19 offen offset:1536 sc1
    s_waitcnt vmcnt(0)
    v_add_f32 v132, v132, v134
    v_add_f32 v133, v133, v135
    v_add_f32 v136, v136, v138
    v_add_f32 v137, v137, v139
    v_add_f32 v140, v140, v142
    v_add_f32 v141, v141, v143
    v_add_f32 v132, v132, v136
    v_add_f32 v133, v133, v137
    v_add_f32 v140, v140, v144
    v_add_f32 v141, v141, v145
    v_add_f32 v132, v132, v140
    v_add_f32 v133, v133, v141
    v_cmp_u_f32 vcc, v132, v133
    s_cbranch_vccz L_sok
    s_add_u32 s54, s54, 1
    s_cmp_lt_u32 s54, 0x400
    s_cbranch_scc1 L_sr1
    s_branch L_sok
L_xredo0:
    s_mov_b32 s54, 0
L_xr0:
    s_sub_u32 s75, s33, s32
    buffer_load_dwordx4 v[132:135], v7, s[48:51], s75 offen offset:0 sc1
    buffer_load_dwordx4 v[136:139], v7, s[48:51], s75 offen offset:1024 sc1
    buffer_load_dwordx4 v[140:143], v7, s[48:51], s75 offen offset:2048 sc1
    buffer_load_dwordx4 v[144:147], v7, s[48:51], s75 offen offset:3072 sc1
    s_add_u32 s75, s75, 4096
    s_waitcnt vmcnt(3)
    v_mfma_f32_32x32x16_bf16 v[32:47], a[0:3], v[132:135], 0
    v_mfma_f32_32x32x16_bf16 v[48:63], a[4:7], v[132:135], 0
    s_waitcnt vmcnt(2)
    v_mfma_f32_32x32x16_bf16 v[32:47], a[8:11], v[136:139], v[32:47]
    v_mfma_f32_32x32x16_bf16 v[48:63], a[12:15], v[136:139], v[48:63]
    s_waitcnt vmcnt(1)
    v_mfma_f32_32x32x16_bf16 v[32:47], a[16:19], v[140:143], v[32:47]
    v_mfma_f32_32x32x16_bf16 v[48:63], a[20:23], v[140:143], v[48:63]
    s_waitcnt vmcnt(0)
    v_mfma_f32_32x32x16_bf16 v[32:47], a[24:27], v[144:147], v[32:47]
    v_mfma_f32_32x32x16_bf16 v[48:63], a[28:31], v[144:147], v[48:63]
    buffer_load_dwordx4 v[132:135], v7, s[48:51], s75 offen offset:0 sc1
    buffer_load_dwordx4 v[136:139], v7, s[48:51], s75 offen offset:1024 sc1
    buffer_load_dwordx4 v[140:143], v7, s[48:51], s75 offen offset:2048 sc1
    buffer_load_dwordx4 v[144:147], v7, s[48:51], s75 offen offset:3072 sc1
    s_add_u32 s75, s75, 4096
    s_waitcnt vmcnt(3)
    v_mfma_f32_32x32x16_bf16 v[32:47], a[32:35], v[132:135], v[32:47]
    v_mfma_f32_32x32x16_bf16 v[48:63], a[36:39], v[132:135], v[48:63]
    s_waitcnt vmcnt(2)
    v_mfma_f32_32x32x16_bf16 v[32:47], a[40:43], v[136:139], v[32:47]
    v_mfma_f32_32x32x16_bf16 v[48:63], a[44:47], v[136:139], v[48:63]
    s_waitcnt vmcnt(1)
    v_mfma_f32_32x32x16_bf16 v[32:47], a[48:51], v[140:143], v[32:47]
    v_mfma_f32_32x32x16_bf16 v[48:63], a[52:55], v[140:143], v[48:63]
    s_waitcnt vmcnt(0)
    v_mfma_f32_32x32x16_bf16 v[32:47], a[56:59], v[144:147], v[32:47]
    v_mfma_f32_32x32x16_bf16 v[48:63], a[60:63], v[144:147], v[48:63]
    buffer_load_dwordx4 v[132:135], v7, s[48:51], s75 offen offset:0 sc1
    buffer_load_dwordx4 v[136:139], v7, s[48:51], s75 offen offset:1024 sc1
    buffer_load_dwordx4 v[140:143], v7, s[48:51], s75 offen offset:2048 sc1
    buffer_load_dwordx4 v[144:147], v7, s[48:51], s75 offen offset:3072 sc1
    s_add_u32 s75, s75, 4096
    s_waitcnt vmcnt(3)
    v_mfma_f32_32x32x16_bf16 v[32:47], a[64:67], v[132:135], v[32:47]
    v_mfma_f32_32x32x16_bf16 v[48:63], a[68:71], v[132:135], v[48:63]
    s_waitcnt vmcnt(2)
    v_mfma_f32_32x32x16_bf16 v[32:47], a[72:75], v[136:139], v[32:47]
    v_mfma_f32_32x32x16_bf16 v[48:63], a[76:79], v[136:139], v[48:63]
    s_waitcnt vmcnt(1)
    v_mfma_f32_32x32x16_bf16 v[32:47], a[80:83], v[140:143], v[32:47]
    v_mfma_f32_32x32x16_bf16 v[48:63], a[84:87], v[140:143], v[48:63]
    s_waitcnt vmcnt(0)
    v_mfma_f32_32x32x16_bf16 v[32:47], a[88:91], v[144:147], v[32:47]
    v_mfma_f32_32x32x16_bf16 v[48:63], a[92:95], v[144:147], v[48:63]
    buffer_load_dwordx4 v[132:135], v7, s[48:51], s75 offen offset:0 sc1
    buffer_load_dwordx4 v[136:139], v7, s[48:51], s75 offen offset:1024 sc1
    buffer_load_dwordx4 v[140:143], v7, s[48:51], s75 offen offset:2048 sc1
    buffer_load_dwordx4 v[144:147], v7, s[48:51], s75 offen offset:3072 sc1
    s_add_u32 s75, s75, 4096
    s_waitcnt vmcnt(3)
    v_mfma_f32_32x32x16_bf16 v[32:47], a[96:99], v[132:135], v[32:47]
    v_mfma_f32_32x32x16_bf16 v[48:63], a[100:103], v[132:135], v[48:63]
    s_waitcnt vmcnt(2)
    v_mfma_f32_32x32x16_bf16 v[32:47], a[104:107], v[136:139], v[32:47]
    v_mfma_f32_32x32x16_bf16 v[48:63], a[108:111], v[136:139], v[48:63]
    s_waitcnt vmcnt(1)
    v_mfma_f32_32x32x16_bf16 v[32:47], a[112:115], v[140:143], v[32:47]
    v_mfma_f32_32x32x16_bf16 v[48:63], a[116:119], v[140:143], v[48:63]
    s_waitcnt vmcnt(0)
    v_mfma_f32_32x32x16_bf16 v[32:47], a[120:123], v[144:147], v[32:47]
    v_mfma_f32_32x32x16_bf16 v[48:63], a[124:127], v[144:147], v[48:63]
    buffer_load_dwordx4 v[132:135], v7, s[48:51], s75 offen offset:0 sc1
    buffer_load_dwordx4 v[136:139], v7, s[48:51], s75 offen offset:1024 sc1
    buffer_load_dwordx4 v[140:143], v7, s[48:51], s75 offen offset:2048 sc1
    buffer_load_dwordx4 v[144:147], v7, s[48:51], s75 offen offset:3072 sc1
    s_add_u32 s75, s75, 4096
    s_waitcnt vmcnt(3)
    v_mfma_f32_32x32x16_bf16 v[32:47], a[128:131], v[132:135], v[32:47]
    v_mfma_f32_32x32x16_bf16 v[48:63], a[132:135], v[132:135], v[48:63]
    s_waitcnt vmcnt(2)
    v_mfma_f32_32x32x16_bf16 v[32:47], a[136:139], v[136:139], v[32:47]
    v_mfma_f32_32x32x16_bf16 v[48:63], a[140:143], v[136:139], v[48:63]
    s_waitcnt vmcnt(1)
    v_mfma_f32_32x32x16_bf16 v[32:47], a[144:147], v[140:143], v[32:47]
    v_mfma_f32_32x32x16_bf16 v[48:63], a[148:151], v[140:143], v[48:63]
    s_waitcnt vmcnt(0)
    v_mfma_f32_32x32x16_bf16 v[32:47], a[152:155], v[144:147], v[32:47]
    v_mfma_f32_32x32x16_bf16 v[48:63], a[156:159], v[144:147], v[48:63]
    buffer_load_dwordx4 v[132:135], v7, s[48:51], s75 offen offset:0 sc1
    buffer_load_dwordx4 v[136:139], v7, s[48:51], s75 offen offset:1024 sc1
    buffer_load_dwordx4 v[140:143], v7, s[48:51], s75 offen offset:2048 sc1
    buffer_load_dwordx4 v[144:147], v7, s[48:51], s75 offen offset:3072 sc1
    s_add_u32 s75, s75, 4096
    s_waitcnt vmcnt(3)
    v_mfma_f32_32x32x16_bf16 v[32:47], a[160:163], v[132:135], v[32:47]
    v_mfma_f32_32x32x16_bf16 v[48:63], a[164:167], v[132:135], v[48:63]
    s_waitcnt vmcnt(2)
    v_mfma_f32_32x32x16_bf16 v[32:47], a[168:171], v[136:139], v[32:47]
    v_mfma_f32_32x32x16_bf16 v[48:63], a[172:175], v[136:139], v[48:63]
    s_waitcnt vmcnt(1)
    v_mfma_f32_32x32x16_bf16 v[32:47], a[176:179], v[140:143], v[32:47]
    v_mfma_f32_32x32x16_bf16 v[48:63], a[180:183], v[140:143], v[48:63]
    s_waitcnt vmcnt(0)
    v_mfma_f32_32x32x16_bf16 v[32:47], a[184:187], v[144:147], v[32:47]
    v_mfma_f32_32x32x16_bf16 v[48:63], a[188:191], v[144:147], v[48:63]
    buffer_load_dwordx4 v[132:135], v7, s[48:51], s75 offen offset:0 sc1
    buffer_load_dwordx4 v[136:139], v7, s[48:51], s75 offen offset:1024 sc1
    buffer_load_dwordx4 v[140:143], v7, s[48:51], s75 offen offset:2048 sc1
    buffer_load_dwordx4 v[144:147], v7, s[48:51], s75 offen offset:3072 sc1
    s_add_u32 s75, s75, 4096
    s_waitcnt vmcnt(3)
    v_mfma_f32_32x32x16_bf16 v[32:47], a[192:195], v[132:135], v[32:47]
    v_mfma_f32_32x32x16_bf16 v[48:63], a[196:199], v[132:135], v[48:63]
    s_waitcnt vmcnt(2)
    v_mfma_f32_32x32x16_bf16 v[32:47], a[200:203], v[136:139], v[32:47]
    v_mfma_f32_32x32x16_bf16 v[48:63], a[204:207], v[136:139], v[48:63]
    s_waitcnt vmcnt(1)
    v_mfma_f32_32x32x16_bf16 v[32:47], a[208:211], v[140:143], v[32:47]
    v_mfma_f32_32x32x16_bf16 v[48:63], a[212:215], v[140:143], v[48:63]
    s_waitcnt vmcnt(0)
    v_mfma_f32_32x32x16_bf16 v[32:47], a[216:219], v[144:147], v[32:47]
    v_mfma_f32_32x32x16_bf16 v[48:63], a[220:223], v[144:147], v[48:63]
    v_mfma_f32_32x32x16_bf16 v[32:47], v[96:99], v[104:107], v[32:47]
    v_mfma_f32_32x32x16_bf16 v[48:63], v[100:103], v[104:107], v[48:63]
    s_nop 10
    v_cmp_u_f32 vcc, v32, v32
    s_cbranch_vccz L_xok0
    s_add_u32 s54, s54, 1
    s_cmp_lt_u32 s54, 0x400
    s_cbranch_scc1 L_xr0
    s_branch L_xok0
L_xredo1:
    s_mov_b32 s54, 0
L_xr1:
    s_sub_u32 s75, s34, s32
    buffer_load_dwordx4 v[132:135], v7, s[48:51], s75 offen offset:0 sc1
    buffer_load_dwordx4 v[136:139], v7, s[48:51], s75 offen offset:1024 sc1
    buffer_load_dwordx4 v[140:143], v7, s[48:51], s75 offen offset:2048 sc1
    buffer_load_dwordx4 v[144:147], v7, s[48:51], s75 offen offset:3072 sc1
    s_add_u32 s75, s75, 4096
    s_waitcnt vmcnt(3)
    v_mfma_f32_32x32x16_bf16 v[64:79], a[0:3], v[132:135], 0
    v_mfma_f32_32x32x16_bf16 v[80:95], a[4:7], v[132:135], 0
    s_waitcnt vmcnt(2)
    v_mfma_f32_32x32x16_bf16 v[64:79], a[8:11], v[136:139], v[64:79]
    v_mfma_f32_32x32x16_bf16 v[80:95], a[12:15], v[136:139], v[80:95]
    s_waitcnt vmcnt(1)
    v_mfma_f32_32x32x16_bf16 v[64:79], a[16:19], v[140:143], v[64:79]
    v_mfma_f32_32x32x16_bf16 v[80:95], a[20:23], v[140:143], v[80:95]
    s_waitcnt vmcnt(0)
    v_mfma_f32_32x32x16_bf16 v[64:79], a[24:27], v[144:147], v[64:79]
    v_mfma_f32_32x32x16_bf16 v[80:95], a[28:31], v[144:147], v[80:95]
    buffer_load_dwordx4 v[132:135], v7, s[48:51], s75 offen offset:0 sc1
    buffer_load_dwordx4 v[136:139], v7, s[48:51], s75 offen offset:1024 sc1
    buffer_load_dwordx4 v[140:143], v7, s[48:51], s75 offen offset:2048 sc1
    buffer_load_dwordx4 v[144:147], v7, s[48:51], s75 offen offset:3072 sc1
    s_add_u32 s75, s75, 4096
    s_waitcnt vmcnt(3)
    v_mfma_f32_32x32x16_bf16 v[64:79], a[32:35], v[132:135], v[64:79]
    v_mfma_f32_32x32x16_bf16 v[80:95], a[36:39], v[132:135], v[80:95]
    s_waitcnt vmcnt(2)
    v_mfma_f32_32x32x16_bf16 v[64:79], a[40:43], v[136:139], v[64:79]
    v_mfma_f32_32x32x16_bf16 v[80:95], a[44:47], v[136:139], v[80:95]
    s_waitcnt vmcnt(1)
    v_mfma_f32_32x32x16_bf16 v[64:79], a[48:51], v[140:143], v[64:79]
    v_mfma_f32_32x32x16_bf16 v[80:95], a[52:55], v[140:143], v[80:95]
    s_waitcnt vmcnt(0)
    v_mfma_f32_32x32x16_bf16 v[64:79], a[56:59], v[144:147], v[64:79]
    v_mfma_f32_32x32x16_bf16 v[80:95], a[60:63], v[144:147], v[80:95]
    buffer_load_dwordx4 v[132:135], v7, s[48:51], s75 offen offset:0 sc1
    buffer_load_dwordx4 v[136:139], v7, s[48:51], s75 offen offset:1024 sc1
    buffer_load_dwordx4 v[140:143], v7, s[48:51], s75 offen offset:2048 sc1
    buffer_load_dwordx4 v[144:147], v7, s[48:51], s75 offen offset:3072 sc1
    s_add_u32 s75, s75, 4096
    s_waitcnt vmcnt(3)
    v_mfma_f32_32x32x16_bf16 v[64:79], a[64:67], v[132:135], v[64:79]
    v_mfma_f32_32x32x16_bf16 v[80:95], a[68:71], v[132:135], v[80:95]
    s_waitcnt vmcnt(2)
    v_mfma_f32_32x32x16_bf16 v[64:79], a[72:75], v[136:139], v[64:79]
    v_mfma_f32_32x32x16_bf16 v[80:95], a[76:79], v[136:139], v[80:95]
    s_waitcnt vmcnt(1)
    v_mfma_f32_32x32x16_bf16 v[64:79], a[80:83], v[140:143], v[64:79]
    v_mfma_f32_32x32x16_bf16 v[80:95], a[84:87], v[140:143], v[80:95]
    s_waitcnt vmcnt(0)
    v_mfma_f32_32x32x16_bf16 v[64:79], a[88:91], v[144:147], v[64:79]
    v_mfma_f32_32x32x16_bf16 v[80:95], a[92:95], v[144:147], v[80:95]
    buffer_load_dwordx4 v[132:135], v7, s[48:51], s75 offen offset:0 sc1
    buffer_load_dwordx4 v[136:139], v7, s[48:51], s75 offen offset:1024 sc1
    buffer_load_dwordx4 v[140:143], v7, s[48:51], s75 offen offset:2048 sc1
    buffer_load_dwordx4 v[144:147], v7, s[48:51], s75 offen offset:3072 sc1
    s_add_u32 s75, s75, 4096
    s_waitcnt vmcnt(3)
    v_mfma_f32_32x32x16_bf16 v[64:79], a[96:99], v[132:135], v[64:79]
    v_mfma_f32_32x32x16_bf16 v[80:95], a[100:103], v[132:135], v[80:95]
    s_waitcnt vmcnt(2)
    v_mfma_f32_32x32x16_bf16 v[64:79], a[104:107], v[136:139], v[64:79]
    v_mfma_f32_32x32x16_bf16 v[80:95], a[108:111], v[136:139], v[80:95]
    s_waitcnt vmcnt(1)
    v_mfma_f32_32x32x16_bf16 v[64:79], a[112:115], v[140:143], v[64:79]
    v_mfma_f32_32x32x16_bf16 v[80:95], a[116:119], v[140:143], v[80:95]
    s_waitcnt vmcnt(0)
    v_mfma_f32_32x32x16_bf16 v[64:79], a[120:123], v[144:147], v[64:79]
    v_mfma_f32_32x32x16_bf16 v[80:95], a[124:127], v[144:147], v[80:95]
    buffer_load_dwordx4 v[132:135], v7, s[48:51], s75 offen offset:0 sc1
    buffer_load_dwordx4 v[136:139], v7, s[48:51], s75 offen offset:1024 sc1
    buffer_load_dwordx4 v[140:143], v7, s[48:51], s75 offen offset:2048 sc1
    buffer_load_dwordx4 v[144:147], v7, s[48:51], s75 offen offset:3072 sc1
    s_add_u32 s75, s75, 4096
    s_waitcnt vmcnt(3)
    v_mfma_f32_32x32x16_bf16 v[64:79], a[128:131], v[132:135], v[64:79]
    v_mfma_f32_32x32x16_bf16 v[80:95], a[132:135], v[132:135], v[80:95]
    s_waitcnt vmcnt(2)
    v_mfma_f32_32x32x16_bf16 v[64:79], a[136:139], v[136:139], v[64:79]
    v_mfma_f32_32x32x16_bf16 v[80:95], a[140:143], v[136:139], v[80:95]
    s_waitcnt vmcnt(1)
    v_mfma_f32_32x32x16_bf16 v[64:79], a[144:147], v[140:143], v[64:79]
    v_mfma_f32_32x32x16_bf16 v[80:95], a[148:151], v[140:143], v[80:95]
    s_waitcnt vmcnt(0)
    v_mfma_f32_32x32x16_bf16 v[64:79], a[152:155], v[144:147], v[64:79]
    v_mfma_f32_32x32x16_bf16 v[80:95], a[156:159], v[144:147], v[80:95]
    buffer_load_dwordx4 v[132:135], v7, s[48:51], s75 offen offset:0 sc1
    buffer_load_dwordx4 v[136:139], v7, s[48:51], s75 offen offset:1024 sc1
    buffer_load_dwordx4 v[140:143], v7, s[48:51], s75 offen offset:2048 sc1
    buffer_load_dwordx4 v[144:147], v7, s[48:51], s75 offen offset:3072 sc1
    s_add_u32 s75, s75, 4096
    s_waitcnt vmcnt(3)
    v_mfma_f32_32x32x16_bf16 v[64:79], a[160:163], v[132:135], v[64:79]
    v_mfma_f32_32x32x16_bf16 v[80:95], a[164:167], v[132:135], v[80:95]
    s_waitcnt vmcnt(2)
    v_mfma_f32_32x32x16_bf16 v[64:79], a[168:171], v[136:139], v[64:79]
    v_mfma_f32_32x32x16_bf16 v[80:95], a[172:175], v[136:139], v[80:95]
    s_waitcnt vmcnt(1)
    v_mfma_f32_32x32x16_bf16 v[64:79], a[176:179], v[140:143], v[64:79]
    v_mfma_f32_32x32x16_bf16 v[80:95], a[180:183], v[140:143], v[80:95]
    s_waitcnt vmcnt(0)
    v_mfma_f32_32x32x16_bf16 v[64:79], a[184:187], v[144:147], v[64:79]
    v_mfma_f32_32x32x16_bf16 v[80:95], a[188:191], v[144:147], v[80:95]
    buffer_load_dwordx4 v[132:135], v7, s[48:51], s75 offen offset:0 sc1
    buffer_load_dwordx4 v[136:139], v7, s[48:51], s75 offen offset:1024 sc1
    buffer_load_dwordx4 v[140:143], v7, s[48:51], s75 offen offset:2048 sc1
    buffer_load_dwordx4 v[144:147], v7, s[48:51], s75 offen offset:3072 sc1
    s_add_u32 s75, s75, 4096
    s_waitcnt vmcnt(3)
    v_mfma_f32_32x32x16_bf16 v[64:79], a[192:195], v[132:135], v[64:79]
    v_mfma_f32_32x32x16_bf16 v[80:95], a[196:199], v[132:135], v[80:95]
    s_waitcnt vmcnt(2)
    v_mfma_f32_32x32x16_bf16 v[64:79], a[200:203], v[136:139], v[64:79]
    v_mfma_f32_32x32x16_bf16 v[80:95], a[204:207], v[136:139], v[80:95]
    s_waitcnt vmcnt(1)
    v_mfma_f32_32x32x16_bf16 v[64:79], a[208:211], v[140:143], v[64:79]
    v_mfma_f32_32x32x16_bf16 v[80:95], a[212:215], v[140:143], v[80:95]
    s_waitcnt vmcnt(0)
    v_mfma_f32_32x32x16_bf16 v[64:79], a[216:219], v[144:147], v[64:79]
    v_mfma_f32_32x32x16_bf16 v[80:95], a[220:223], v[144:147], v[80:95]
    v_mfma_f32_32x32x16_bf16 v[64:79], v[96:99], v[104:107], v[64:79]
    v_mfma_f32_32x32x16_bf16 v[80:95], v[100:103], v[104:107], v[80:95]
    s_nop 10
    v_cmp_u_f32 vcc, v64, v64
    s_cbranch_vccz L_xok1
    s_add_u32 s54, s54, 1
    s_cmp_lt_u32 s54, 0x400
    s_cbranch_scc1 L_xr1
    s_branch L_xok1
L_xslow:
    s_mov_b32 s54, 0
L_poll_30:
    buffer_load_dwordx2 v[104:105], v147, s[48:51], s6 offen sc1
    s_waitcnt vmcnt(0)
    v_cmp_ne_u64 vcc, s[52:53], v[104:105]
    s_cbranch_vccz L_pdone_31
    s_add_u32 s54, s54, 1
    s_cmp_lt_u32 s54, 16384
    s_cbranch_scc1 L_poll_30
    s_waitcnt vmcnt(0)
    v_mov_b32 v104, 5
    buffer_store_dword v104, off, s[44:47], 0 offset:16
    s_waitcnt vmcnt(0)
L_pdone_31:
    s_add_u32 m0, s32, 131072
    s_add_u32 s56, s33, 0
    buffer_load_dwordx4 v7, s[48:51], s56 offen offset:0 sc1 lds
    buffer_load_dwordx4 v7, s[48:51], s56 offen offset:1024 sc1 lds
    buffer_load_dwordx4 v7, s[48:51], s56 offen offset:2048 sc1 lds
    buffer_load_dwordx4 v7, s[48:51], s56 offen offset:3072 sc1 lds
    s_add_u32 m0, s32, 135168
    s_add_u32 s56, s33, 4096
    buffer_load_dwordx4 v7, s[48:51], s56 offen offset:0 sc1 lds
    buffer_load_dwordx4 v7, s[48:51], s56 offen offset:1024 sc1 lds
    buffer_load_dwordx4 v7, s[48:51], s56 offen offset:2048 sc1 lds
    buffer_load_dwordx2 v[132:133], v125, s[48:51], s19 offen offset:0 sc1
    buffer_load_dwordx2 v[134:135], v125, s[48:51], s19 offen offset:256 sc1
    buffer_load_dwordx2 v[136:137], v125, s[48:51], s19 offen offset:512 sc1
    buffer_load_dwordx2 v[138:139], v125, s[48:51], s19 offen offset:768 sc1
    buffer_load_dwordx2 v[140:141], v125, s[48:51], s19 offen offset:1024 sc1
    buffer_load_dwordx2 v[142:143], v125, s[48:51], s19 offen offset:1280 sc1
    buffer_load_dwordx2 v[144:145], v125, s[48:51], s19 offen offset:1536 sc1
    s_branch L_xsok
L_idle:
    s_lshl_b32 s59, s4, 1
    s_add_u32 s59, s59, s62
    s_lshl_b32 s60, s59, 2
    s_add_u32 s60, s60, s3
    s_mul_i32 s56, s60, 14336
    s_lshl_b32 s76, s3, 14
    s_add_u32 s76, s76, 32768
    s_add_u32 m0, s76, 0
    s_add_u32 s57, s56, 0
    buffer_load_dwordx4 v7, s[28:31], s57 offen offset:0 nt lds
    buffer_load_dwordx4 v7, s[28:31], s57 offen offset:1024 nt lds
    buffer_load_dwordx4 v7, s[28:31], s57 offen offset:2048 nt lds
    buffer_load_dwordx4 v7, s[28:31], s57 offen offset:3072 nt lds
    s_add_u32 m0, s76, 4096
    s_add_u32 s57, s56, 4096
    buffer_load_dwordx4 v7, s[28:31], s57 offen offset:0 nt lds
    buffer_load_dwordx4 v7, s[28:31], s57 offen offset:1024 nt lds
    buffer_load_dwordx4 v7, s[28:31], s57 offen offset:2048 nt lds
    buffer_load_dwordx4 v7, s[28:31], s57 offen offset:3072 nt lds
    s_add_u32 m0, s76, 8192
    s_add_u32 s57, s56, 8192
    buffer_load_dwordx4 v7, s[28:31], s57 offen offset:0 nt lds
    buffer_load_dwordx4 v7, s[28:31], s57 offen offset:1024 nt lds
    buffer_load_dwordx4 v7, s[28:31], s57 offen offset:2048 nt lds
    buffer_load_dwordx4 v7, s[28:31], s57 offen offset:3072 nt lds
    s_add_u32 m0, s76, 12288
    s_add_u32 s57, s56, 12288
    buffer_load_dwordx4 v7, s[28:31], s57 offen offset:0 nt lds
    buffer_load_dwordx4 v7, s[28:31], s57 offen offset:1024 nt lds
    v_lshrrev_b32 v6, 5, v0
    v_lshrrev_b32 v8, 2, v4
    v_lshl_add_u32 v8, v6, 2, v8
    v_and_b32 v9, 1, v5
    v_and_b32 v10, 3, v0
    v_lshlrev_b32 v10, 3, v10
    v_mul_u32_u24 v11, 896, v8
    v_lshl_add_u32 v11, v9, 5, v11
    v_add3_u32 v11, v11, v10, s76
    v_mov_b32 v12, -1
    v_mov_b32 v13, -1
    v_mov_b32 v14, -1
    v_mov_b32 v15, -1
    s_lshl_b32 s56, s60, 11
    s_add_u32 s56, s56, 20971520
    s_cmp_ge_u32 s59, 28
    s_cselect_b32 s56, 0x40000000, s56
    s_waitcnt vmcnt(0)
    ds_read_b64_tr_b16 v[64:65], v11 offset:0
    ds_read_b64_tr_b16 v[66:67], v11 offset:7168
    ds_read_b64_tr_b16 v[68:69], v11 offset:64
    ds_read_b64_tr_b16 v[70:71], v11 offset:7232
    ds_read_b64_tr_b16 v[72:73], v11 offset:128
    ds_read_b64_tr_b16 v[74:75], v11 offset:7296
    ds_read_b64_tr_b16 v[76:77], v11 offset:192
    ds_read_b64_tr_b16 v[78:79], v11 offset:7360
    ds_read_b64_tr_b16 v[80:81], v11 offset:256
    ds_read_b64_tr_b16 v[82:83], v11 offset:7424
    ds_read_b64_tr_b16 v[84:85], v11 offset:320
    ds_read_b64_tr_b16 v[86:87], v11 offset:7488
    ds_read_b64_tr_b16 v[88:89], v11 offset:384
    ds_read_b64_tr_b16 v[90:91], v11 offset:7552
    ds_read_b64_tr_b16 v[92:93], v11 offset:448
    ds_read_b64_tr_b16 v[94:95], v11 offset:7616
    ds_read_b64_tr_b16 v[96:97], v11 offset:512
    ds_read_b64_tr_b16 v[98:99], v11 offset:7680
    ds_read_b64_tr_b16 v[100:101], v11 offset:576
    ds_read_b64_tr_b16 v[102:103], v11 offset:7744
    ds_read_b64_tr_b16 v[104:105], v11 offset:640
    ds_read_b64_tr_b16 v[106:107], v11 offset:7808
    ds_read_b64_tr_b16 v[108:109], v11 offset:704
    ds_read_b64_tr_b16 v[110:111], v11 offset:7872
    ds_read_b64_tr_b16 v[112:113], v11 offset:768
    ds_read_b64_tr_b16 v[114:115], v11 offset:7936
    ds_read_b64_tr_b16 v[116:117], v11 offset:832
    ds_read_b64_tr_b16 v[118:119], v11 offset:8000
    s_waitcnt lgkmcnt(14)
    buffer_store_dwordx4 v[64:67], v7, s[48:51], s56 offen offset:0 sc1
    buffer_store_dwordx4 v[68:71], v7, s[48:51], s56 offen offset:1024 sc1
    s_add_u32 s56, s56, 229376
    buffer_store_dwordx4 v[72:75], v7, s[48:51], s56 offen offset:0 sc1
    buffer_store_dwordx4 v[76:79], v7, s[48:51], s56 offen offset:1024 sc1
    s_add_u32 s56, s56, 229376
    buffer_store_dwordx4 v[80:83], v7, s[48:51], s56 offen offset:0 sc1
    buffer_store_dwordx4 v[84:87], v7, s[48:51], s56 offen offset:1024 sc1
    s_add_u32 s56, s56, 229376
    buffer_store_dwordx4 v[88:91], v7, s[48:51], s56 offen offset:0 sc1
    s_waitcnt lgkmcnt(12)
    buffer_store_dwordx4 v[92:95], v7, s[48:51], s56 offen offset:1024 sc1
    s_add_u32 s56, s56, 229376
    s_waitcnt lgkmcnt(10)
    buffer_store_dwordx4 v[96:99], v7, s[48:51], s56 offen offset:0 sc1
    s_waitcnt lgkmcnt(8)
    buffer_store_dwordx4 v[100:103], v7, s[48:51], s56 offen offset:1024 sc1
    s_add_u32 s56, s56, 229376
    s_waitcnt lgkmcnt(6)
    buffer_store_dwordx4 v[104:107], v7, s[48:51], s56 offen offset:0 sc1
    s_waitcnt lgkmcnt(4)
    buffer_store_dwordx4 v[108:111], v7, s[48:51], s56 offen offset:1024 sc1
    s_add_u32 s56, s56, 229376
    s_waitcnt lgkmcnt(2)
    buffer_store_dwordx4 v[112:115], v7, s[48:51], s56 offen offset:0 sc1
    s_waitcnt lgkmcnt(0)
    buffer_store_dwordx4 v[116:119], v7, s[48:51], s56 offen offset:1024 sc1
    s_add_u32 s56, s56, 229376
    s_lshl_b32 s59, s59, 7
    s_add_u32 s59, s59, 22675456
    s_lshl_b32 s60, s62, 7
    s_add_u32 s60, s60, s77
    s_add_u32 s60, s60, 1013760
    s_cmp_lg_u32 s3, 0
    s_cselect_b32 s59, 0x40000000, s59
    s_cselect_b32 s60, 0x40000000, s60
    s_lshl_b32 s56, s62, 2
    s_add_u32 s56, s56, s3
    s_mul_i32 s56, s56, 28672
    s_add_u32 s56, s56, s77
    s_add_u32 s56, s56, 524288
    s_waitcnt vmcnt(0)
    s_barrier
    s_mov_b64 exec, 0xffff
    buffer_store_dwordx2 v[26:27], v29, s[48:51], s59 offen sc1
    s_mov_b64 exec, -1
    s_mov_b32 s57, 7
L_idle0:
    buffer_store_dwordx4 v[12:15], v7, s[48:51], s56 offen offset:0 sc1
    buffer_store_dwordx4 v[12:15], v7, s[48:51], s56 offen offset:1024 sc1
    buffer_store_dwordx4 v[12:15], v7, s[48:51], s56 offen offset:2048 sc1
    buffer_store_dwordx4 v[12:15], v7, s[48:51], s56 offen offset:3072 sc1
    s_add_u32 s56, s56, 4096
    s_sub_u32 s57, s57, 1
    s_cmp_lg_u32 s57, 0
    s_cbranch_scc1 L_idle0
    s_add_u32 s56, s56, 200704
    s_waitcnt vmcnt(0)
    s_barrier
    s_mov_b64 exec, 0xffff
    buffer_store_dwordx2 v[26:27], v29, s[48:51], s60 offen sc1
    s_mov_b64 exec, -1
    s_add_u32 s60, s60, 256
    s_mov_b32 s57, 7
L_idle1:
    buffer_store_dwordx4 v[12:15], v7, s[48:51], s56 offen offset:0 sc1
    buffer_store_dwordx4 v[12:15], v7, s[48:51], s56 offen offset:1024 sc1
    buffer_store_dwordx4 v[12:15], v7, s[48:51], s56 offen offset:2048 sc1
    buffer_store_dwordx4 v[12:15], v7, s[48:51], s56 offen offset:3072 sc1
    s_add_u32 s56, s56, 4096
    s_sub_u32 s57, s57, 1
    s_cmp_lg_u32 s57, 0
    s_cbranch_scc1 L_idle1
    s_add_u32 s56, s56, 200704
    s_waitcnt vmcnt(0)
    s_barrier
    s_mov_b64 exec, 0xffff
    buffer_store_dwordx2 v[26:27], v29, s[48:51], s60 offen sc1
    s_mov_b64 exec, -1
    s_add_u32 s60, s60, 256
L_fin:
L_end:
    s_endpgm
.section .rodata,"a"
.p2align 6
.amdhsa_kernel adaLN_cond__sliding_local_dilated__glu_gated_geglu__prompt_kernel
  .amdhsa_next_free_vgpr 512
  .amdhsa_next_free_sgpr 102
  .amdhsa_accum_offset 256
  .amdhsa_group_segment_fixed_size 0
  .amdhsa_kernarg_size 96
  .amdhsa_user_sgpr_count 2
  .amdhsa_user_sgpr_kernarg_segment_ptr 1
  .amdhsa_system_sgpr_workgroup_id_x 1
.end_amdhsa_kernel
```
